```python
import torch

def _softmax(x, axis=-1):
    return torch.softmax(x, dim=axis)

def _gelu(x):
    return torch.nn.functional.gelu(x, approximate='tanh')

def _silu(x):
    return torch.nn.functional.silu(x)

def _sigmoid(x):
    return torch.sigmoid(x)

def _layernorm(x, axis=-1, eps=1e-05):
    m = x.mean(dim=axis, keepdim=True)
    v = x.var(dim=axis, keepdim=True, unbiased=False)
    return (x - m) / torch.sqrt(v + eps)

def _scatter_add(tgt, idx, src, axis=0):
    return tgt.clone().index_add_(axis, idx, src)

def _segment_sum(src, seg, n):
    out = torch.zeros((n,) + src.shape[1:], dtype=src.dtype)
    return out.index_add_(0, seg, src)

def _pad(x, pw):
    flat = tuple((v for pair in reversed(pw) for v in pair))
    return torch.nn.functional.pad(x, flat)
kernel_name = 'concat_heads__memory_aug_recurrent_mem_tr__linear_kernel_hedgehog__prompt'

def setup_inputs():

    _w = lambda a: (lambda t: t.to(torch.bfloat16) if t.is_floating_point() else t)(torch.as_tensor(a))

    def _A_setup():
        B, S, Dm = (1, 2048, 640)
        H, Dh = (32, 192)
        M, seg = (8, 32)
        seg = min(seg, S)
        S = S // seg * seg
        return {'x': _w((lambda *s: torch.randn(*s, dtype=torch.bfloat16) * 0.05)(B, S, Dm)), 'mem0': _w((lambda *s: torch.randn(*s, dtype=torch.bfloat16) * 1.6)(B, M, Dm)), 'Wq': _w((lambda *s: torch.randn(*s, dtype=torch.bfloat16) * 0.8)(Dm, H, Dh) * Dm ** (-0.5)), 'Wk': _w((lambda *s: torch.randn(*s, dtype=torch.bfloat16) * 0.8)(Dm, H, Dh) * Dm ** (-0.5)), 'Wv': _w((lambda *s: torch.randn(*s, dtype=torch.bfloat16) * 1.6)(Dm, H, Dh) * Dm ** (-0.5)), 'Wo': _w((lambda *s: torch.randn(*s, dtype=torch.bfloat16) * 1.6)(H, Dh, Dm) * (H * Dh) ** (-0.5)), 'seg_len': seg}
    _A_in = _A_setup()

    def _B_setup():
        B, S, D, H = (1, 2048, 640, 32)
        Dh = D // H
        return {'x': _w((lambda *s: torch.randn(*s, dtype=torch.bfloat16) * 0.8)(B, S, D)), 'wqkv': _w((lambda *s: torch.randn(*s, dtype=torch.bfloat16) * 0.8)(D, 3 * D)), 'w_phi': _w((lambda *s: torch.randn(*s, dtype=torch.bfloat16) * 0.8)(H, Dh, Dh) * Dh ** (-0.5)), 'wo': _w((lambda *s: torch.randn(*s, dtype=torch.bfloat16) * 0.05)(D, D))}
    _B_in = _B_setup()
    return {'A_x': _A_in['x'], 'A_mem0': _A_in['mem0'], 'A_Wq': _A_in['Wq'], 'A_Wk': _A_in['Wk'], 'A_Wv': _A_in['Wv'], 'A_Wo': _A_in['Wo'], 'A_seg_len': _A_in['seg_len'], 'B_x': _B_in['x'], 'B_wqkv': _B_in['wqkv'], 'B_w_phi': _B_in['w_phi'], 'B_wo': _B_in['wo']}

def reference(A_x, A_mem0, A_Wq, A_Wk, A_Wv, A_Wo, A_seg_len, B_x, B_wqkv, B_w_phi, B_wo):

    def _A_ref(x, mem0, Wq, Wk, Wv, Wo, seg_len):
        B, S, Dm = x.shape
        H, Dh = (Wq.shape[1], Wq.shape[2])
        M = mem0.shape[1]
        scale = Dh ** (-0.5)
        n_seg = S // seg_len
        L = M + seg_len
        idx = torch.arange(L)
        mask = (idx[:, None] < M) | (idx[:, None] >= idx[None, :])
        mem = mem0
        outs = []
        for s in range(n_seg):
            xs = x[:, s * seg_len:(s + 1) * seg_len, :].clone()
            h = torch.concatenate([mem, xs], axis=1)
            q = torch.einsum('btd,dhe->bhte', h, Wq)
            k = torch.einsum('btd,dhe->bhte', h, Wk)
            v = torch.einsum('btd,dhe->bhte', h, Wv)
            scores = torch.einsum('bhqe,bhke->bhqk', q, k) * scale
            scores = torch.where(mask[None, None], scores, -1000000000.0)
            p = _softmax(scores, axis=-1)
            o = torch.einsum('bhqk,bhke->bhqe', p, v)
            o = torch.einsum('bhte,hed->btd', o, Wo)
            mem = o[:, :M, :].clone()
            outs.append(o[:, M:, :])
        return torch.concatenate(outs, axis=1)

    def _B_ref(x, wqkv, w_phi, wo):
        B, S, D = x.shape
        H = 32
        Dh = D // H
        qkv = (lambda x, *d: x.permute(*d))((x @ wqkv).reshape(B, S, 3, H, Dh), 2, 0, 3, 1, 4)
        q, k, v = (qkv[0], qkv[1], qkv[2])
        pq = torch.einsum('bhsd,hdf->bhsf', q, w_phi)
        pk = torch.einsum('bhsd,hdf->bhsf', k, w_phi)
        phi_q = torch.concatenate([_softmax(pq, axis=-1), _softmax(-pq, axis=-1)], axis=-1)
        phi_k = torch.concatenate([_softmax(pk, axis=-1), _softmax(-pk, axis=-1)], axis=-1)
        kv = torch.einsum('bhsf,bhsd->bhfd', phi_k, v)
        z = torch.einsum('bhsf->bhf', phi_k)
        num = torch.einsum('bhqf,bhfd->bhqd', phi_q, kv)
        den = torch.einsum('bhqf,bhf->bhq', phi_q, z)[..., None] + 1e-06
        o = num / den
        return (lambda x, *d: x.permute(*d))(o, 0, 2, 1, 3).reshape(B, S, D) @ wo
    a = _A_ref(A_x, A_mem0, A_Wq, A_Wk, A_Wv, A_Wo, A_seg_len)
    b = _B_ref(B_x, B_wqkv, B_w_phi, B_wo)
    return torch.concatenate([a, b], axis=-1)
```

```asm
; @launch grid=(256,1,1) block=(256,1,1) lds=161792
.amdgcn_target "amdgcn-amd-amdhsa--gfx950"
.text
.globl concat_heads__memory_aug_recurrent_mem_tr__linear_kernel_hedgehog__prompt_kernel
.p2align 8
.type concat_heads__memory_aug_recurrent_mem_tr__linear_kernel_hedgehog__prompt_kernel,@function
concat_heads__memory_aug_recurrent_mem_tr__linear_kernel_hedgehog__prompt_kernel:
    s_cmp_ge_u32 s2, 256
    s_cbranch_scc1 L_end
    s_load_dwordx16 s[68:83], s[0:1], 0
    s_load_dwordx8 s[84:91], s[0:1], 64
    s_load_dwordx4 s[92:95], s[0:1], 96
    s_getreg_b32 s32, hwreg(HW_REG_XCC_ID)
    s_and_b32 s32, s32, 15
    v_and_b32 v1, 63, v0
    v_lshrrev_b32 v2, 6, v0
    s_mov_b32 s37, 200000
    v_readfirstlane_b32 s34, v2
    s_waitcnt lgkmcnt(0)
    s_mov_b32 s8, s94
    s_mov_b32 s9, s95
    s_mov_b32 s10, 268435456
    s_mov_b32 s11, 0x20000
    s_mov_b32 s12, s92
    s_mov_b32 s13, s93
    s_mov_b32 s14, 256
    s_mov_b32 s15, 0x20000
    s_lshr_b32 s33, s2, 3
    s_mov_b32 s100, 0
    s_mov_b32 s38, 1
    s_lshl_b32 s46, 1, s33
    s_cmp_ge_u32 s32, 8
    s_cselect_b32 s47, 0x01000000, 0
    s_or_b32 s47, s47, 0x100
    s_and_b32 s32, s32, 7
    s_cmp_ge_u32 s2, 208
    s_cbranch_scc1 L_init
    s_cmp_lg_u32 s34, 0
    s_cbranch_scc1 CL_1
    s_mov_b64 exec, 1
    v_mov_b32 v4, s46
    v_mov_b32 v5, s47
    s_lshl_b32 s44, s32, 3
    v_mov_b32 v3, s44
    buffer_atomic_add_x2 v[4:5], v3, s[12:15], 0 offen
    s_mov_b64 exec, -1
CL_1:
    s_cmp_ge_u32 s2, 128
    s_cbranch_scc1 L_str
    s_branch L_disp
L_init:
    s_cmp_lt_u32 s2, 240
    s_cbranch_scc1 L_ncp
    s_getpc_b64 s[48:49]
    s_bfe_u32 s44, s2, 0x10003
    s_lshl_b32 s44, s44, 2
    s_add_u32 s44, s44, s34
    s_lshl_b32 s44, s44, 10
    v_lshlrev_b32 v24, 4, v1
    v_add_u32 v24, s44, v24
    global_load_dwordx4 v[28:31], v24, s[48:49]
    v_add_u32 v24, 0x2000, v24
    global_load_dwordx4 v[28:31], v24, s[48:49]
    v_add_u32 v24, 0x2000, v24
    global_load_dwordx4 v[28:31], v24, s[48:49]
    v_add_u32 v24, 0x2000, v24
    global_load_dwordx4 v[28:31], v24, s[48:49]
    v_add_u32 v24, 0x2000, v24
    global_load_dwordx4 v[28:31], v24, s[48:49]
    v_add_u32 v24, 0x2000, v24
    global_load_dwordx4 v[28:31], v24, s[48:49]
    v_add_u32 v24, 0x2000, v24
L_ncp:
    s_sub_u32 s50, s2, 208
    s_lshl_b32 s50, s50, 2
    s_add_u32 s50, s50, s34
    v_lshlrev_b32 v24, 4, v1
    s_lshr_b32 s53, s50, 5
    s_lshl_b32 s53, s53, 2
    s_add_u32 s53, s53, s34
    s_lshr_b32 s44, s53, 3
    s_and_b32 s53, s53, 7
    s_lshl_b32 s51, s53, 21
    s_lshl_b32 s44, s44, 3
    s_and_b32 s45, s2, 7
    s_add_u32 s44, s44, s45
    s_lshl_b32 s44, s44, 8
    s_add_u32 s51, s51, s44
    s_add_u32 s51, s51, 2064384
    s_add_u32 s52, s51, 8192
    s_mov_b64 exec, 1
    v_mov_b32 v3, 0
    s_mov_b32 s54, -1
    s_mov_b32 s55, -1
    v_mov_b32 v2, 0
    buffer_atomic_add v2, v3, s[8:11], s51 offen
    buffer_atomic_add v2, v3, s[8:11], s52 offen
    s_waitcnt vmcnt(0)
    v_mov_b32 v2, 0
    s_memtime s[56:57]
    buffer_atomic_add v2, v3, s[8:11], s51 offen sc0
    s_waitcnt vmcnt(0)
    s_memtime s[48:49]
    s_waitcnt lgkmcnt(0)
    s_sub_u32 s44, s48, s56
    s_min_u32 s54, s54, s44
    v_mov_b32 v2, 0
    s_memtime s[56:57]
    buffer_atomic_add v2, v3, s[8:11], s52 offen sc0
    s_waitcnt vmcnt(0)
    s_memtime s[48:49]
    s_waitcnt lgkmcnt(0)
    s_sub_u32 s44, s48, s56
    s_min_u32 s55, s55, s44
    v_mov_b32 v2, 0
    s_memtime s[56:57]
    buffer_atomic_add v2, v3, s[8:11], s51 offen sc0
    s_waitcnt vmcnt(0)
    s_memtime s[48:49]
    s_waitcnt lgkmcnt(0)
    s_sub_u32 s44, s48, s56
    s_min_u32 s54, s54, s44
    v_mov_b32 v2, 0
    s_memtime s[56:57]
    buffer_atomic_add v2, v3, s[8:11], s52 offen sc0
    s_waitcnt vmcnt(0)
    s_memtime s[48:49]
    s_waitcnt lgkmcnt(0)
    s_sub_u32 s44, s48, s56
    s_min_u32 s55, s55, s44
    v_mov_b32 v2, 0
    s_memtime s[56:57]
    buffer_atomic_add v2, v3, s[8:11], s51 offen sc0
    s_waitcnt vmcnt(0)
    s_memtime s[48:49]
    s_waitcnt lgkmcnt(0)
    s_sub_u32 s44, s48, s56
    s_min_u32 s54, s54, s44
    v_mov_b32 v2, 0
    s_memtime s[56:57]
    buffer_atomic_add v2, v3, s[8:11], s52 offen sc0
    s_waitcnt vmcnt(0)
    s_memtime s[48:49]
    s_waitcnt lgkmcnt(0)
    s_sub_u32 s44, s48, s56
    s_min_u32 s55, s55, s44
    v_mov_b32 v2, 0
    s_memtime s[56:57]
    buffer_atomic_add v2, v3, s[8:11], s51 offen sc0
    s_waitcnt vmcnt(0)
    s_memtime s[48:49]
    s_waitcnt lgkmcnt(0)
    s_sub_u32 s44, s48, s56
    s_min_u32 s54, s54, s44
    v_mov_b32 v2, 0
    s_memtime s[56:57]
    buffer_atomic_add v2, v3, s[8:11], s52 offen sc0
    s_waitcnt vmcnt(0)
    s_memtime s[48:49]
    s_waitcnt lgkmcnt(0)
    s_sub_u32 s44, s48, s56
    s_min_u32 s55, s55, s44
    s_cmp_lt_u32 s55, s54
    s_cselect_b32 s44, 1, 0
    s_lshr_b32 s45, s32, 2
    s_xor_b32 s44, s44, s45
    s_lshl_b32 s45, s53, 2
    s_and_b32 s45, s45, 24
    s_lshl_b32 s44, s44, s45
    v_mov_b32 v2, s44
    s_and_b32 s45, s53, 1
    s_lshl_b32 s45, s45, 2
    s_add_u32 s45, s45, 64
    v_mov_b32 v3, s45
    v_cmpx_ne_u32 vcc, 0, v2
    buffer_atomic_add v2, v3, s[12:15], 0 offen
    s_mov_b64 exec, -1
    v_mov_b32 v20, -1
    v_mov_b32 v21, -1
    v_mov_b32 v22, -1
    v_mov_b32 v23, -1
    s_lshl_b32 s44, s50, 10
    s_add_u32 s45, s44, 0
    buffer_store_dwordx4 v[20:23], v24, s[8:11], s45 offen sc1
    s_add_u32 s45, s44, 196608
    buffer_store_dwordx4 v[20:23], v24, s[8:11], s45 offen sc1
    s_add_u32 s45, s44, 393216
    buffer_store_dwordx4 v[20:23], v24, s[8:11], s45 offen sc1
    s_add_u32 s45, s44, 589824
    buffer_store_dwordx4 v[20:23], v24, s[8:11], s45 offen sc1
    s_add_u32 s45, s44, 786432
    buffer_store_dwordx4 v[20:23], v24, s[8:11], s45 offen sc1
    s_add_u32 s45, s44, 983040
    buffer_store_dwordx4 v[20:23], v24, s[8:11], s45 offen sc1
    s_add_u32 s45, s44, 1179648
    buffer_store_dwordx4 v[20:23], v24, s[8:11], s45 offen sc1
    s_add_u32 s45, s44, 1376256
    buffer_store_dwordx4 v[20:23], v24, s[8:11], s45 offen sc1
    s_add_u32 s45, s44, 1572864
    buffer_store_dwordx4 v[20:23], v24, s[8:11], s45 offen sc1
    s_cmp_ge_u32 s50, 64
    s_cbranch_scc1 L_ip0
    s_add_u32 s45, s44, 1769472
    buffer_store_dwordx4 v[20:23], v24, s[8:11], s45 offen sc1
L_ip0:
    s_add_u32 s45, s44, 2097152
    buffer_store_dwordx4 v[20:23], v24, s[8:11], s45 offen sc1
    s_add_u32 s45, s44, 2293760
    buffer_store_dwordx4 v[20:23], v24, s[8:11], s45 offen sc1
    s_add_u32 s45, s44, 2490368
    buffer_store_dwordx4 v[20:23], v24, s[8:11], s45 offen sc1
    s_add_u32 s45, s44, 2686976
    buffer_store_dwordx4 v[20:23], v24, s[8:11], s45 offen sc1
    s_add_u32 s45, s44, 2883584
    buffer_store_dwordx4 v[20:23], v24, s[8:11], s45 offen sc1
    s_add_u32 s45, s44, 3080192
    buffer_store_dwordx4 v[20:23], v24, s[8:11], s45 offen sc1
    s_add_u32 s45, s44, 3276800
    buffer_store_dwordx4 v[20:23], v24, s[8:11], s45 offen sc1
    s_add_u32 s45, s44, 3473408
    buffer_store_dwordx4 v[20:23], v24, s[8:11], s45 offen sc1
    s_add_u32 s45, s44, 3670016
    buffer_store_dwordx4 v[20:23], v24, s[8:11], s45 offen sc1
    s_cmp_ge_u32 s50, 64
    s_cbranch_scc1 L_ip1
    s_add_u32 s45, s44, 3866624
    buffer_store_dwordx4 v[20:23], v24, s[8:11], s45 offen sc1
L_ip1:
    s_add_u32 s45, s44, 14680064
    buffer_store_dwordx4 v[20:23], v24, s[8:11], s45 offen sc1
    s_add_u32 s45, s44, 14876672
    s_cmp_lt_u32 s50, 128
    s_cbranch_scc1 L_in1
    v_mov_b32 v20, 0
    v_mov_b32 v21, 0
    v_mov_b32 v22, 0
    v_mov_b32 v23, 0
    buffer_store_dwordx4 v[20:23], v24, s[8:11], s45 offen sc1
    s_add_u32 s45, s44, 1769472
    buffer_store_dwordx4 v[20:23], v24, s[8:11], s45 offen sc1
    s_add_u32 s45, s44, 1703936
L_in1:
    buffer_store_dwordx4 v[20:23], v24, s[8:11], s45 offen sc1
    s_waitcnt vmcnt(0)
    s_barrier
    s_cmp_lg_u32 s34, 0
    s_cbranch_scc1 CL_2
    s_mov_b64 exec, 1
    v_mov_b32 v4, s46
    v_mov_b32 v5, s47
    s_lshl_b32 s44, s32, 3
    v_mov_b32 v3, s44
    buffer_atomic_add_x2 v[4:5], v3, s[12:15], 0 offen
    s_mov_b64 exec, -1
CL_2:
    s_cmp_lg_u32 s50, 188
    s_cbranch_scc1 L_disp
    s_mov_b64 exec, 0x1ff
    v_lshlrev_b32 v3, 3, v1
    s_mov_b32 s42, 0
L_go_w:
    buffer_load_dwordx2 v[4:5], v3, s[12:15], 0 offen sc1
    s_waitcnt vmcnt(0)
    s_mov_b32 s46, 0
    v_readlane_b32 s44, v5, 0
    s_nop 0
    s_bfe_u32 s44, s44, 0x100008
    s_add_u32 s46, s46, s44
    v_readlane_b32 s44, v5, 1
    s_nop 0
    s_bfe_u32 s44, s44, 0x100008
    s_add_u32 s46, s46, s44
    v_readlane_b32 s44, v5, 2
    s_nop 0
    s_bfe_u32 s44, s44, 0x100008
    s_add_u32 s46, s46, s44
    v_readlane_b32 s44, v5, 3
    s_nop 0
    s_bfe_u32 s44, s44, 0x100008
    s_add_u32 s46, s46, s44
    v_readlane_b32 s44, v5, 4
    s_nop 0
    s_bfe_u32 s44, s44, 0x100008
    s_add_u32 s46, s46, s44
    v_readlane_b32 s44, v5, 5
    s_nop 0
    s_bfe_u32 s44, s44, 0x100008
    s_add_u32 s46, s46, s44
    v_readlane_b32 s44, v5, 6
    s_nop 0
    s_bfe_u32 s44, s44, 0x100008
    s_add_u32 s46, s46, s44
    v_readlane_b32 s44, v5, 7
    s_nop 0
    s_bfe_u32 s44, s44, 0x100008
    s_add_u32 s46, s46, s44
    s_cmp_ge_u32 s46, 256
    s_cbranch_scc1 L_go_a
    s_sleep 8
    s_add_u32 s42, s42, 1
    s_cmp_lt_u32 s42, s37
    s_cbranch_scc1 L_go_w
    s_mov_b32 s37, 1
L_go_a:
    buffer_load_dwordx2 v[4:5], v3, s[12:15], 0 offen sc1
    s_waitcnt vmcnt(0)
    v_readlane_b32 s45, v4, 8
    v_readlane_b32 s46, v5, 8
    s_mov_b64 exec, 0xff
    v_cmp_ne_u32 vcc, -1, v4
    s_mov_b32 s44, 0x2000
    v_cmp_ne_u32 s[48:49], s44, v5
    s_add_u32 s45, s45, 0x13131313
    s_lshr_b32 s45, s45, 5
    s_and_b32 s45, s45, 0x01010101
    s_add_u32 s46, s46, 0x13131313
    s_lshr_b32 s46, s46, 1
    s_and_b32 s46, s46, 0x10101010
    s_or_b32 s45, s45, s46
    s_or_b64 vcc, vcc, s[48:49]
    s_cselect_b32 s44, 2, 1
    s_mov_b64 exec, 1
    v_mov_b32 v4, s44
    v_mov_b32 v5, s45
    v_mov_b32 v3, 128
    buffer_store_dwordx2 v[4:5], v3, s[12:15], 0 offen sc1
    s_mov_b64 exec, -1
    s_branch L_disp
L_str:
    s_mov_b32 s16, s72
    s_mov_b32 s17, s73
    s_mov_b32 s18, 7864320
    s_mov_b32 s19, 0x20000
    s_mov_b32 s20, s74
    s_mov_b32 s21, s75
    s_mov_b32 s22, 7864320
    s_mov_b32 s23, 0x20000
    s_mov_b32 s24, s76
    s_mov_b32 s25, s77
    s_mov_b32 s26, 7864320
    s_mov_b32 s27, 0x20000
    s_mov_b32 s28, s78
    s_mov_b32 s29, s79
    s_mov_b32 s30, 7864320
    s_mov_b32 s31, 0x20000
    s_sub_u32 s50, s2, 128
    s_lshl_b32 s50, s50, 2
    s_add_u32 s50, s50, s34
    v_lshlrev_b32 v24, 4, v1
    s_mov_b32 s24, s68
    s_mov_b32 s25, s69
    s_mov_b32 s26, 2621440
    s_mov_b32 s27, 0x20000
    s_lshl_b32 s44, s50, 13
    s_waitcnt vmcnt(40)
    buffer_load_dwordx4 v[28:31], v24, s[24:27], s44 offen
    s_add_u32 s44, s44, 1024
    buffer_load_dwordx4 v[28:31], v24, s[24:27], s44 offen
    s_add_u32 s44, s44, 1024
    buffer_load_dwordx4 v[28:31], v24, s[24:27], s44 offen
    s_add_u32 s44, s44, 1024
    buffer_load_dwordx4 v[28:31], v24, s[24:27], s44 offen
    s_add_u32 s44, s44, 1024
    buffer_load_dwordx4 v[28:31], v24, s[24:27], s44 offen
    s_add_u32 s44, s44, 1024
    buffer_load_dwordx4 v[28:31], v24, s[24:27], s44 offen
    s_add_u32 s44, s44, 1024
    buffer_load_dwordx4 v[28:31], v24, s[24:27], s44 offen
    s_add_u32 s44, s44, 1024
    buffer_load_dwordx4 v[28:31], v24, s[24:27], s44 offen
    s_add_u32 s44, s44, 1024
    s_waitcnt vmcnt(0)
L_disp:
    s_lshr_b32 s40, s32, 2
    s_and_b32 s41, s32, 3
    s_cmp_lt_u32 s33, 8
    s_cbranch_scc1 L_S
    s_cmp_lt_u32 s33, 16
    s_cbranch_scc1 L_V
    s_cmp_lt_u32 s33, 26
    s_cbranch_scc1 L_R
    s_cmp_lt_u32 s33, 30
    s_cbranch_scc1 L_B
    s_mov_b32 s42, 0
    v_mov_b32 v3, 128
WST_3:
    buffer_load_dwordx2 v[4:5], v3, s[12:15], 0 offen sc1
    s_waitcnt vmcnt(0)
    v_readfirstlane_b32 s44, v4
    v_readfirstlane_b32 s39, v5
    s_cmp_lg_u32 s44, 0
    s_cbranch_scc1 WSO_4
    s_sleep 4
    s_add_u32 s42, s42, 1
    s_cmp_lt_u32 s42, s37
    s_cbranch_scc1 WST_3
    s_mov_b32 s37, 1
WSO_4:
    s_cmp_lg_u32 s100, 0
    s_cbranch_scc1 WSE_6
    s_cmp_eq_u32 s44, 2
    s_cbranch_scc1 L_fallback
WSE_6:
L_end:
    s_endpgm
L_fallback:
    s_mov_b64 exec, -1
    s_waitcnt vmcnt(0) lgkmcnt(0)
    s_barrier
    s_load_dwordx16 s[68:83], s[0:1], 0
    s_load_dwordx8 s[84:91], s[0:1], 64
    s_getreg_b32 s32, hwreg(HW_REG_XCC_ID)
    s_and_b32 s32, s32, 15
    s_mov_b32 s100, 1
    s_min_u32 s32, s32, 8
    s_cmp_lg_u32 s34, 0
    s_cbranch_scc1 L_tk
    s_mov_b64 exec, 1
    v_mov_b32 v2, 1
    s_lshl_b32 s44, s32, 2
    v_mov_b32 v3, s44
    buffer_atomic_add v2, v3, s[12:15], 0 offen offset:72 sc0
    s_waitcnt vmcnt(0)
    v_readfirstlane_b32 s33, v2
    s_mov_b32 s45, -1
    s_cmp_ge_u32 s32, 8
    s_cbranch_scc1 L_ovf
    s_cmp_lt_u32 s33, 32
    s_cbranch_scc1 L_cnt
L_ovf:
    v_mov_b32 v2, 1
    v_mov_b32 v3, 112
    buffer_atomic_add v2, v3, s[12:15], 0 offen sc0
    s_waitcnt vmcnt(0)
    v_readfirstlane_b32 s45, v2
    s_mov_b32 s32, 0
    s_mov_b32 s33, 31
L_cnt:
    s_mov_b64 exec, 0x1ff
    v_lshlrev_b32 v3, 2, v1
    s_mov_b32 s42, 0
L_ovf_w:
    buffer_load_dword v2, v3, s[12:15], 0 offen offset:72 sc1
    s_waitcnt vmcnt(0)
    s_mov_b32 s46, 0
    v_readlane_b32 s44, v2, 0
    s_nop 0
    s_add_u32 s46, s46, s44
    v_readlane_b32 s44, v2, 1
    s_nop 0
    s_add_u32 s46, s46, s44
    v_readlane_b32 s44, v2, 2
    s_nop 0
    s_add_u32 s46, s46, s44
    v_readlane_b32 s44, v2, 3
    s_nop 0
    s_add_u32 s46, s46, s44
    v_readlane_b32 s44, v2, 4
    s_nop 0
    s_add_u32 s46, s46, s44
    v_readlane_b32 s44, v2, 5
    s_nop 0
    s_add_u32 s46, s46, s44
    v_readlane_b32 s44, v2, 6
    s_nop 0
    s_add_u32 s46, s46, s44
    v_readlane_b32 s44, v2, 7
    s_nop 0
    s_add_u32 s46, s46, s44
    v_readlane_b32 s44, v2, 8
    s_nop 0
    s_add_u32 s46, s46, s44
    s_cmp_ge_u32 s46, 256
    s_cbranch_scc1 L_ovf_a
    s_sleep 16
    s_add_u32 s42, s42, 1
    s_cmp_lt_u32 s42, s37
    s_cbranch_scc1 L_ovf_w
    s_mov_b32 s37, 1
L_ovf_a:
    v_readlane_b32 s44, v2, 0
    s_nop 0
    s_min_u32 s44, s44, 32
    s_sub_u32 s46, 32, s44
    s_add_u32 s47, s44, s45
    s_cmp_lt_u32 s45, s46
    s_cselect_b32 s32, 0, s32
    s_cselect_b32 s33, s47, s33
    s_cselect_b32 s45, -1, s45
    s_sub_u32 s45, s45, s46
    v_readlane_b32 s44, v2, 1
    s_nop 0
    s_min_u32 s44, s44, 32
    s_sub_u32 s46, 32, s44
    s_add_u32 s47, s44, s45
    s_cmp_lt_u32 s45, s46
    s_cselect_b32 s32, 1, s32
    s_cselect_b32 s33, s47, s33
    s_cselect_b32 s45, -1, s45
    s_sub_u32 s45, s45, s46
    v_readlane_b32 s44, v2, 2
    s_nop 0
    s_min_u32 s44, s44, 32
    s_sub_u32 s46, 32, s44
    s_add_u32 s47, s44, s45
    s_cmp_lt_u32 s45, s46
    s_cselect_b32 s32, 2, s32
    s_cselect_b32 s33, s47, s33
    s_cselect_b32 s45, -1, s45
    s_sub_u32 s45, s45, s46
    v_readlane_b32 s44, v2, 3
    s_nop 0
    s_min_u32 s44, s44, 32
    s_sub_u32 s46, 32, s44
    s_add_u32 s47, s44, s45
    s_cmp_lt_u32 s45, s46
    s_cselect_b32 s32, 3, s32
    s_cselect_b32 s33, s47, s33
    s_cselect_b32 s45, -1, s45
    s_sub_u32 s45, s45, s46
    v_readlane_b32 s44, v2, 4
    s_nop 0
    s_min_u32 s44, s44, 32
    s_sub_u32 s46, 32, s44
    s_add_u32 s47, s44, s45
    s_cmp_lt_u32 s45, s46
    s_cselect_b32 s32, 4, s32
    s_cselect_b32 s33, s47, s33
    s_cselect_b32 s45, -1, s45
    s_sub_u32 s45, s45, s46
    v_readlane_b32 s44, v2, 5
    s_nop 0
    s_min_u32 s44, s44, 32
    s_sub_u32 s46, 32, s44
    s_add_u32 s47, s44, s45
    s_cmp_lt_u32 s45, s46
    s_cselect_b32 s32, 5, s32
    s_cselect_b32 s33, s47, s33
    s_cselect_b32 s45, -1, s45
    s_sub_u32 s45, s45, s46
    v_readlane_b32 s44, v2, 6
    s_nop 0
    s_min_u32 s44, s44, 32
    s_sub_u32 s46, 32, s44
    s_add_u32 s47, s44, s45
    s_cmp_lt_u32 s45, s46
    s_cselect_b32 s32, 6, s32
    s_cselect_b32 s33, s47, s33
    s_cselect_b32 s45, -1, s45
    s_sub_u32 s45, s45, s46
    v_readlane_b32 s44, v2, 7
    s_nop 0
    s_min_u32 s44, s44, 32
    s_sub_u32 s46, 32, s44
    s_add_u32 s47, s44, s45
    s_cmp_lt_u32 s45, s46
    s_cselect_b32 s32, 7, s32
    s_cselect_b32 s33, s47, s33
    s_cselect_b32 s45, -1, s45
    s_sub_u32 s45, s45, s46
    v_readlane_b32 s44, v2, s32
    s_nop 0
    s_cmp_ge_u32 s44, 32
    s_cselect_b32 s45, 0x10000, 0
    s_mov_b64 exec, 1
    s_lshl_b32 s44, s32, 8
    s_or_b32 s44, s44, s33
    s_or_b32 s44, s44, s45
    v_mov_b32 v2, s44
    v_mov_b32 v3, 0
    ds_write_b32 v3, v2
    s_mov_b64 exec, -1
L_tk:
    s_waitcnt lgkmcnt(0)
    s_barrier
    v_mov_b32 v3, 0
    ds_read_b32 v2, v3
    s_waitcnt lgkmcnt(0)
    v_readfirstlane_b32 s44, v2
    s_barrier
    s_and_b32 s33, s44, 31
    s_bfe_u32 s32, s44, 0x30008
    s_lshr_b32 s38, s44, 16
    s_branch L_disp
L_R:
    s_mov_b32 s28, s90
    s_mov_b32 s29, s91
    s_mov_b32 s30, 5242880
    s_mov_b32 s31, 0x20000
    s_mov_b32 s16, s70
    s_mov_b32 s17, s71
    s_mov_b32 s18, 10240
    s_mov_b32 s19, 0x20000
    s_sub_u32 s36, s33, 16
    v_lshlrev_b32 v12, 4, v1
    v_lshlrev_b32 v13, 2, v1
    s_mul_i32 s61, s32, 40960
    s_lshl_b32 s44, s36, 10
    s_add_u32 s61, s61, s44
    s_lshl_b32 s44, s34, 1
    s_xor_b32 s44, s44, s41
    s_and_b32 s44, s44, 2
    s_lshr_b32 s45, s34, 1
    s_add_u32 s44, s44, s45
    s_lshl_b32 s45, s44, 8
    s_add_u32 s61, s61, s45
    s_add_u32 s61, s61, 14680064
    v_mov_b32 v20, -1
    s_lshl_b32 s63, s41, 14
    s_lshl_b32 s45, s36, 9
    s_add_u32 s63, s63, s45
    s_lshl_b32 s45, s34, 7
    s_add_u32 s63, s63, s45
    s_add_u32 s63, s63, 1835008
    v_lshrrev_b32 v2, 3, v1
    v_mul_u32_u24 v2, 1280, v2
    v_and_b32 v3, 3, v1
    v_lshl_add_u32 v2, v3, 3, v2
    v_bfe_u32 v3, v1, 2, 1
    v_lshl_add_u32 v2, v3, 2, v2
    s_lshl_b32 s45, s36, 7
    s_lshl_b32 s44, s44, 5
    s_add_u32 s45, s45, s44
    buffer_load_dword v21, v2, s[16:19], s45 offen
    v_and_b32 v2, 15, v1
    v_lshrrev_b32 v3, 4, v1
    v_and_b32 v4, 1, v1
    v_cmp_eq_u32 vcc, 0, v4
    v_mov_b32 v4, 0xeeee
    v_mov_b32 v5, 0x4444
    v_cndmask_b32 v9, v4, v5, vcc
    v_lshrrev_b32 v4, 5, v1
    v_mul_u32_u24 v4, 640, v4
    v_and_b32 v5, 31, v1
    v_lshl_add_u32 v14, v5, 4, v4
    v_mul_u32_u24 v4, 1280, v3
    v_lshl_add_u32 v15, v2, 3, v4
    v_mul_u32_u24 v4, 2560, v3
    v_lshl_add_u32 v16, v2, 4, v4
    v_lshlrev_b32 v17, 7, v1
    s_lshl_b32 s44, s34, 11
    v_add_u32 v18, s44, v12
    v_lshlrev_b32 v4, 6, v3
    v_and_b32 v5, 1, v1
    v_lshl_add_u32 v6, v5, 8, v4
    v_lshrrev_b32 v5, 1, v2
    v_lshl_add_u32 v6, v5, 3, v6
    v_add_u32 v6, s44, v6
    v_and_b32 v5, 3, v1
    v_lshl_add_u32 v4, v5, 4, v4
    v_bfe_u32 v5, v1, 2, 1
    v_lshl_add_u32 v4, v5, 3, v4
    v_bfe_u32 v5, v1, 3, 1
    v_lshl_add_u32 v4, v5, 2, v4
    s_lshl_b32 s44, s34, 9
    v_add_u32 v19, s44, v4
    v_mul_u32_u24 v4, 2560, v2
    v_lshl_add_u32 v22, v3, 3, v4
    s_xor_b32 s44, s40, 1
    s_lshl_b32 s44, s44, 5
    s_lshl_b32 s45, s34, 3
    s_add_u32 s44, s44, s45
    s_lshl_b32 s60, s44, 7
    s_add_u32 s60, s60, 15007744
    s_lshl_b32 s59, s44, 8
    s_add_u32 s59, s59, 15015936
    s_and_b32 s44, s41, 1
    s_lshl_b32 s44, s44, 7
    s_add_u32 s59, s59, s44
    v_lshlrev_b32 v7, 8, v1
    s_xor_b32 s44, s41, 0
    s_and_b32 s44, s44, 2
    s_add_u32 s44, s44, 0
    s_lshl_b32 s45, s36, 2
    s_add_u32 s64, s44, s45
    s_xor_b32 s44, s41, 2
    s_and_b32 s44, s44, 2
    s_add_u32 s44, s44, 0
    s_lshl_b32 s45, s36, 2
    s_add_u32 s65, s44, s45
    s_xor_b32 s44, s41, 4
    s_and_b32 s44, s44, 2
    s_add_u32 s44, s44, 1
    s_lshl_b32 s45, s36, 2
    s_add_u32 s66, s44, s45
    s_xor_b32 s44, s41, 6
    s_and_b32 s44, s44, 2
    s_add_u32 s44, s44, 1
    s_lshl_b32 s45, s36, 2
    s_add_u32 s67, s44, s45
    v_mov_b32 v40, 0
    v_mov_b32 v240, 0
    v_mov_b32 v41, 0
    v_mov_b32 v241, 0
    v_mov_b32 v42, 0
    v_mov_b32 v242, 0
    v_mov_b32 v43, 0
    v_mov_b32 v243, 0
    v_mov_b32 v44, 0
    v_mov_b32 v244, 0
    v_mov_b32 v45, 0
    v_mov_b32 v245, 0
    v_mov_b32 v46, 0
    v_mov_b32 v246, 0
    v_mov_b32 v47, 0
    v_mov_b32 v247, 0
    s_mov_b32 s42, 0
    v_mov_b32 v3, 128
WST_7:
    buffer_load_dwordx2 v[4:5], v3, s[12:15], 0 offen sc1
    s_waitcnt vmcnt(0)
    v_readfirstlane_b32 s44, v4
    v_readfirstlane_b32 s39, v5
    s_cmp_lg_u32 s44, 0
    s_cbranch_scc1 WSO_8
    s_sleep 4
    s_add_u32 s42, s42, 1
    s_cmp_lt_u32 s42, s37
    s_cbranch_scc1 WST_7
    s_mov_b32 s37, 1
WSO_8:
    s_cmp_lg_u32 s100, 0
    s_cbranch_scc1 WSE_10
    s_cmp_eq_u32 s44, 2
    s_cbranch_scc1 L_fallback
WSE_10:
    s_mul_i32 s44, s40, 0x11111111
    s_xor_b32 s39, s39, s44
    s_lshr_b32 s43, s63, 19
    s_and_b32 s43, s43, 28
    s_lshr_b32 s43, s39, s43
    s_and_b32 s43, s43, 1
    s_lshl_b32 s43, s43, 13
    s_add_u32 s63, s63, s43
    s_add_u32 s91, s63, 65536
    s_lshl_b32 s62, s32, 12
    s_lshl_b32 s44, s36, 2
    s_add_u32 s44, s44, s34
    s_lshl_b32 s44, s44, 2
    s_add_u32 s62, s62, s44
    s_add_u32 s62, s62, 15040512
    s_mov_b32 s44, 0xffff
    s_cmp_lg_u32 s38, 0
    s_cselect_b32 s92, s44, 0
    s_cselect_b32 s94, 0, s44
    s_mov_b32 s93, 0
    s_mov_b32 s95, 0
    s_mov_b32 s35, s40
    s_cmp_lg_u32 s40, 0
    s_cbranch_scc1 L_R_pre
    v_min_u32 v21, -2, v21
    buffer_store_dword v21, v13, s[8:11], s61 offen sc1
    v_mov_b32 v8, 1
    s_mov_b64 exec, 0xffff
    buffer_store_dword v8, v7, s[8:11], s62 offen sc1
    s_mov_b64 exec, -1
    s_mov_b32 s35, 2
L_R_pre:
    s_sub_u32 s58, s35, 1
    s_mov_b32 s42, 0
    s_mov_b64 exec, 0xff
WF_11:
    buffer_load_dword v2, v17, s[8:11], s60 offen sc1
    s_waitcnt vmcnt(0)
    v_cmp_gt_u32 vcc, s35, v2
    s_cbranch_vccz WFO_12
    s_sleep 1
    s_add_u32 s42, s42, 1
    s_cmp_lt_u32 s42, s37
    s_cbranch_scc1 WF_11
    s_mov_b32 s37, 1
WFO_12:
    s_mov_b64 exec, -1
    s_lshr_b32 s48, s58, 1
    s_and_b32 s48, s48, 3
    s_mul_i32 s48, s48, 160
    s_add_u32 s48, s48, s34
    s_lshl_b32 s48, s48, 14
    s_add_u32 s48, s48, 4194304
    s_lshl_b32 s84, s64, 16
    s_add_u32 s84, s84, s48
    s_lshr_b32 s43, s84, 19
    s_and_b32 s43, s43, 28
    s_lshr_b32 s43, s39, s43
    s_and_b32 s43, s43, 1
    s_lshl_b32 s43, s43, 13
    s_add_u32 s84, s84, s43
    s_lshl_b32 s85, s65, 16
    s_add_u32 s85, s85, s48
    s_lshr_b32 s43, s85, 19
    s_and_b32 s43, s43, 28
    s_lshr_b32 s43, s39, s43
    s_and_b32 s43, s43, 1
    s_lshl_b32 s43, s43, 13
    s_add_u32 s85, s85, s43
    s_lshl_b32 s86, s66, 16
    s_add_u32 s86, s86, s48
    s_lshr_b32 s43, s86, 19
    s_and_b32 s43, s43, 28
    s_lshr_b32 s43, s39, s43
    s_and_b32 s43, s43, 1
    s_lshl_b32 s43, s43, 13
    s_add_u32 s86, s86, s43
    s_lshl_b32 s87, s67, 16
    s_add_u32 s87, s87, s48
    s_lshr_b32 s43, s87, 19
    s_and_b32 s43, s43, 28
    s_lshr_b32 s43, s39, s43
    s_and_b32 s43, s43, 1
    s_lshl_b32 s43, s43, 13
    s_add_u32 s87, s87, s43
    s_add_u32 s45, s84, 4096
    buffer_load_dwordx4 v[80:83], v12, s[8:11], s84 offen offset:0 sc1
    buffer_load_dwordx4 v[84:87], v12, s[8:11], s84 offen offset:1024 sc1
    buffer_load_dwordx4 v[88:91], v12, s[8:11], s84 offen offset:2048 sc1
    buffer_load_dwordx4 v[92:95], v12, s[8:11], s84 offen offset:3072 sc1
    buffer_load_dwordx4 v[96:99], v12, s[8:11], s45 offen offset:0 sc1
    buffer_load_dwordx4 v[100:103], v12, s[8:11], s45 offen offset:1024 sc1
    buffer_load_dwordx4 v[104:107], v12, s[8:11], s45 offen offset:2048 sc1
    buffer_load_dwordx4 v[108:111], v12, s[8:11], s45 offen offset:3072 sc1
    s_add_u32 s45, s85, 4096
    buffer_load_dwordx4 v[112:115], v12, s[8:11], s85 offen offset:0 sc1
    buffer_load_dwordx4 v[116:119], v12, s[8:11], s85 offen offset:1024 sc1
    buffer_load_dwordx4 v[120:123], v12, s[8:11], s85 offen offset:2048 sc1
    buffer_load_dwordx4 v[124:127], v12, s[8:11], s85 offen offset:3072 sc1
    buffer_load_dwordx4 v[128:131], v12, s[8:11], s45 offen offset:0 sc1
    buffer_load_dwordx4 v[132:135], v12, s[8:11], s45 offen offset:1024 sc1
    buffer_load_dwordx4 v[136:139], v12, s[8:11], s45 offen offset:2048 sc1
    buffer_load_dwordx4 v[140:143], v12, s[8:11], s45 offen offset:3072 sc1
    s_add_u32 s45, s86, 4096
    buffer_load_dwordx4 v[144:147], v12, s[8:11], s86 offen offset:0 sc1
    buffer_load_dwordx4 v[148:151], v12, s[8:11], s86 offen offset:1024 sc1
    buffer_load_dwordx4 v[152:155], v12, s[8:11], s86 offen offset:2048 sc1
    buffer_load_dwordx4 v[156:159], v12, s[8:11], s86 offen offset:3072 sc1
    buffer_load_dwordx4 v[160:163], v12, s[8:11], s45 offen offset:0 sc1
    buffer_load_dwordx4 v[164:167], v12, s[8:11], s45 offen offset:1024 sc1
    buffer_load_dwordx4 v[168:171], v12, s[8:11], s45 offen offset:2048 sc1
    buffer_load_dwordx4 v[172:175], v12, s[8:11], s45 offen offset:3072 sc1
    s_add_u32 s45, s87, 4096
    buffer_load_dwordx4 v[176:179], v12, s[8:11], s87 offen offset:0 sc1
    buffer_load_dwordx4 v[180:183], v12, s[8:11], s87 offen offset:1024 sc1
    buffer_load_dwordx4 v[184:187], v12, s[8:11], s87 offen offset:2048 sc1
    buffer_load_dwordx4 v[188:191], v12, s[8:11], s87 offen offset:3072 sc1
    buffer_load_dwordx4 v[192:195], v12, s[8:11], s45 offen offset:0 sc1
    buffer_load_dwordx4 v[196:199], v12, s[8:11], s45 offen offset:1024 sc1
    buffer_load_dwordx4 v[200:203], v12, s[8:11], s45 offen offset:2048 sc1
    buffer_load_dwordx4 v[204:207], v12, s[8:11], s45 offen offset:3072 sc1
L_R_loop:
    s_sub_u32 s56, s35, 1
    s_lshr_b32 s43, s56, 1
    s_add_u32 s43, s43, 0
    s_bfe_u32 s50, s43, 0x10001
    s_lshl_b32 s50, s50, 21
    s_and_b32 s43, s43, 1
    s_mul_i32 s43, s43, 655360
    s_add_u32 s50, s50, s43
    s_lshl_b32 s45, s34, 11
    s_add_u32 s50, s50, s45
    s_lshr_b32 s43, s50, 19
    s_and_b32 s43, s43, 28
    s_lshr_b32 s43, s39, s43
    s_and_b32 s43, s43, 1
    s_lshl_b32 s43, s43, 13
    s_add_u32 s50, s50, s43
    s_lshl_b32 s44, s64, 14
    s_add_u32 s52, s50, s44
    s_lshl_b32 s44, s65, 14
    s_add_u32 s53, s50, s44
    s_lshl_b32 s44, s66, 14
    s_add_u32 s54, s50, s44
    s_lshl_b32 s44, s67, 14
    s_add_u32 s55, s50, s44
    s_mov_b32 s42, 0
    v_mov_b32 v208, 0
    v_mov_b32 v209, 0
    v_mov_b32 v210, 0
    v_mov_b32 v211, 0
    s_mov_b64 exec, 1
    buffer_atomic_umax v240, v13, s[8:11], s63 offen sc0
    buffer_atomic_umax v240, v13, s[8:11], s63 offen sc0
    buffer_atomic_umax v240, v13, s[8:11], s63 offen sc0
AP_13:
    s_waitcnt vmcnt(2)
    v_cmp_gt_u32 vcc, s35, v240
    s_cbranch_vccz APO_14
    buffer_atomic_umax v240, v13, s[8:11], s63 offen sc0
    s_sleep 2
    s_add_u32 s42, s42, 1
    s_cmp_lt_u32 s42, s37
    s_cbranch_scc1 AP_13
    s_mov_b32 s37, 1
APO_14:
    s_mov_b64 exec, -1
    buffer_load_dwordx4 v[48:51], v12, s[8:11], s52 offen offset:0 sc1
    buffer_load_dwordx4 v[52:55], v12, s[8:11], s52 offen offset:1024 sc1
    buffer_load_dwordx4 v[56:59], v12, s[8:11], s53 offen offset:0 sc1
    buffer_load_dwordx4 v[60:63], v12, s[8:11], s53 offen offset:1024 sc1
    v_mov_b32 v212, 0
    v_mov_b32 v213, 0
    v_mov_b32 v214, 0
    v_mov_b32 v215, 0
    v_mov_b32 v216, 0
    v_mov_b32 v217, 0
    v_mov_b32 v218, 0
    v_mov_b32 v219, 0
    v_mov_b32 v220, 0
    v_mov_b32 v221, 0
    v_mov_b32 v222, 0
    v_mov_b32 v223, 0
    s_lshr_b32 s44, s35, 1
    s_and_b32 s45, s44, 3
    s_mul_i32 s46, s45, 10240
    s_add_u32 s46, s46, s61
    s_add_u32 s44, s44, 3
    s_and_b32 s44, s44, 3
    s_mul_i32 s47, s44, 10240
    s_add_u32 s47, s47, s61
    s_add_u32 s58, s35, 1
    s_add_u32 s57, s35, 2
    s_lshr_b32 s48, s58, 1
    s_and_b32 s48, s48, 3
    s_mul_i32 s48, s48, 160
    s_add_u32 s48, s48, s34
    s_lshl_b32 s48, s48, 14
    s_add_u32 s48, s48, 4194304
    s_lshl_b32 s84, s64, 16
    s_add_u32 s84, s84, s48
    s_lshr_b32 s43, s84, 19
    s_and_b32 s43, s43, 28
    s_lshr_b32 s43, s39, s43
    s_and_b32 s43, s43, 1
    s_lshl_b32 s43, s43, 13
    s_add_u32 s84, s84, s43
    s_lshl_b32 s85, s65, 16
    s_add_u32 s85, s85, s48
    s_lshr_b32 s43, s85, 19
    s_and_b32 s43, s43, 28
    s_lshr_b32 s43, s39, s43
    s_and_b32 s43, s43, 1
    s_lshl_b32 s43, s43, 13
    s_add_u32 s85, s85, s43
    s_lshl_b32 s86, s66, 16
    s_add_u32 s86, s86, s48
    s_lshr_b32 s43, s86, 19
    s_and_b32 s43, s43, 28
    s_lshr_b32 s43, s39, s43
    s_and_b32 s43, s43, 1
    s_lshl_b32 s43, s43, 13
    s_add_u32 s86, s86, s43
    s_lshl_b32 s87, s67, 16
    s_add_u32 s87, s87, s48
    s_lshr_b32 s43, s87, 19
    s_and_b32 s43, s43, 28
    s_lshr_b32 s43, s39, s43
    s_and_b32 s43, s43, 1
    s_lshl_b32 s43, s43, 13
    s_add_u32 s87, s87, s43
    s_and_b32 s44, s56, 3
    s_lshl_b32 s44, s44, 5
    s_lshl_b32 s45, s34, 3
    s_add_u32 s44, s44, s45
    s_mul_i32 s88, s44, 2560
    s_add_u32 s88, s88, 15728640
    s_and_b32 s44, s41, 1
    s_lshl_b32 s89, s44, 8
    s_add_u32 s89, s89, s88
    s_lshl_b32 s45, s44, 10
    s_add_u32 s88, s88, s45
    s_lshl_b32 s90, s56, 1
    s_add_u32 s90, s90, s44
    s_mul_i32 s90, s90, 40960
    s_add_u32 s45, s64, s34
    s_lshl_b32 s45, s45, 5
    s_add_u32 s90, s90, s45
    s_lshr_b32 s43, s56, 1
    s_add_u32 s43, s43, 0
    s_bfe_u32 s51, s43, 0x10001
    s_lshl_b32 s51, s51, 21
    s_and_b32 s43, s43, 1
    s_mul_i32 s43, s43, 262144
    s_add_u32 s51, s51, s43
    s_lshl_b32 s45, s41, 2
    s_add_u32 s45, s45, s34
    s_add_u32 s45, s45, 80
    s_lshl_b32 s45, s45, 14
    s_add_u32 s51, s51, s45
    s_lshr_b32 s43, s51, 19
    s_and_b32 s43, s43, 28
    s_lshr_b32 s43, s39, s43
    s_and_b32 s43, s43, 1
    s_lshl_b32 s43, s43, 13
    s_add_u32 s51, s51, s43
    buffer_load_dwordx4 v[24:27], v14, s[8:11], s51 offen offset:0 sc1
    buffer_load_dwordx4 v[28:31], v14, s[8:11], s51 offen offset:1280 sc1
    buffer_load_dwordx2 v[40:41], v15, s[8:11], s51 offen offset:512 sc1
    buffer_load_dwordx2 v[42:43], v15, s[8:11], s51 offen offset:1152 sc1
    buffer_load_dwordx4 v[32:35], v14, s[8:11], s51 offen offset:2560 sc1
    buffer_load_dwordx4 v[36:39], v14, s[8:11], s51 offen offset:3840 sc1
    buffer_load_dwordx4 v[64:67], v12, s[8:11], s54 offen offset:0 sc1
    buffer_load_dwordx4 v[68:71], v12, s[8:11], s54 offen offset:1024 sc1
    buffer_load_dwordx4 v[72:75], v12, s[8:11], s55 offen offset:0 sc1
    buffer_load_dwordx4 v[76:79], v12, s[8:11], s55 offen offset:1024 sc1
    s_mov_b32 s42, 0
L_R_go:
    s_waitcnt vmcnt(12)
    v_max3_u32 v2, v48, v49, v50
    v_max3_u32 v2, v2, v51, v52
    v_max3_u32 v2, v2, v53, v54
    s_waitcnt vmcnt(10)
    v_max3_u32 v2, v2, v55, v56
    v_max3_u32 v2, v2, v57, v58
    v_max3_u32 v2, v2, v59, v60
    v_max3_u32 v2, v2, v61, v62
    s_waitcnt vmcnt(9)
    v_smfmac_f32_16x16x64_bf16 v[208:211], v[24:27], v[80:87], v9
    v_max3_u32 v2, v2, v63, v24
    v_smfmac_f32_16x16x64_bf16 v[212:215], v[24:27], v[112:119], v9
    v_max3_u32 v2, v2, v25, v26
    v_smfmac_f32_16x16x64_bf16 v[216:219], v[24:27], v[144:151], v9
    v_smfmac_f32_16x16x64_bf16 v[220:223], v[24:27], v[176:183], v9
    s_waitcnt vmcnt(8)
    v_smfmac_f32_16x16x64_bf16 v[208:211], v[28:31], v[88:95], v9
    v_max3_u32 v2, v2, v27, v28
    v_smfmac_f32_16x16x64_bf16 v[212:215], v[28:31], v[120:127], v9
    v_max3_u32 v2, v2, v29, v30
    v_smfmac_f32_16x16x64_bf16 v[216:219], v[28:31], v[152:159], v9
    v_smfmac_f32_16x16x64_bf16 v[220:223], v[28:31], v[184:191], v9
    s_waitcnt vmcnt(6)
    v_smfmac_f32_16x16x64_bf16 v[208:211], v[40:43], v[48:55], v9
    v_max3_u32 v2, v2, v31, v40
    v_smfmac_f32_16x16x64_bf16 v[212:215], v[40:43], v[56:63], v9
    v_max3_u32 v2, v2, v41, v42
    s_waitcnt vmcnt(5)
    v_smfmac_f32_16x16x64_bf16 v[208:211], v[32:35], v[96:103], v9
    v_max3_u32 v2, v2, v43, v32
    v_smfmac_f32_16x16x64_bf16 v[212:215], v[32:35], v[128:135], v9
    v_max3_u32 v2, v2, v33, v34
    v_smfmac_f32_16x16x64_bf16 v[216:219], v[32:35], v[160:167], v9
    v_smfmac_f32_16x16x64_bf16 v[220:223], v[32:35], v[192:199], v9
    s_waitcnt vmcnt(4)
    v_smfmac_f32_16x16x64_bf16 v[208:211], v[36:39], v[104:111], v9
    v_max3_u32 v2, v2, v35, v36
    v_smfmac_f32_16x16x64_bf16 v[212:215], v[36:39], v[136:143], v9
    v_max3_u32 v2, v2, v37, v38
    v_smfmac_f32_16x16x64_bf16 v[216:219], v[36:39], v[168:175], v9
    v_smfmac_f32_16x16x64_bf16 v[220:223], v[36:39], v[200:207], v9
    s_waitcnt vmcnt(2)
    v_smfmac_f32_16x16x64_bf16 v[216:219], v[40:43], v[64:71], v9
    v_max3_u32 v2, v2, v39, v64
    v_add_f32 v224, v208, v209
    v_add_f32 v225, v210, v211
    ds_write_b64 v6, v[224:225] offset:0
    s_waitcnt vmcnt(0)
    v_smfmac_f32_16x16x64_bf16 v[220:223], v[40:43], v[72:79], v9
    v_add_f32 v226, v212, v213
    v_add_f32 v227, v214, v215
    ds_write_b64 v6, v[226:227] offset:512
    v_add_f32 v228, v216, v217
    v_add_f32 v229, v218, v219
    ds_write_b64 v6, v[228:229] offset:1024
    v_max3_u32 v2, v2, v65, v66
    v_max3_u32 v2, v2, v67, v68
    v_add_f32 v230, v220, v221
    v_add_f32 v231, v222, v223
    ds_write_b64 v6, v[230:231] offset:1536
    v_max3_u32 v2, v2, v69, v70
    v_max3_u32 v2, v2, v71, v72
    v_max3_u32 v2, v2, v73, v74
    v_max3_u32 v2, v2, v75, v76
    v_max3_u32 v2, v2, v77, v78
    v_max_u32 v2, v2, v79
    v_cmp_eq_u32 vcc, -1, v2
    s_cbranch_vccnz L_R_cold
L_R_ok:
    s_cmp_eq_u32 s38, 0
    s_waitcnt lgkmcnt(0)
    s_barrier
    ds_read2st64_b32 v[208:209], v19 offset0:0 offset1:1
    ds_read2st64_b32 v[210:211], v19 offset0:8 offset1:9
    ds_read2st64_b32 v[212:213], v19 offset0:16 offset1:17
    ds_read2st64_b32 v[214:215], v19 offset0:24 offset1:25
    s_waitcnt lgkmcnt(2)
    v_pk_add_f32 v[208:209], v[208:209], v[210:211]
    s_waitcnt lgkmcnt(1)
    v_pk_add_f32 v[208:209], v[208:209], v[212:213]
    s_waitcnt lgkmcnt(0)
    v_pk_add_f32 v[208:209], v[208:209], v[214:215]
    v_cvt_pk_bf16_f32 v2, v208, v209
    s_cbranch_scc1 L_R_slow
    buffer_store_dword v2, v13, s[8:11], s46 offen
    buffer_store_dword v20, v13, s[8:11], s47 offen
    s_branch L_R_x
L_R_slow:
    buffer_store_dword v2, v13, s[8:11], s46 offen sc1
    buffer_store_dword v20, v13, s[8:11], s47 offen sc1
L_R_x:
    s_cmp_ge_u32 s58, 64
    s_cbranch_scc1 L_R_nou
    s_cmp_ge_u32 s35, 99
    s_cbranch_scc1 L_R_nof
    s_mov_b32 s42, 0
    s_mov_b64 exec, 0xff
WF_15:
    buffer_load_dword v2, v17, s[8:11], s60 offen sc1
    s_waitcnt vmcnt(0)
    v_cmp_gt_u32 vcc, s57, v2
    s_cbranch_vccz WFO_16
    s_sleep 1
    s_add_u32 s42, s42, 1
    s_cmp_lt_u32 s42, s37
    s_cbranch_scc1 WF_15
    s_mov_b32 s37, 1
WFO_16:
    s_mov_b64 exec, -1
L_R_nof:
    s_add_u32 s45, s85, 4096
    buffer_load_dwordx4 v[112:115], v12, s[8:11], s85 offen offset:0 sc1
    buffer_load_dwordx4 v[116:119], v12, s[8:11], s85 offen offset:1024 sc1
    buffer_load_dwordx4 v[120:123], v12, s[8:11], s85 offen offset:2048 sc1
    buffer_load_dwordx4 v[124:127], v12, s[8:11], s85 offen offset:3072 sc1
    buffer_load_dwordx4 v[128:131], v12, s[8:11], s45 offen offset:0 sc1
    buffer_load_dwordx4 v[132:135], v12, s[8:11], s45 offen offset:1024 sc1
    buffer_load_dwordx4 v[136:139], v12, s[8:11], s45 offen offset:2048 sc1
    buffer_load_dwordx4 v[140:143], v12, s[8:11], s45 offen offset:3072 sc1
    s_add_u32 s45, s87, 4096
    buffer_load_dwordx4 v[176:179], v12, s[8:11], s87 offen offset:0 sc1
    buffer_load_dwordx4 v[180:183], v12, s[8:11], s87 offen offset:1024 sc1
    buffer_load_dwordx4 v[184:187], v12, s[8:11], s87 offen offset:2048 sc1
    buffer_load_dwordx4 v[188:191], v12, s[8:11], s87 offen offset:3072 sc1
    buffer_load_dwordx4 v[192:195], v12, s[8:11], s45 offen offset:0 sc1
    buffer_load_dwordx4 v[196:199], v12, s[8:11], s45 offen offset:1024 sc1
    buffer_load_dwordx4 v[200:203], v12, s[8:11], s45 offen offset:2048 sc1
    buffer_load_dwordx4 v[204:207], v12, s[8:11], s45 offen offset:3072 sc1
L_R_nou:
    s_mov_b32 s42, 0
    s_mov_b64 exec, 0xff
WF_17:
    buffer_load_dword v2, v7, s[8:11], s59 offen sc1
    s_waitcnt vmcnt(0)
    v_cmp_gt_u32 vcc, s35, v2
    s_cbranch_vccz WFO_18
    s_sleep 1
    s_add_u32 s42, s42, 1
    s_cmp_lt_u32 s42, s37
    s_cbranch_scc1 WF_17
    s_mov_b32 s37, 1
WFO_18:
    s_mov_b64 exec, -1
    s_add_u32 s44, s88, 0
    buffer_load_dwordx4 a[0:3], v12, s[8:11], s44 offen sc1
    s_add_u32 s44, s88, 2560
    buffer_load_dwordx4 a[4:7], v12, s[8:11], s44 offen sc1
    s_add_u32 s44, s88, 5120
    buffer_load_dwordx4 a[8:11], v12, s[8:11], s44 offen sc1
    s_add_u32 s44, s88, 7680
    buffer_load_dwordx4 a[12:15], v12, s[8:11], s44 offen sc1
    s_add_u32 s44, s88, 10240
    buffer_load_dwordx4 a[16:19], v12, s[8:11], s44 offen sc1
    s_add_u32 s44, s88, 12800
    buffer_load_dwordx4 a[20:23], v12, s[8:11], s44 offen sc1
    s_add_u32 s44, s88, 15360
    buffer_load_dwordx4 a[24:27], v12, s[8:11], s44 offen sc1
    s_add_u32 s44, s88, 17920
    buffer_load_dwordx4 a[28:31], v12, s[8:11], s44 offen sc1
    s_add_u32 s44, s89, 0
    buffer_load_dwordx4 a[32:35], v16, s[8:11], s44 offen offset:2048 sc1
    s_add_u32 s44, s89, 10240
    buffer_load_dwordx4 a[36:39], v16, s[8:11], s44 offen offset:2048 sc1
    s_waitcnt vmcnt(9)
    v_mfma_f32_16x16x32_bf16 v[224:227], v[80:83], a[0:3], 0
    v_mfma_f32_16x16x32_bf16 v[228:231], v[144:147], a[0:3], 0
    s_waitcnt vmcnt(8)
    v_mfma_f32_16x16x32_bf16 v[224:227], v[84:87], a[4:7], v[224:227]
    v_mfma_f32_16x16x32_bf16 v[228:231], v[148:151], a[4:7], v[228:231]
    s_waitcnt vmcnt(7)
    v_mfma_f32_16x16x32_bf16 v[224:227], v[88:91], a[8:11], v[224:227]
    v_mfma_f32_16x16x32_bf16 v[228:231], v[152:155], a[8:11], v[228:231]
    s_waitcnt vmcnt(6)
    v_mfma_f32_16x16x32_bf16 v[224:227], v[92:95], a[12:15], v[224:227]
    v_mfma_f32_16x16x32_bf16 v[228:231], v[156:159], a[12:15], v[228:231]
    s_waitcnt vmcnt(5)
    v_mfma_f32_16x16x32_bf16 v[224:227], v[96:99], a[16:19], v[224:227]
    v_mfma_f32_16x16x32_bf16 v[228:231], v[160:163], a[16:19], v[228:231]
    s_waitcnt vmcnt(4)
    v_mfma_f32_16x16x32_bf16 v[224:227], v[100:103], a[20:23], v[224:227]
    v_mfma_f32_16x16x32_bf16 v[228:231], v[164:167], a[20:23], v[228:231]
    s_waitcnt vmcnt(3)
    v_mfma_f32_16x16x32_bf16 v[224:227], v[104:107], a[24:27], v[224:227]
    v_mfma_f32_16x16x32_bf16 v[228:231], v[168:171], a[24:27], v[228:231]
    s_waitcnt vmcnt(2)
    v_mfma_f32_16x16x32_bf16 v[224:227], v[108:111], a[28:31], v[224:227]
    v_mfma_f32_16x16x32_bf16 v[228:231], v[172:175], a[28:31], v[228:231]
    s_waitcnt vmcnt(1)
    v_mfma_f32_16x16x32_bf16 v[224:227], v[48:51], a[32:35], v[224:227]
    v_mfma_f32_16x16x32_bf16 v[228:231], v[64:67], a[32:35], v[228:231]
    s_waitcnt vmcnt(0)
    v_mfma_f32_16x16x32_bf16 v[224:227], v[52:55], a[36:39], v[224:227]
    v_mfma_f32_16x16x32_bf16 v[228:231], v[68:71], a[36:39], v[228:231]
    s_nop 6
    ds_write_b128 v18, v[224:227] offset:8192
    ds_write_b128 v18, v[228:231] offset:9216
    s_cmp_ge_u32 s58, 64
    s_cbranch_scc1 L_R_nou2
    s_add_u32 s45, s84, 4096
    buffer_load_dwordx4 v[80:83], v12, s[8:11], s84 offen offset:0 sc1
    buffer_load_dwordx4 v[84:87], v12, s[8:11], s84 offen offset:1024 sc1
    buffer_load_dwordx4 v[88:91], v12, s[8:11], s84 offen offset:2048 sc1
    buffer_load_dwordx4 v[92:95], v12, s[8:11], s84 offen offset:3072 sc1
    buffer_load_dwordx4 v[96:99], v12, s[8:11], s45 offen offset:0 sc1
    buffer_load_dwordx4 v[100:103], v12, s[8:11], s45 offen offset:1024 sc1
    buffer_load_dwordx4 v[104:107], v12, s[8:11], s45 offen offset:2048 sc1
    buffer_load_dwordx4 v[108:111], v12, s[8:11], s45 offen offset:3072 sc1
    s_add_u32 s45, s86, 4096
    buffer_load_dwordx4 v[144:147], v12, s[8:11], s86 offen offset:0 sc1
    buffer_load_dwordx4 v[148:151], v12, s[8:11], s86 offen offset:1024 sc1
    buffer_load_dwordx4 v[152:155], v12, s[8:11], s86 offen offset:2048 sc1
    buffer_load_dwordx4 v[156:159], v12, s[8:11], s86 offen offset:3072 sc1
    buffer_load_dwordx4 v[160:163], v12, s[8:11], s45 offen offset:0 sc1
    buffer_load_dwordx4 v[164:167], v12, s[8:11], s45 offen offset:1024 sc1
    buffer_load_dwordx4 v[168:171], v12, s[8:11], s45 offen offset:2048 sc1
    buffer_load_dwordx4 v[172:175], v12, s[8:11], s45 offen offset:3072 sc1
L_R_nou2:
    s_waitcnt lgkmcnt(0)
    s_barrier
    s_cmp_ge_u32 s34, 2
    s_cbranch_scc1 L_R_next
    s_lshl_b32 s44, s34, 10
    v_add_u32 v2, s44, v12
    ds_read_b128 v[224:227], v2 offset:8192
    ds_read_b128 v[228:231], v2 offset:10240
    ds_read_b128 v[232:235], v2 offset:12288
    ds_read_b128 v[236:239], v2 offset:14336
    s_waitcnt lgkmcnt(0)
    v_add_f32 v224, v224, v228
    v_add_f32 v232, v232, v236
    v_add_f32 v225, v225, v229
    v_add_f32 v233, v233, v237
    v_add_f32 v226, v226, v230
    v_add_f32 v234, v234, v238
    v_add_f32 v227, v227, v231
    v_add_f32 v235, v235, v239
    v_add_f32 v224, v224, v232
    v_add_f32 v225, v225, v233
    v_add_f32 v226, v226, v234
    v_add_f32 v227, v227, v235
    v_cvt_pk_bf16_f32 v4, v224, v225
    v_cvt_pk_bf16_f32 v5, v226, v227
    buffer_store_dwordx2 v[4:5], v22, s[28:31], s90 offen
L_R_next:
    s_add_u32 s35, s35, 2
    s_cmp_le_u32 s35, 64
    s_cbranch_scc1 L_R_loop
    s_endpgm
L_R_cold:
    s_add_u32 s42, s42, 1
    s_cmp_ge_u32 s42, s37
    s_cbranch_scc1 L_R_dead
    buffer_load_dwordx4 v[24:27], v14, s[8:11], s51 offen offset:0 sc1
    buffer_load_dwordx4 v[28:31], v14, s[8:11], s51 offen offset:1280 sc1
    buffer_load_dwordx4 v[32:35], v14, s[8:11], s51 offen offset:2560 sc1
    buffer_load_dwordx4 v[36:39], v14, s[8:11], s51 offen offset:3840 sc1
    buffer_load_dwordx2 v[40:41], v15, s[8:11], s51 offen offset:512 sc1
    buffer_load_dwordx2 v[42:43], v15, s[8:11], s51 offen offset:1152 sc1
    v_max3_u32 v2, v48, v49, v50
    v_max3_u32 v2, v2, v51, v52
    v_max3_u32 v2, v2, v53, v54
    v_max_u32 v2, v2, v55
    v_cmp_eq_u32 vcc, -1, v2
    s_cbranch_vccz RC_19
    buffer_load_dwordx4 v[48:51], v12, s[8:11], s52 offen offset:0 sc1
    buffer_load_dwordx4 v[52:55], v12, s[8:11], s52 offen offset:1024 sc1
RC_19:
    v_max3_u32 v2, v56, v57, v58
    v_max3_u32 v2, v2, v59, v60
    v_max3_u32 v2, v2, v61, v62
    v_max_u32 v2, v2, v63
    v_cmp_eq_u32 vcc, -1, v2
    s_cbranch_vccz RC_20
    buffer_load_dwordx4 v[56:59], v12, s[8:11], s53 offen offset:0 sc1
    buffer_load_dwordx4 v[60:63], v12, s[8:11], s53 offen offset:1024 sc1
RC_20:
    v_max3_u32 v2, v64, v65, v66
    v_max3_u32 v2, v2, v67, v68
    v_max3_u32 v2, v2, v69, v70
    v_max_u32 v2, v2, v71
    v_cmp_eq_u32 vcc, -1, v2
    s_cbranch_vccz RC_21
    buffer_load_dwordx4 v[64:67], v12, s[8:11], s54 offen offset:0 sc1
    buffer_load_dwordx4 v[68:71], v12, s[8:11], s54 offen offset:1024 sc1
RC_21:
    v_max3_u32 v2, v72, v73, v74
    v_max3_u32 v2, v2, v75, v76
    v_max3_u32 v2, v2, v77, v78
    v_max_u32 v2, v2, v79
    v_cmp_eq_u32 vcc, -1, v2
    s_cbranch_vccz RC_22
    buffer_load_dwordx4 v[72:75], v12, s[8:11], s55 offen offset:0 sc1
    buffer_load_dwordx4 v[76:79], v12, s[8:11], s55 offen offset:1024 sc1
RC_22:
    s_nop 7
    s_nop 3
    v_mov_b32 v208, 0
    v_mov_b32 v209, 0
    v_mov_b32 v210, 0
    v_mov_b32 v211, 0
    v_mov_b32 v212, 0
    v_mov_b32 v213, 0
    v_mov_b32 v214, 0
    v_mov_b32 v215, 0
    v_mov_b32 v216, 0
    v_mov_b32 v217, 0
    v_mov_b32 v218, 0
    v_mov_b32 v219, 0
    v_mov_b32 v220, 0
    v_mov_b32 v221, 0
    v_mov_b32 v222, 0
    v_mov_b32 v223, 0
    s_waitcnt vmcnt(0)
    s_branch L_R_go
L_R_dead:
    s_mov_b32 s37, 1
    s_branch L_R_ok
L_S:
    s_and_b32 s36, s33, 7
    s_lshl_b32 s44, s41, 3
    s_add_u32 s36, s36, s44
    v_lshlrev_b32 v12, 4, v1
    s_mul_i32 s44, s34, 28672
    v_add_u32 v10, s44, v12
    v_add_u32 v13, 114688, v12
    v_and_b32 v4, 1, v1
    v_cmp_eq_u32 vcc, 0, v4
    v_mov_b32 v4, 0xeeee
    v_mov_b32 v5, 0x4444
    v_cndmask_b32 v9, v4, v5, vcc
    s_mul_i32 s84, s34, 3
    s_min_u32 s84, s84, 8
    s_sub_u32 s44, s84, 10
    s_cmp_ge_u32 s34, 3
    s_cselect_b32 s85, s44, s84
    s_cmp_ge_u32 s34, 2
    s_cselect_b32 s86, s44, s84
    s_cmp_ge_u32 s34, 1
    s_cselect_b32 s87, s44, s84
    s_mov_b32 s24, s68
    s_mov_b32 s25, s69
    s_mov_b32 s26, 2621440
    s_mov_b32 s27, 0x20000
    v_lshrrev_b32 v2, 3, v1
    v_and_b32 v3, 7, v1
    v_xor_b32 v3, v3, v2
    s_lshl_b32 s44, s34, 3
    v_add_u32 v2, s44, v2
    v_mul_u32_u24 v11, 1280, v2
    v_lshl_add_u32 v11, v3, 4, v11
    v_and_b32 v2, 15, v1
    v_lshrrev_b32 v3, 4, v1
    v_and_b32 v4, 7, v1
    v_xor_b32 v3, v3, v4
    v_lshlrev_b32 v3, 4, v3
    v_lshl_add_u32 v0, v2, 7, v3
    v_xor_b32 v5, 64, v0
    v_add_u32 v0, 114688, v0
    v_add_u32 v5, 114688, v5
    s_lshl_b32 s44, s40, 5
    s_add_u32 s44, s44, s36
    s_lshl_b32 s44, s44, 1
    s_and_b32 s45, s34, 1
    s_add_u32 s44, s44, s45
    s_lshl_b32 s60, s44, 7
    s_add_u32 s60, s60, 15015936
    s_lshl_b32 s61, s34, 2
    s_add_u32 s61, s61, s41
    s_lshl_b32 s61, s61, 14
    s_and_b32 s44, s33, 7
    s_mul_i32 s44, s44, 640
    s_add_u32 s61, s61, s44
    s_add_u32 s61, s61, 1310720
    v_mov_b32 v20, -1
    v_mov_b32 v21, -1
    v_mov_b32 v22, -1
    v_mov_b32 v23, -1
    s_mov_b32 s16, s72
    s_mov_b32 s17, s73
    s_mov_b32 s18, 7864320
    s_mov_b32 s19, 0x20000
    s_mov_b32 s20, s74
    s_mov_b32 s21, s75
    s_mov_b32 s22, 7864320
    s_mov_b32 s23, 0x20000
    s_mul_i32 s50, s36, 384
    s_mul_i32 s44, s34, 196608
    s_add_u32 s50, s50, s44
    s_mul_i32 s51, s34, 6144
    v_add_u32 v2, 0, v1
    v_mul_u32_u24 v3, 2731, v2
    v_lshrrev_b32 v3, 16, v3
    v_mul_u32_u24 v4, 24, v3
    v_sub_u32 v4, v2, v4
    v_lshlrev_b32 v4, 4, v4
    v_and_b32 v5, 2, v3
    v_lshlrev_b32 v5, 4, v5
    v_xor_b32 v4, v4, v5
    v_mul_u32_u24 v3, 12288, v3
    v_add_u32 v136, v4, v3
    v_add_u32 v2, 64, v1
    v_mul_u32_u24 v3, 2731, v2
    v_lshrrev_b32 v3, 16, v3
    v_mul_u32_u24 v4, 24, v3
    v_sub_u32 v4, v2, v4
    v_lshlrev_b32 v4, 4, v4
    v_and_b32 v5, 2, v3
    v_lshlrev_b32 v5, 4, v5
    v_xor_b32 v4, v4, v5
    v_mul_u32_u24 v3, 12288, v3
    v_add_u32 v137, v4, v3
    v_add_u32 v2, 128, v1
    v_mul_u32_u24 v3, 2731, v2
    v_lshrrev_b32 v3, 16, v3
    v_mul_u32_u24 v4, 24, v3
    v_sub_u32 v4, v2, v4
    v_lshlrev_b32 v4, 4, v4
    v_and_b32 v5, 2, v3
    v_lshlrev_b32 v5, 4, v5
    v_xor_b32 v4, v4, v5
    v_mul_u32_u24 v3, 12288, v3
    v_add_u32 v138, v4, v3
    v_lshrrev_b32 v2, 4, v1
    v_bfe_u32 v3, v1, 2, 2
    v_lshl_add_u32 v2, v2, 3, v3
    v_mul_u32_u24 v2, 384, v2
    v_and_b32 v3, 3, v1
    v_lshl_add_u32 v2, v3, 3, v2
    v_and_b32 v3, 24, v1
    v_lshlrev_b32 v3, 2, v3
    s_mul_i32 s44, s34, 96
    v_xad_u32 v14, s44, v3, v2
    s_add_u32 s44, s44, 32
    v_xad_u32 v15, s44, v3, v2
    s_add_u32 s44, s44, 32
    v_xad_u32 v16, s44, v3, v2
    v_mul_u32_u24 v3, 21846, v1
    v_lshrrev_b32 v3, 16, v3
    v_mul_u32_u24 v4, 3, v3
    v_sub_u32 v4, v1, v4
    v_mul_u32_u24 v3, 12288, v3
    v_lshl_add_u32 v19, v4, 7, v3
    v_lshlrev_b32 v7, 7, v1
    s_add_u32 s44, s50, 0
    s_add_u32 m0, s51, 0
    s_nop 0
    buffer_load_dwordx4 v136, s[16:19], s44 offen  lds
    s_add_u32 m0, s51, 1024
    s_nop 0
    buffer_load_dwordx4 v137, s[16:19], s44 offen  lds
    s_add_u32 m0, s51, 2048
    s_nop 0
    buffer_load_dwordx4 v138, s[16:19], s44 offen  lds
    s_add_u32 s44, s50, 98304
    s_add_u32 m0, s51, 3072
    v_xor_b32 v2, 64, v136
    buffer_load_dwordx4 v2, s[16:19], s44 offen  lds
    s_add_u32 m0, s51, 4096
    v_xor_b32 v2, 64, v137
    buffer_load_dwordx4 v2, s[16:19], s44 offen  lds
    s_add_u32 m0, s51, 5120
    v_xor_b32 v2, 64, v138
    buffer_load_dwordx4 v2, s[16:19], s44 offen  lds
    s_add_u32 s44, s50, 0
    s_add_u32 m0, s51, 24576
    s_nop 0
    buffer_load_dwordx4 v136, s[20:23], s44 offen  lds
    s_add_u32 m0, s51, 25600
    s_nop 0
    buffer_load_dwordx4 v137, s[20:23], s44 offen  lds
    s_add_u32 m0, s51, 26624
    s_nop 0
    buffer_load_dwordx4 v138, s[20:23], s44 offen  lds
    s_add_u32 s44, s50, 98304
    s_add_u32 m0, s51, 27648
    v_xor_b32 v2, 64, v136
    buffer_load_dwordx4 v2, s[20:23], s44 offen  lds
    s_add_u32 m0, s51, 28672
    v_xor_b32 v2, 64, v137
    buffer_load_dwordx4 v2, s[20:23], s44 offen  lds
    s_add_u32 m0, s51, 29696
    v_xor_b32 v2, 64, v138
    buffer_load_dwordx4 v2, s[20:23], s44 offen  lds
    s_add_u32 s44, s50, 786432
    s_add_u32 m0, s51, 49152
    s_nop 0
    buffer_load_dwordx4 v136, s[16:19], s44 offen  lds
    s_add_u32 m0, s51, 50176
    s_nop 0
    buffer_load_dwordx4 v137, s[16:19], s44 offen  lds
    s_add_u32 m0, s51, 51200
    s_nop 0
    buffer_load_dwordx4 v138, s[16:19], s44 offen  lds
    s_add_u32 s44, s50, 884736
    s_add_u32 m0, s51, 52224
    v_xor_b32 v2, 64, v136
    buffer_load_dwordx4 v2, s[16:19], s44 offen  lds
    s_add_u32 m0, s51, 53248
    v_xor_b32 v2, 64, v137
    buffer_load_dwordx4 v2, s[16:19], s44 offen  lds
    s_add_u32 m0, s51, 54272
    v_xor_b32 v2, 64, v138
    buffer_load_dwordx4 v2, s[16:19], s44 offen  lds
    s_add_u32 s44, s50, 786432
    s_add_u32 m0, s51, 73728
    s_nop 0
    buffer_load_dwordx4 v136, s[20:23], s44 offen  lds
    s_add_u32 m0, s51, 74752
    s_nop 0
    buffer_load_dwordx4 v137, s[20:23], s44 offen  lds
    s_add_u32 m0, s51, 75776
    s_nop 0
    buffer_load_dwordx4 v138, s[20:23], s44 offen  lds
    s_add_u32 s44, s50, 884736
    s_add_u32 m0, s51, 76800
    v_xor_b32 v2, 64, v136
    buffer_load_dwordx4 v2, s[20:23], s44 offen  lds
    s_add_u32 m0, s51, 77824
    v_xor_b32 v2, 64, v137
    buffer_load_dwordx4 v2, s[20:23], s44 offen  lds
    s_add_u32 m0, s51, 78848
    v_xor_b32 v2, 64, v138
    buffer_load_dwordx4 v2, s[20:23], s44 offen  lds
    s_add_u32 s44, s50, 1572864
    s_add_u32 m0, s51, 98304
    s_nop 0
    buffer_load_dwordx4 v136, s[16:19], s44 offen  lds
    s_add_u32 m0, s51, 99328
    s_nop 0
    buffer_load_dwordx4 v137, s[16:19], s44 offen  lds
    s_add_u32 m0, s51, 100352
    s_nop 0
    buffer_load_dwordx4 v138, s[16:19], s44 offen  lds
    s_add_u32 s44, s50, 1671168
    s_add_u32 m0, s51, 101376
    v_xor_b32 v2, 64, v136
    buffer_load_dwordx4 v2, s[16:19], s44 offen  lds
    s_add_u32 m0, s51, 102400
    v_xor_b32 v2, 64, v137
    buffer_load_dwordx4 v2, s[16:19], s44 offen  lds
    s_add_u32 m0, s51, 103424
    v_xor_b32 v2, 64, v138
    buffer_load_dwordx4 v2, s[16:19], s44 offen  lds
    s_add_u32 s44, s50, 1572864
    s_add_u32 m0, s51, 122880
    s_nop 0
    buffer_load_dwordx4 v136, s[20:23], s44 offen  lds
    s_add_u32 m0, s51, 123904
    s_nop 0
    buffer_load_dwordx4 v137, s[20:23], s44 offen  lds
    s_add_u32 m0, s51, 124928
    s_nop 0
    buffer_load_dwordx4 v138, s[20:23], s44 offen  lds
    s_add_u32 s44, s50, 1671168
    s_add_u32 m0, s51, 125952
    v_xor_b32 v2, 64, v136
    buffer_load_dwordx4 v2, s[20:23], s44 offen  lds
    s_add_u32 m0, s51, 126976
    v_xor_b32 v2, 64, v137
    buffer_load_dwordx4 v2, s[20:23], s44 offen  lds
    s_add_u32 m0, s51, 128000
    v_xor_b32 v2, 64, v138
    buffer_load_dwordx4 v2, s[20:23], s44 offen  lds
    s_waitcnt vmcnt(24)
    s_barrier
    s_cmp_eq_u32 s34, 1
    s_cbranch_scc1 PWW_25
    s_cmp_eq_u32 s34, 2
    s_cbranch_scc1 PWW_26
    s_cmp_eq_u32 s34, 3
    s_cbranch_scc1 PWW_27
    ds_read_b64_tr_b16 v[24:25], v14 offset:0
    ds_read_b64_tr_b16 v[26:27], v14 offset:1536
    ds_read_b64_tr_b16 v[28:29], v14 offset:12288
    ds_read_b64_tr_b16 v[30:31], v14 offset:13824
    ds_read_b64_tr_b16 v[32:33], v15 offset:0
    ds_read_b64_tr_b16 v[34:35], v15 offset:1536
    ds_read_b64_tr_b16 v[36:37], v15 offset:12288
    ds_read_b64_tr_b16 v[38:39], v15 offset:13824
    ds_read_b64_tr_b16 v[40:41], v16 offset:0
    ds_read_b64_tr_b16 v[42:43], v16 offset:1536
    ds_read_b64_tr_b16 v[44:45], v16 offset:12288
    ds_read_b64_tr_b16 v[46:47], v16 offset:13824
    ds_read_b64_tr_b16 v[48:49], v14 offset:24576
    ds_read_b64_tr_b16 v[50:51], v14 offset:26112
    ds_read_b64_tr_b16 v[52:53], v14 offset:36864
    ds_read_b64_tr_b16 v[54:55], v14 offset:38400
    ds_read_b64_tr_b16 v[56:57], v15 offset:24576
    ds_read_b64_tr_b16 v[58:59], v15 offset:26112
    ds_read_b64_tr_b16 v[60:61], v15 offset:36864
    ds_read_b64_tr_b16 v[62:63], v15 offset:38400
    ds_read_b64_tr_b16 v[64:65], v16 offset:24576
    ds_read_b64_tr_b16 v[66:67], v16 offset:26112
    ds_read_b64_tr_b16 v[68:69], v16 offset:36864
    ds_read_b64_tr_b16 v[70:71], v16 offset:38400
    s_branch PW_23
PWW_25:
    ds_read_b64_tr_b16 v[128:129], v14 offset:0
    ds_read_b64_tr_b16 v[130:131], v14 offset:1536
    ds_read_b64_tr_b16 v[132:133], v14 offset:12288
    ds_read_b64_tr_b16 v[134:135], v14 offset:13824
    ds_read_b64_tr_b16 a[232:233], v15 offset:0
    ds_read_b64_tr_b16 a[234:235], v15 offset:1536
    ds_read_b64_tr_b16 a[236:237], v15 offset:12288
    ds_read_b64_tr_b16 a[238:239], v15 offset:13824
    ds_read_b64_tr_b16 a[240:241], v16 offset:0
    ds_read_b64_tr_b16 a[242:243], v16 offset:1536
    ds_read_b64_tr_b16 a[244:245], v16 offset:12288
    ds_read_b64_tr_b16 a[246:247], v16 offset:13824
    ds_read_b64_tr_b16 a[248:249], v14 offset:24576
    ds_read_b64_tr_b16 a[250:251], v14 offset:26112
    ds_read_b64_tr_b16 a[252:253], v14 offset:36864
    ds_read_b64_tr_b16 a[254:255], v14 offset:38400
    ds_read_b64_tr_b16 v[144:145], v15 offset:24576
    ds_read_b64_tr_b16 v[146:147], v15 offset:26112
    ds_read_b64_tr_b16 v[148:149], v15 offset:36864
    ds_read_b64_tr_b16 v[150:151], v15 offset:38400
    ds_read_b64_tr_b16 v[152:153], v16 offset:24576
    ds_read_b64_tr_b16 v[154:155], v16 offset:26112
    ds_read_b64_tr_b16 v[156:157], v16 offset:36864
    ds_read_b64_tr_b16 v[158:159], v16 offset:38400
    s_branch PW_23
PWW_26:
    ds_read_b64_tr_b16 a[136:137], v14 offset:0
    ds_read_b64_tr_b16 a[138:139], v14 offset:1536
    ds_read_b64_tr_b16 a[140:141], v14 offset:12288
    ds_read_b64_tr_b16 a[142:143], v14 offset:13824
    ds_read_b64_tr_b16 a[144:145], v15 offset:0
    ds_read_b64_tr_b16 a[146:147], v15 offset:1536
    ds_read_b64_tr_b16 a[148:149], v15 offset:12288
    ds_read_b64_tr_b16 a[150:151], v15 offset:13824
    ds_read_b64_tr_b16 a[152:153], v16 offset:0
    ds_read_b64_tr_b16 a[154:155], v16 offset:1536
    ds_read_b64_tr_b16 a[156:157], v16 offset:12288
    ds_read_b64_tr_b16 a[158:159], v16 offset:13824
    ds_read_b64_tr_b16 a[160:161], v14 offset:24576
    ds_read_b64_tr_b16 a[162:163], v14 offset:26112
    ds_read_b64_tr_b16 a[164:165], v14 offset:36864
    ds_read_b64_tr_b16 a[166:167], v14 offset:38400
    ds_read_b64_tr_b16 a[168:169], v15 offset:24576
    ds_read_b64_tr_b16 a[170:171], v15 offset:26112
    ds_read_b64_tr_b16 a[172:173], v15 offset:36864
    ds_read_b64_tr_b16 a[174:175], v15 offset:38400
    ds_read_b64_tr_b16 a[176:177], v16 offset:24576
    ds_read_b64_tr_b16 a[178:179], v16 offset:26112
    ds_read_b64_tr_b16 a[180:181], v16 offset:36864
    ds_read_b64_tr_b16 a[182:183], v16 offset:38400
    s_branch PW_23
PWW_27:
    ds_read_b64_tr_b16 a[40:41], v14 offset:0
    ds_read_b64_tr_b16 a[42:43], v14 offset:1536
    ds_read_b64_tr_b16 a[44:45], v14 offset:12288
    ds_read_b64_tr_b16 a[46:47], v14 offset:13824
    ds_read_b64_tr_b16 a[48:49], v15 offset:0
    ds_read_b64_tr_b16 a[50:51], v15 offset:1536
    ds_read_b64_tr_b16 a[52:53], v15 offset:12288
    ds_read_b64_tr_b16 a[54:55], v15 offset:13824
    ds_read_b64_tr_b16 a[56:57], v16 offset:0
    ds_read_b64_tr_b16 a[58:59], v16 offset:1536
    ds_read_b64_tr_b16 a[60:61], v16 offset:12288
    ds_read_b64_tr_b16 a[62:63], v16 offset:13824
    ds_read_b64_tr_b16 a[64:65], v14 offset:24576
    ds_read_b64_tr_b16 a[66:67], v14 offset:26112
    ds_read_b64_tr_b16 a[68:69], v14 offset:36864
    ds_read_b64_tr_b16 a[70:71], v14 offset:38400
    ds_read_b64_tr_b16 a[72:73], v15 offset:24576
    ds_read_b64_tr_b16 a[74:75], v15 offset:26112
    ds_read_b64_tr_b16 a[76:77], v15 offset:36864
    ds_read_b64_tr_b16 a[78:79], v15 offset:38400
    ds_read_b64_tr_b16 a[80:81], v16 offset:24576
    ds_read_b64_tr_b16 a[82:83], v16 offset:26112
    ds_read_b64_tr_b16 a[84:85], v16 offset:36864
    ds_read_b64_tr_b16 a[86:87], v16 offset:38400
PW_23:
    v_add_u32 v14, 49152, v14
    v_add_u32 v15, 49152, v15
    v_add_u32 v16, 49152, v16
    s_waitcnt lgkmcnt(0)
    s_barrier
    s_add_u32 s44, s50, 2359296
    s_add_u32 m0, s51, 0
    s_nop 0
    buffer_load_dwordx4 v136, s[16:19], s44 offen  lds
    s_add_u32 m0, s51, 1024
    s_nop 0
    buffer_load_dwordx4 v137, s[16:19], s44 offen  lds
    s_add_u32 m0, s51, 2048
    s_nop 0
    buffer_load_dwordx4 v138, s[16:19], s44 offen  lds
    s_add_u32 s44, s50, 2457600
    s_add_u32 m0, s51, 3072
    v_xor_b32 v2, 64, v136
    buffer_load_dwordx4 v2, s[16:19], s44 offen  lds
    s_add_u32 m0, s51, 4096
    v_xor_b32 v2, 64, v137
    buffer_load_dwordx4 v2, s[16:19], s44 offen  lds
    s_add_u32 m0, s51, 5120
    v_xor_b32 v2, 64, v138
    buffer_load_dwordx4 v2, s[16:19], s44 offen  lds
    s_add_u32 s44, s50, 2359296
    s_add_u32 m0, s51, 24576
    s_nop 0
    buffer_load_dwordx4 v136, s[20:23], s44 offen  lds
    s_add_u32 m0, s51, 25600
    s_nop 0
    buffer_load_dwordx4 v137, s[20:23], s44 offen  lds
    s_add_u32 m0, s51, 26624
    s_nop 0
    buffer_load_dwordx4 v138, s[20:23], s44 offen  lds
    s_add_u32 s44, s50, 2457600
    s_add_u32 m0, s51, 27648
    v_xor_b32 v2, 64, v136
    buffer_load_dwordx4 v2, s[20:23], s44 offen  lds
    s_add_u32 m0, s51, 28672
    v_xor_b32 v2, 64, v137
    buffer_load_dwordx4 v2, s[20:23], s44 offen  lds
    s_add_u32 m0, s51, 29696
    v_xor_b32 v2, 64, v138
    buffer_load_dwordx4 v2, s[20:23], s44 offen  lds
    s_waitcnt vmcnt(24)
    s_barrier
    s_cmp_eq_u32 s34, 1
    s_cbranch_scc1 PWW_30
    s_cmp_eq_u32 s34, 2
    s_cbranch_scc1 PWW_31
    s_cmp_eq_u32 s34, 3
    s_cbranch_scc1 PWW_32
    ds_read_b64_tr_b16 v[72:73], v14 offset:0
    ds_read_b64_tr_b16 v[74:75], v14 offset:1536
    ds_read_b64_tr_b16 v[76:77], v14 offset:12288
    ds_read_b64_tr_b16 v[78:79], v14 offset:13824
    ds_read_b64_tr_b16 a[0:1], v15 offset:0
    ds_read_b64_tr_b16 a[2:3], v15 offset:1536
    ds_read_b64_tr_b16 a[4:5], v15 offset:12288
    ds_read_b64_tr_b16 a[6:7], v15 offset:13824
    ds_read_b64_tr_b16 a[8:9], v16 offset:0
    ds_read_b64_tr_b16 a[10:11], v16 offset:1536
    ds_read_b64_tr_b16 a[12:13], v16 offset:12288
    ds_read_b64_tr_b16 a[14:15], v16 offset:13824
    ds_read_b64_tr_b16 a[16:17], v14 offset:24576
    ds_read_b64_tr_b16 a[18:19], v14 offset:26112
    ds_read_b64_tr_b16 a[20:21], v14 offset:36864
    ds_read_b64_tr_b16 a[22:23], v14 offset:38400
    ds_read_b64_tr_b16 a[24:25], v15 offset:24576
    ds_read_b64_tr_b16 a[26:27], v15 offset:26112
    ds_read_b64_tr_b16 a[28:29], v15 offset:36864
    ds_read_b64_tr_b16 a[30:31], v15 offset:38400
    ds_read_b64_tr_b16 a[32:33], v16 offset:24576
    ds_read_b64_tr_b16 a[34:35], v16 offset:26112
    ds_read_b64_tr_b16 a[36:37], v16 offset:36864
    ds_read_b64_tr_b16 a[38:39], v16 offset:38400
    s_branch PW_28
PWW_30:
    ds_read_b64_tr_b16 v[160:161], v14 offset:0
    ds_read_b64_tr_b16 v[162:163], v14 offset:1536
    ds_read_b64_tr_b16 v[164:165], v14 offset:12288
    ds_read_b64_tr_b16 v[166:167], v14 offset:13824
    ds_read_b64_tr_b16 v[168:169], v15 offset:0
    ds_read_b64_tr_b16 v[170:171], v15 offset:1536
    ds_read_b64_tr_b16 v[172:173], v15 offset:12288
    ds_read_b64_tr_b16 v[174:175], v15 offset:13824
    ds_read_b64_tr_b16 v[176:177], v16 offset:0
    ds_read_b64_tr_b16 v[178:179], v16 offset:1536
    ds_read_b64_tr_b16 v[180:181], v16 offset:12288
    ds_read_b64_tr_b16 v[182:183], v16 offset:13824
    ds_read_b64_tr_b16 v[184:185], v14 offset:24576
    ds_read_b64_tr_b16 v[186:187], v14 offset:26112
    ds_read_b64_tr_b16 v[188:189], v14 offset:36864
    ds_read_b64_tr_b16 v[190:191], v14 offset:38400
    ds_read_b64_tr_b16 v[192:193], v15 offset:24576
    ds_read_b64_tr_b16 v[194:195], v15 offset:26112
    ds_read_b64_tr_b16 v[196:197], v15 offset:36864
    ds_read_b64_tr_b16 v[198:199], v15 offset:38400
    ds_read_b64_tr_b16 v[200:201], v16 offset:24576
    ds_read_b64_tr_b16 v[202:203], v16 offset:26112
    ds_read_b64_tr_b16 v[204:205], v16 offset:36864
    ds_read_b64_tr_b16 v[206:207], v16 offset:38400
    s_branch PW_28
PWW_31:
    ds_read_b64_tr_b16 v[80:81], v14 offset:0
    ds_read_b64_tr_b16 v[82:83], v14 offset:1536
    ds_read_b64_tr_b16 v[84:85], v14 offset:12288
    ds_read_b64_tr_b16 v[86:87], v14 offset:13824
    ds_read_b64_tr_b16 v[88:89], v15 offset:0
    ds_read_b64_tr_b16 v[90:91], v15 offset:1536
    ds_read_b64_tr_b16 v[92:93], v15 offset:12288
    ds_read_b64_tr_b16 v[94:95], v15 offset:13824
    ds_read_b64_tr_b16 v[96:97], v16 offset:0
    ds_read_b64_tr_b16 v[98:99], v16 offset:1536
    ds_read_b64_tr_b16 v[100:101], v16 offset:12288
    ds_read_b64_tr_b16 v[102:103], v16 offset:13824
    ds_read_b64_tr_b16 a[184:185], v14 offset:24576
    ds_read_b64_tr_b16 a[186:187], v14 offset:26112
    ds_read_b64_tr_b16 a[188:189], v14 offset:36864
    ds_read_b64_tr_b16 a[190:191], v14 offset:38400
    ds_read_b64_tr_b16 a[192:193], v15 offset:24576
    ds_read_b64_tr_b16 a[194:195], v15 offset:26112
    ds_read_b64_tr_b16 a[196:197], v15 offset:36864
    ds_read_b64_tr_b16 a[198:199], v15 offset:38400
    ds_read_b64_tr_b16 a[200:201], v16 offset:24576
    ds_read_b64_tr_b16 a[202:203], v16 offset:26112
    ds_read_b64_tr_b16 a[204:205], v16 offset:36864
    ds_read_b64_tr_b16 a[206:207], v16 offset:38400
    s_branch PW_28
PWW_32:
    ds_read_b64_tr_b16 a[88:89], v14 offset:0
    ds_read_b64_tr_b16 a[90:91], v14 offset:1536
    ds_read_b64_tr_b16 a[92:93], v14 offset:12288
    ds_read_b64_tr_b16 a[94:95], v14 offset:13824
    ds_read_b64_tr_b16 a[96:97], v15 offset:0
    ds_read_b64_tr_b16 a[98:99], v15 offset:1536
    ds_read_b64_tr_b16 a[100:101], v15 offset:12288
    ds_read_b64_tr_b16 a[102:103], v15 offset:13824
    ds_read_b64_tr_b16 a[104:105], v16 offset:0
    ds_read_b64_tr_b16 a[106:107], v16 offset:1536
    ds_read_b64_tr_b16 a[108:109], v16 offset:12288
    ds_read_b64_tr_b16 a[110:111], v16 offset:13824
    ds_read_b64_tr_b16 a[112:113], v14 offset:24576
    ds_read_b64_tr_b16 a[114:115], v14 offset:26112
    ds_read_b64_tr_b16 a[116:117], v14 offset:36864
    ds_read_b64_tr_b16 a[118:119], v14 offset:38400
    ds_read_b64_tr_b16 a[120:121], v15 offset:24576
    ds_read_b64_tr_b16 a[122:123], v15 offset:26112
    ds_read_b64_tr_b16 a[124:125], v15 offset:36864
    ds_read_b64_tr_b16 a[126:127], v15 offset:38400
    ds_read_b64_tr_b16 a[128:129], v16 offset:24576
    ds_read_b64_tr_b16 a[130:131], v16 offset:26112
    ds_read_b64_tr_b16 a[132:133], v16 offset:36864
    ds_read_b64_tr_b16 a[134:135], v16 offset:38400
PW_28:
    v_add_u32 v14, 49152, v14
    v_add_u32 v15, 49152, v15
    v_add_u32 v16, 49152, v16
    s_waitcnt lgkmcnt(0)
    s_barrier
    s_add_u32 s44, s50, 3145728
    s_add_u32 m0, s51, 49152
    s_nop 0
    buffer_load_dwordx4 v136, s[16:19], s44 offen  lds
    s_add_u32 m0, s51, 50176
    s_nop 0
    buffer_load_dwordx4 v137, s[16:19], s44 offen  lds
    s_add_u32 m0, s51, 51200
    s_nop 0
    buffer_load_dwordx4 v138, s[16:19], s44 offen  lds
    s_add_u32 s44, s50, 3244032
    s_add_u32 m0, s51, 52224
    v_xor_b32 v2, 64, v136
    buffer_load_dwordx4 v2, s[16:19], s44 offen  lds
    s_add_u32 m0, s51, 53248
    v_xor_b32 v2, 64, v137
    buffer_load_dwordx4 v2, s[16:19], s44 offen  lds
    s_add_u32 m0, s51, 54272
    v_xor_b32 v2, 64, v138
    buffer_load_dwordx4 v2, s[16:19], s44 offen  lds
    s_add_u32 s44, s50, 3145728
    s_add_u32 m0, s51, 73728
    s_nop 0
    buffer_load_dwordx4 v136, s[20:23], s44 offen  lds
    s_add_u32 m0, s51, 74752
    s_nop 0
    buffer_load_dwordx4 v137, s[20:23], s44 offen  lds
    s_add_u32 m0, s51, 75776
    s_nop 0
    buffer_load_dwordx4 v138, s[20:23], s44 offen  lds
    s_add_u32 s44, s50, 3244032
    s_add_u32 m0, s51, 76800
    v_xor_b32 v2, 64, v136
    buffer_load_dwordx4 v2, s[20:23], s44 offen  lds
    s_add_u32 m0, s51, 77824
    v_xor_b32 v2, 64, v137
    buffer_load_dwordx4 v2, s[20:23], s44 offen  lds
    s_add_u32 m0, s51, 78848
    v_xor_b32 v2, 64, v138
    buffer_load_dwordx4 v2, s[20:23], s44 offen  lds
    s_waitcnt vmcnt(24)
    s_barrier
    s_cmp_eq_u32 s34, 1
    s_cbranch_scc1 PWW_35
    s_cmp_eq_u32 s34, 2
    s_cbranch_scc1 PWW_36
    s_cmp_eq_u32 s34, 3
    s_cbranch_scc1 PWW_37
    ds_read_b64_tr_b16 a[40:41], v14 offset:0
    ds_read_b64_tr_b16 a[42:43], v14 offset:1536
    ds_read_b64_tr_b16 a[44:45], v14 offset:12288
    ds_read_b64_tr_b16 a[46:47], v14 offset:13824
    ds_read_b64_tr_b16 a[48:49], v15 offset:0
    ds_read_b64_tr_b16 a[50:51], v15 offset:1536
    ds_read_b64_tr_b16 a[52:53], v15 offset:12288
    ds_read_b64_tr_b16 a[54:55], v15 offset:13824
    ds_read_b64_tr_b16 a[56:57], v16 offset:0
    ds_read_b64_tr_b16 a[58:59], v16 offset:1536
    ds_read_b64_tr_b16 a[60:61], v16 offset:12288
    ds_read_b64_tr_b16 a[62:63], v16 offset:13824
    ds_read_b64_tr_b16 a[64:65], v14 offset:24576
    ds_read_b64_tr_b16 a[66:67], v14 offset:26112
    ds_read_b64_tr_b16 a[68:69], v14 offset:36864
    ds_read_b64_tr_b16 a[70:71], v14 offset:38400
    ds_read_b64_tr_b16 a[72:73], v15 offset:24576
    ds_read_b64_tr_b16 a[74:75], v15 offset:26112
    ds_read_b64_tr_b16 a[76:77], v15 offset:36864
    ds_read_b64_tr_b16 a[78:79], v15 offset:38400
    ds_read_b64_tr_b16 a[80:81], v16 offset:24576
    ds_read_b64_tr_b16 a[82:83], v16 offset:26112
    ds_read_b64_tr_b16 a[84:85], v16 offset:36864
    ds_read_b64_tr_b16 a[86:87], v16 offset:38400
    s_branch PW_33
PWW_35:
    ds_read_b64_tr_b16 v[208:209], v14 offset:0
    ds_read_b64_tr_b16 v[210:211], v14 offset:1536
    ds_read_b64_tr_b16 v[212:213], v14 offset:12288
    ds_read_b64_tr_b16 v[214:215], v14 offset:13824
    ds_read_b64_tr_b16 v[216:217], v15 offset:0
    ds_read_b64_tr_b16 v[218:219], v15 offset:1536
    ds_read_b64_tr_b16 v[220:221], v15 offset:12288
    ds_read_b64_tr_b16 v[222:223], v15 offset:13824
    ds_read_b64_tr_b16 v[224:225], v16 offset:0
    ds_read_b64_tr_b16 v[226:227], v16 offset:1536
    ds_read_b64_tr_b16 v[228:229], v16 offset:12288
    ds_read_b64_tr_b16 v[230:231], v16 offset:13824
    ds_read_b64_tr_b16 v[232:233], v14 offset:24576
    ds_read_b64_tr_b16 v[234:235], v14 offset:26112
    ds_read_b64_tr_b16 v[236:237], v14 offset:36864
    ds_read_b64_tr_b16 v[238:239], v14 offset:38400
    ds_read_b64_tr_b16 v[240:241], v15 offset:24576
    ds_read_b64_tr_b16 v[242:243], v15 offset:26112
    ds_read_b64_tr_b16 v[244:245], v15 offset:36864
    ds_read_b64_tr_b16 v[246:247], v15 offset:38400
    ds_read_b64_tr_b16 v[248:249], v16 offset:24576
    ds_read_b64_tr_b16 v[250:251], v16 offset:26112
    ds_read_b64_tr_b16 v[252:253], v16 offset:36864
    ds_read_b64_tr_b16 v[254:255], v16 offset:38400
    s_branch PW_33
PWW_36:
    ds_read_b64_tr_b16 v[104:105], v14 offset:0
    ds_read_b64_tr_b16 v[106:107], v14 offset:1536
    ds_read_b64_tr_b16 v[108:109], v14 offset:12288
    ds_read_b64_tr_b16 v[110:111], v14 offset:13824
    ds_read_b64_tr_b16 v[112:113], v15 offset:0
    ds_read_b64_tr_b16 v[114:115], v15 offset:1536
    ds_read_b64_tr_b16 v[116:117], v15 offset:12288
    ds_read_b64_tr_b16 v[118:119], v15 offset:13824
    ds_read_b64_tr_b16 v[120:121], v16 offset:0
    ds_read_b64_tr_b16 v[122:123], v16 offset:1536
    ds_read_b64_tr_b16 v[124:125], v16 offset:12288
    ds_read_b64_tr_b16 v[126:127], v16 offset:13824
    ds_read_b64_tr_b16 a[208:209], v14 offset:24576
    ds_read_b64_tr_b16 a[210:211], v14 offset:26112
    ds_read_b64_tr_b16 a[212:213], v14 offset:36864
    ds_read_b64_tr_b16 a[214:215], v14 offset:38400
    ds_read_b64_tr_b16 a[216:217], v15 offset:24576
    ds_read_b64_tr_b16 a[218:219], v15 offset:26112
    ds_read_b64_tr_b16 a[220:221], v15 offset:36864
    ds_read_b64_tr_b16 a[222:223], v15 offset:38400
    ds_read_b64_tr_b16 a[224:225], v16 offset:24576
    ds_read_b64_tr_b16 a[226:227], v16 offset:26112
    ds_read_b64_tr_b16 a[228:229], v16 offset:36864
    ds_read_b64_tr_b16 a[230:231], v16 offset:38400
    s_branch PW_33
PWW_37:
    ds_read_b64_tr_b16 a[136:137], v14 offset:0
    ds_read_b64_tr_b16 a[138:139], v14 offset:1536
    ds_read_b64_tr_b16 a[140:141], v14 offset:12288
    ds_read_b64_tr_b16 a[142:143], v14 offset:13824
    ds_read_b64_tr_b16 a[144:145], v15 offset:0
    ds_read_b64_tr_b16 a[146:147], v15 offset:1536
    ds_read_b64_tr_b16 a[148:149], v15 offset:12288
    ds_read_b64_tr_b16 a[150:151], v15 offset:13824
    ds_read_b64_tr_b16 a[152:153], v16 offset:0
    ds_read_b64_tr_b16 a[154:155], v16 offset:1536
    ds_read_b64_tr_b16 a[156:157], v16 offset:12288
    ds_read_b64_tr_b16 a[158:159], v16 offset:13824
    ds_read_b64_tr_b16 a[160:161], v14 offset:24576
    ds_read_b64_tr_b16 a[162:163], v14 offset:26112
    ds_read_b64_tr_b16 a[164:165], v14 offset:36864
    ds_read_b64_tr_b16 a[166:167], v14 offset:38400
    ds_read_b64_tr_b16 a[168:169], v15 offset:24576
    ds_read_b64_tr_b16 a[170:171], v15 offset:26112
    ds_read_b64_tr_b16 a[172:173], v15 offset:36864
    ds_read_b64_tr_b16 a[174:175], v15 offset:38400
    ds_read_b64_tr_b16 a[176:177], v16 offset:24576
    ds_read_b64_tr_b16 a[178:179], v16 offset:26112
    ds_read_b64_tr_b16 a[180:181], v16 offset:36864
    ds_read_b64_tr_b16 a[182:183], v16 offset:38400
PW_33:
    v_add_u32 v14, -98304, v14
    v_add_u32 v15, -98304, v15
    v_add_u32 v16, -98304, v16
    s_waitcnt lgkmcnt(0)
    s_barrier
    s_add_u32 s44, s50, 3932160
    s_add_u32 m0, s51, 98304
    s_nop 0
    buffer_load_dwordx4 v136, s[16:19], s44 offen  lds
    s_add_u32 m0, s51, 99328
    s_nop 0
    buffer_load_dwordx4 v137, s[16:19], s44 offen  lds
    s_add_u32 m0, s51, 100352
    s_nop 0
    buffer_load_dwordx4 v138, s[16:19], s44 offen  lds
    s_add_u32 s44, s50, 4030464
    s_add_u32 m0, s51, 101376
    v_xor_b32 v2, 64, v136
    buffer_load_dwordx4 v2, s[16:19], s44 offen  lds
    s_add_u32 m0, s51, 102400
    v_xor_b32 v2, 64, v137
    buffer_load_dwordx4 v2, s[16:19], s44 offen  lds
    s_add_u32 m0, s51, 103424
    v_xor_b32 v2, 64, v138
    buffer_load_dwordx4 v2, s[16:19], s44 offen  lds
    s_add_u32 s44, s50, 3932160
    s_add_u32 m0, s51, 122880
    s_nop 0
    buffer_load_dwordx4 v136, s[20:23], s44 offen  lds
    s_add_u32 m0, s51, 123904
    s_nop 0
    buffer_load_dwordx4 v137, s[20:23], s44 offen  lds
    s_add_u32 m0, s51, 124928
    s_nop 0
    buffer_load_dwordx4 v138, s[20:23], s44 offen  lds
    s_add_u32 s44, s50, 4030464
    s_add_u32 m0, s51, 125952
    v_xor_b32 v2, 64, v136
    buffer_load_dwordx4 v2, s[20:23], s44 offen  lds
    s_add_u32 m0, s51, 126976
    v_xor_b32 v2, 64, v137
    buffer_load_dwordx4 v2, s[20:23], s44 offen  lds
    s_add_u32 m0, s51, 128000
    v_xor_b32 v2, 64, v138
    buffer_load_dwordx4 v2, s[20:23], s44 offen  lds
    s_waitcnt vmcnt(24)
    s_barrier
    s_cmp_eq_u32 s34, 1
    s_cbranch_scc1 PWW_40
    s_cmp_eq_u32 s34, 2
    s_cbranch_scc1 PWW_41
    s_cmp_eq_u32 s34, 3
    s_cbranch_scc1 PWW_42
    ds_read_b64_tr_b16 a[88:89], v14 offset:0
    ds_read_b64_tr_b16 a[90:91], v14 offset:1536
    ds_read_b64_tr_b16 a[92:93], v14 offset:12288
    ds_read_b64_tr_b16 a[94:95], v14 offset:13824
    ds_read_b64_tr_b16 a[96:97], v15 offset:0
    ds_read_b64_tr_b16 a[98:99], v15 offset:1536
    ds_read_b64_tr_b16 a[100:101], v15 offset:12288
    ds_read_b64_tr_b16 a[102:103], v15 offset:13824
    ds_read_b64_tr_b16 a[104:105], v16 offset:0
    ds_read_b64_tr_b16 a[106:107], v16 offset:1536
    ds_read_b64_tr_b16 a[108:109], v16 offset:12288
    ds_read_b64_tr_b16 a[110:111], v16 offset:13824
    ds_read_b64_tr_b16 a[112:113], v14 offset:24576
    ds_read_b64_tr_b16 a[114:115], v14 offset:26112
    ds_read_b64_tr_b16 a[116:117], v14 offset:36864
    ds_read_b64_tr_b16 a[118:119], v14 offset:38400
    ds_read_b64_tr_b16 a[120:121], v15 offset:24576
    ds_read_b64_tr_b16 a[122:123], v15 offset:26112
    ds_read_b64_tr_b16 a[124:125], v15 offset:36864
    ds_read_b64_tr_b16 a[126:127], v15 offset:38400
    ds_read_b64_tr_b16 a[128:129], v16 offset:24576
    ds_read_b64_tr_b16 a[130:131], v16 offset:26112
    ds_read_b64_tr_b16 a[132:133], v16 offset:36864
    ds_read_b64_tr_b16 a[134:135], v16 offset:38400
    s_branch PW_38
PWW_40:
    ds_read_b64_tr_b16 v[24:25], v14 offset:0
    ds_read_b64_tr_b16 v[26:27], v14 offset:1536
    ds_read_b64_tr_b16 v[28:29], v14 offset:12288
    ds_read_b64_tr_b16 v[30:31], v14 offset:13824
    ds_read_b64_tr_b16 v[32:33], v15 offset:0
    ds_read_b64_tr_b16 v[34:35], v15 offset:1536
    ds_read_b64_tr_b16 v[36:37], v15 offset:12288
    ds_read_b64_tr_b16 v[38:39], v15 offset:13824
    ds_read_b64_tr_b16 v[40:41], v16 offset:0
    ds_read_b64_tr_b16 v[42:43], v16 offset:1536
    ds_read_b64_tr_b16 v[44:45], v16 offset:12288
    ds_read_b64_tr_b16 v[46:47], v16 offset:13824
    ds_read_b64_tr_b16 v[48:49], v14 offset:24576
    ds_read_b64_tr_b16 v[50:51], v14 offset:26112
    ds_read_b64_tr_b16 v[52:53], v14 offset:36864
    ds_read_b64_tr_b16 v[54:55], v14 offset:38400
    ds_read_b64_tr_b16 v[56:57], v15 offset:24576
    ds_read_b64_tr_b16 v[58:59], v15 offset:26112
    ds_read_b64_tr_b16 v[60:61], v15 offset:36864
    ds_read_b64_tr_b16 v[62:63], v15 offset:38400
    ds_read_b64_tr_b16 v[64:65], v16 offset:24576
    ds_read_b64_tr_b16 v[66:67], v16 offset:26112
    ds_read_b64_tr_b16 v[68:69], v16 offset:36864
    ds_read_b64_tr_b16 v[70:71], v16 offset:38400
    s_branch PW_38
PWW_41:
    ds_read_b64_tr_b16 v[128:129], v14 offset:0
    ds_read_b64_tr_b16 v[130:131], v14 offset:1536
    ds_read_b64_tr_b16 v[132:133], v14 offset:12288
    ds_read_b64_tr_b16 v[134:135], v14 offset:13824
    ds_read_b64_tr_b16 a[232:233], v15 offset:0
    ds_read_b64_tr_b16 a[234:235], v15 offset:1536
    ds_read_b64_tr_b16 a[236:237], v15 offset:12288
    ds_read_b64_tr_b16 a[238:239], v15 offset:13824
    ds_read_b64_tr_b16 a[240:241], v16 offset:0
    ds_read_b64_tr_b16 a[242:243], v16 offset:1536
    ds_read_b64_tr_b16 a[244:245], v16 offset:12288
    ds_read_b64_tr_b16 a[246:247], v16 offset:13824
    ds_read_b64_tr_b16 a[248:249], v14 offset:24576
    ds_read_b64_tr_b16 a[250:251], v14 offset:26112
    ds_read_b64_tr_b16 a[252:253], v14 offset:36864
    ds_read_b64_tr_b16 a[254:255], v14 offset:38400
    ds_read_b64_tr_b16 v[144:145], v15 offset:24576
    ds_read_b64_tr_b16 v[146:147], v15 offset:26112
    ds_read_b64_tr_b16 v[148:149], v15 offset:36864
    ds_read_b64_tr_b16 v[150:151], v15 offset:38400
    ds_read_b64_tr_b16 v[152:153], v16 offset:24576
    ds_read_b64_tr_b16 v[154:155], v16 offset:26112
    ds_read_b64_tr_b16 v[156:157], v16 offset:36864
    ds_read_b64_tr_b16 v[158:159], v16 offset:38400
    s_branch PW_38
PWW_42:
    ds_read_b64_tr_b16 v[80:81], v14 offset:0
    ds_read_b64_tr_b16 v[82:83], v14 offset:1536
    ds_read_b64_tr_b16 v[84:85], v14 offset:12288
    ds_read_b64_tr_b16 v[86:87], v14 offset:13824
    ds_read_b64_tr_b16 v[88:89], v15 offset:0
    ds_read_b64_tr_b16 v[90:91], v15 offset:1536
    ds_read_b64_tr_b16 v[92:93], v15 offset:12288
    ds_read_b64_tr_b16 v[94:95], v15 offset:13824
    ds_read_b64_tr_b16 v[96:97], v16 offset:0
    ds_read_b64_tr_b16 v[98:99], v16 offset:1536
    ds_read_b64_tr_b16 v[100:101], v16 offset:12288
    ds_read_b64_tr_b16 v[102:103], v16 offset:13824
    ds_read_b64_tr_b16 a[184:185], v14 offset:24576
    ds_read_b64_tr_b16 a[186:187], v14 offset:26112
    ds_read_b64_tr_b16 a[188:189], v14 offset:36864
    ds_read_b64_tr_b16 a[190:191], v14 offset:38400
    ds_read_b64_tr_b16 a[192:193], v15 offset:24576
    ds_read_b64_tr_b16 a[194:195], v15 offset:26112
    ds_read_b64_tr_b16 a[196:197], v15 offset:36864
    ds_read_b64_tr_b16 a[198:199], v15 offset:38400
    ds_read_b64_tr_b16 a[200:201], v16 offset:24576
    ds_read_b64_tr_b16 a[202:203], v16 offset:26112
    ds_read_b64_tr_b16 a[204:205], v16 offset:36864
    ds_read_b64_tr_b16 a[206:207], v16 offset:38400
PW_38:
    v_add_u32 v14, 49152, v14
    v_add_u32 v15, 49152, v15
    v_add_u32 v16, 49152, v16
    s_waitcnt lgkmcnt(0)
    s_barrier
    s_add_u32 s44, s50, 4718592
    s_add_u32 m0, s51, 0
    s_nop 0
    buffer_load_dwordx4 v136, s[16:19], s44 offen  lds
    s_add_u32 m0, s51, 1024
    s_nop 0
    buffer_load_dwordx4 v137, s[16:19], s44 offen  lds
    s_add_u32 m0, s51, 2048
    s_nop 0
    buffer_load_dwordx4 v138, s[16:19], s44 offen  lds
    s_add_u32 s44, s50, 4816896
    s_add_u32 m0, s51, 3072
    v_xor_b32 v2, 64, v136
    buffer_load_dwordx4 v2, s[16:19], s44 offen  lds
    s_add_u32 m0, s51, 4096
    v_xor_b32 v2, 64, v137
    buffer_load_dwordx4 v2, s[16:19], s44 offen  lds
    s_add_u32 m0, s51, 5120
    v_xor_b32 v2, 64, v138
    buffer_load_dwordx4 v2, s[16:19], s44 offen  lds
    s_add_u32 s44, s50, 4718592
    s_add_u32 m0, s51, 24576
    s_nop 0
    buffer_load_dwordx4 v136, s[20:23], s44 offen  lds
    s_add_u32 m0, s51, 25600
    s_nop 0
    buffer_load_dwordx4 v137, s[20:23], s44 offen  lds
    s_add_u32 m0, s51, 26624
    s_nop 0
    buffer_load_dwordx4 v138, s[20:23], s44 offen  lds
    s_add_u32 s44, s50, 4816896
    s_add_u32 m0, s51, 27648
    v_xor_b32 v2, 64, v136
    buffer_load_dwordx4 v2, s[20:23], s44 offen  lds
    s_add_u32 m0, s51, 28672
    v_xor_b32 v2, 64, v137
    buffer_load_dwordx4 v2, s[20:23], s44 offen  lds
    s_add_u32 m0, s51, 29696
    v_xor_b32 v2, 64, v138
    buffer_load_dwordx4 v2, s[20:23], s44 offen  lds
    s_waitcnt vmcnt(24)
    s_barrier
    s_cmp_eq_u32 s34, 1
    s_cbranch_scc1 PWW_45
    s_cmp_eq_u32 s34, 2
    s_cbranch_scc1 PWW_46
    s_cmp_eq_u32 s34, 3
    s_cbranch_scc1 PWW_47
    ds_read_b64_tr_b16 a[136:137], v14 offset:0
    ds_read_b64_tr_b16 a[138:139], v14 offset:1536
    ds_read_b64_tr_b16 a[140:141], v14 offset:12288
    ds_read_b64_tr_b16 a[142:143], v14 offset:13824
    ds_read_b64_tr_b16 a[144:145], v15 offset:0
    ds_read_b64_tr_b16 a[146:147], v15 offset:1536
    ds_read_b64_tr_b16 a[148:149], v15 offset:12288
    ds_read_b64_tr_b16 a[150:151], v15 offset:13824
    ds_read_b64_tr_b16 a[152:153], v16 offset:0
    ds_read_b64_tr_b16 a[154:155], v16 offset:1536
    ds_read_b64_tr_b16 a[156:157], v16 offset:12288
    ds_read_b64_tr_b16 a[158:159], v16 offset:13824
    ds_read_b64_tr_b16 a[160:161], v14 offset:24576
    ds_read_b64_tr_b16 a[162:163], v14 offset:26112
    ds_read_b64_tr_b16 a[164:165], v14 offset:36864
    ds_read_b64_tr_b16 a[166:167], v14 offset:38400
    ds_read_b64_tr_b16 a[168:169], v15 offset:24576
    ds_read_b64_tr_b16 a[170:171], v15 offset:26112
    ds_read_b64_tr_b16 a[172:173], v15 offset:36864
    ds_read_b64_tr_b16 a[174:175], v15 offset:38400
    ds_read_b64_tr_b16 a[176:177], v16 offset:24576
    ds_read_b64_tr_b16 a[178:179], v16 offset:26112
    ds_read_b64_tr_b16 a[180:181], v16 offset:36864
    ds_read_b64_tr_b16 a[182:183], v16 offset:38400
    s_branch PW_43
PWW_45:
    ds_read_b64_tr_b16 v[72:73], v14 offset:0
    ds_read_b64_tr_b16 v[74:75], v14 offset:1536
    ds_read_b64_tr_b16 v[76:77], v14 offset:12288
    ds_read_b64_tr_b16 v[78:79], v14 offset:13824
    ds_read_b64_tr_b16 a[0:1], v15 offset:0
    ds_read_b64_tr_b16 a[2:3], v15 offset:1536
    ds_read_b64_tr_b16 a[4:5], v15 offset:12288
    ds_read_b64_tr_b16 a[6:7], v15 offset:13824
    ds_read_b64_tr_b16 a[8:9], v16 offset:0
    ds_read_b64_tr_b16 a[10:11], v16 offset:1536
    ds_read_b64_tr_b16 a[12:13], v16 offset:12288
    ds_read_b64_tr_b16 a[14:15], v16 offset:13824
    ds_read_b64_tr_b16 a[16:17], v14 offset:24576
    ds_read_b64_tr_b16 a[18:19], v14 offset:26112
    ds_read_b64_tr_b16 a[20:21], v14 offset:36864
    ds_read_b64_tr_b16 a[22:23], v14 offset:38400
    ds_read_b64_tr_b16 a[24:25], v15 offset:24576
    ds_read_b64_tr_b16 a[26:27], v15 offset:26112
    ds_read_b64_tr_b16 a[28:29], v15 offset:36864
    ds_read_b64_tr_b16 a[30:31], v15 offset:38400
    ds_read_b64_tr_b16 a[32:33], v16 offset:24576
    ds_read_b64_tr_b16 a[34:35], v16 offset:26112
    ds_read_b64_tr_b16 a[36:37], v16 offset:36864
    ds_read_b64_tr_b16 a[38:39], v16 offset:38400
    s_branch PW_43
PWW_46:
    ds_read_b64_tr_b16 v[160:161], v14 offset:0
    ds_read_b64_tr_b16 v[162:163], v14 offset:1536
    ds_read_b64_tr_b16 v[164:165], v14 offset:12288
    ds_read_b64_tr_b16 v[166:167], v14 offset:13824
    ds_read_b64_tr_b16 v[168:169], v15 offset:0
    ds_read_b64_tr_b16 v[170:171], v15 offset:1536
    ds_read_b64_tr_b16 v[172:173], v15 offset:12288
    ds_read_b64_tr_b16 v[174:175], v15 offset:13824
    ds_read_b64_tr_b16 v[176:177], v16 offset:0
    ds_read_b64_tr_b16 v[178:179], v16 offset:1536
    ds_read_b64_tr_b16 v[180:181], v16 offset:12288
    ds_read_b64_tr_b16 v[182:183], v16 offset:13824
    ds_read_b64_tr_b16 v[184:185], v14 offset:24576
    ds_read_b64_tr_b16 v[186:187], v14 offset:26112
    ds_read_b64_tr_b16 v[188:189], v14 offset:36864
    ds_read_b64_tr_b16 v[190:191], v14 offset:38400
    ds_read_b64_tr_b16 v[192:193], v15 offset:24576
    ds_read_b64_tr_b16 v[194:195], v15 offset:26112
    ds_read_b64_tr_b16 v[196:197], v15 offset:36864
    ds_read_b64_tr_b16 v[198:199], v15 offset:38400
    ds_read_b64_tr_b16 v[200:201], v16 offset:24576
    ds_read_b64_tr_b16 v[202:203], v16 offset:26112
    ds_read_b64_tr_b16 v[204:205], v16 offset:36864
    ds_read_b64_tr_b16 v[206:207], v16 offset:38400
    s_branch PW_43
PWW_47:
    ds_read_b64_tr_b16 v[104:105], v14 offset:0
    ds_read_b64_tr_b16 v[106:107], v14 offset:1536
    ds_read_b64_tr_b16 v[108:109], v14 offset:12288
    ds_read_b64_tr_b16 v[110:111], v14 offset:13824
    ds_read_b64_tr_b16 v[112:113], v15 offset:0
    ds_read_b64_tr_b16 v[114:115], v15 offset:1536
    ds_read_b64_tr_b16 v[116:117], v15 offset:12288
    ds_read_b64_tr_b16 v[118:119], v15 offset:13824
    ds_read_b64_tr_b16 v[120:121], v16 offset:0
    ds_read_b64_tr_b16 v[122:123], v16 offset:1536
    ds_read_b64_tr_b16 v[124:125], v16 offset:12288
    ds_read_b64_tr_b16 v[126:127], v16 offset:13824
    ds_read_b64_tr_b16 a[208:209], v14 offset:24576
    ds_read_b64_tr_b16 a[210:211], v14 offset:26112
    ds_read_b64_tr_b16 a[212:213], v14 offset:36864
    ds_read_b64_tr_b16 a[214:215], v14 offset:38400
    ds_read_b64_tr_b16 a[216:217], v15 offset:24576
    ds_read_b64_tr_b16 a[218:219], v15 offset:26112
    ds_read_b64_tr_b16 a[220:221], v15 offset:36864
    ds_read_b64_tr_b16 a[222:223], v15 offset:38400
    ds_read_b64_tr_b16 a[224:225], v16 offset:24576
    ds_read_b64_tr_b16 a[226:227], v16 offset:26112
    ds_read_b64_tr_b16 a[228:229], v16 offset:36864
    ds_read_b64_tr_b16 a[230:231], v16 offset:38400
PW_43:
    v_add_u32 v14, 49152, v14
    v_add_u32 v15, 49152, v15
    v_add_u32 v16, 49152, v16
    s_waitcnt lgkmcnt(0)
    s_barrier
    s_add_u32 s44, s50, 5505024
    s_add_u32 m0, s51, 49152
    s_nop 0
    buffer_load_dwordx4 v136, s[16:19], s44 offen  lds
    s_add_u32 m0, s51, 50176
    s_nop 0
    buffer_load_dwordx4 v137, s[16:19], s44 offen  lds
    s_add_u32 m0, s51, 51200
    s_nop 0
    buffer_load_dwordx4 v138, s[16:19], s44 offen  lds
    s_add_u32 s44, s50, 5603328
    s_add_u32 m0, s51, 52224
    v_xor_b32 v2, 64, v136
    buffer_load_dwordx4 v2, s[16:19], s44 offen  lds
    s_add_u32 m0, s51, 53248
    v_xor_b32 v2, 64, v137
    buffer_load_dwordx4 v2, s[16:19], s44 offen  lds
    s_add_u32 m0, s51, 54272
    v_xor_b32 v2, 64, v138
    buffer_load_dwordx4 v2, s[16:19], s44 offen  lds
    s_add_u32 s44, s50, 5505024
    s_add_u32 m0, s51, 73728
    s_nop 0
    buffer_load_dwordx4 v136, s[20:23], s44 offen  lds
    s_add_u32 m0, s51, 74752
    s_nop 0
    buffer_load_dwordx4 v137, s[20:23], s44 offen  lds
    s_add_u32 m0, s51, 75776
    s_nop 0
    buffer_load_dwordx4 v138, s[20:23], s44 offen  lds
    s_add_u32 s44, s50, 5603328
    s_add_u32 m0, s51, 76800
    v_xor_b32 v2, 64, v136
    buffer_load_dwordx4 v2, s[20:23], s44 offen  lds
    s_add_u32 m0, s51, 77824
    v_xor_b32 v2, 64, v137
    buffer_load_dwordx4 v2, s[20:23], s44 offen  lds
    s_add_u32 m0, s51, 78848
    v_xor_b32 v2, 64, v138
    buffer_load_dwordx4 v2, s[20:23], s44 offen  lds
    s_waitcnt vmcnt(24)
    s_barrier
    s_cmp_eq_u32 s34, 1
    s_cbranch_scc1 PWW_50
    s_cmp_eq_u32 s34, 2
    s_cbranch_scc1 PWW_51
    s_cmp_eq_u32 s34, 3
    s_cbranch_scc1 PWW_52
    ds_read_b64_tr_b16 v[80:81], v14 offset:0
    ds_read_b64_tr_b16 v[82:83], v14 offset:1536
    ds_read_b64_tr_b16 v[84:85], v14 offset:12288
    ds_read_b64_tr_b16 v[86:87], v14 offset:13824
    ds_read_b64_tr_b16 v[88:89], v15 offset:0
    ds_read_b64_tr_b16 v[90:91], v15 offset:1536
    ds_read_b64_tr_b16 v[92:93], v15 offset:12288
    ds_read_b64_tr_b16 v[94:95], v15 offset:13824
    ds_read_b64_tr_b16 v[96:97], v16 offset:0
    ds_read_b64_tr_b16 v[98:99], v16 offset:1536
    ds_read_b64_tr_b16 v[100:101], v16 offset:12288
    ds_read_b64_tr_b16 v[102:103], v16 offset:13824
    ds_read_b64_tr_b16 a[184:185], v14 offset:24576
    ds_read_b64_tr_b16 a[186:187], v14 offset:26112
    ds_read_b64_tr_b16 a[188:189], v14 offset:36864
    ds_read_b64_tr_b16 a[190:191], v14 offset:38400
    ds_read_b64_tr_b16 a[192:193], v15 offset:24576
    ds_read_b64_tr_b16 a[194:195], v15 offset:26112
    ds_read_b64_tr_b16 a[196:197], v15 offset:36864
    ds_read_b64_tr_b16 a[198:199], v15 offset:38400
    ds_read_b64_tr_b16 a[200:201], v16 offset:24576
    ds_read_b64_tr_b16 a[202:203], v16 offset:26112
    ds_read_b64_tr_b16 a[204:205], v16 offset:36864
    ds_read_b64_tr_b16 a[206:207], v16 offset:38400
    s_branch PW_48
PWW_50:
    ds_read_b64_tr_b16 a[40:41], v14 offset:0
    ds_read_b64_tr_b16 a[42:43], v14 offset:1536
    ds_read_b64_tr_b16 a[44:45], v14 offset:12288
    ds_read_b64_tr_b16 a[46:47], v14 offset:13824
    ds_read_b64_tr_b16 a[48:49], v15 offset:0
    ds_read_b64_tr_b16 a[50:51], v15 offset:1536
    ds_read_b64_tr_b16 a[52:53], v15 offset:12288
    ds_read_b64_tr_b16 a[54:55], v15 offset:13824
    ds_read_b64_tr_b16 a[56:57], v16 offset:0
    ds_read_b64_tr_b16 a[58:59], v16 offset:1536
    ds_read_b64_tr_b16 a[60:61], v16 offset:12288
    ds_read_b64_tr_b16 a[62:63], v16 offset:13824
    ds_read_b64_tr_b16 a[64:65], v14 offset:24576
    ds_read_b64_tr_b16 a[66:67], v14 offset:26112
    ds_read_b64_tr_b16 a[68:69], v14 offset:36864
    ds_read_b64_tr_b16 a[70:71], v14 offset:38400
    ds_read_b64_tr_b16 a[72:73], v15 offset:24576
    ds_read_b64_tr_b16 a[74:75], v15 offset:26112
    ds_read_b64_tr_b16 a[76:77], v15 offset:36864
    ds_read_b64_tr_b16 a[78:79], v15 offset:38400
    ds_read_b64_tr_b16 a[80:81], v16 offset:24576
    ds_read_b64_tr_b16 a[82:83], v16 offset:26112
    ds_read_b64_tr_b16 a[84:85], v16 offset:36864
    ds_read_b64_tr_b16 a[86:87], v16 offset:38400
    s_branch PW_48
PWW_51:
    ds_read_b64_tr_b16 v[208:209], v14 offset:0
    ds_read_b64_tr_b16 v[210:211], v14 offset:1536
    ds_read_b64_tr_b16 v[212:213], v14 offset:12288
    ds_read_b64_tr_b16 v[214:215], v14 offset:13824
    ds_read_b64_tr_b16 v[216:217], v15 offset:0
    ds_read_b64_tr_b16 v[218:219], v15 offset:1536
    ds_read_b64_tr_b16 v[220:221], v15 offset:12288
    ds_read_b64_tr_b16 v[222:223], v15 offset:13824
    ds_read_b64_tr_b16 v[224:225], v16 offset:0
    ds_read_b64_tr_b16 v[226:227], v16 offset:1536
    ds_read_b64_tr_b16 v[228:229], v16 offset:12288
    ds_read_b64_tr_b16 v[230:231], v16 offset:13824
    ds_read_b64_tr_b16 v[232:233], v14 offset:24576
    ds_read_b64_tr_b16 v[234:235], v14 offset:26112
    ds_read_b64_tr_b16 v[236:237], v14 offset:36864
    ds_read_b64_tr_b16 v[238:239], v14 offset:38400
    ds_read_b64_tr_b16 v[240:241], v15 offset:24576
    ds_read_b64_tr_b16 v[242:243], v15 offset:26112
    ds_read_b64_tr_b16 v[244:245], v15 offset:36864
    ds_read_b64_tr_b16 v[246:247], v15 offset:38400
    ds_read_b64_tr_b16 v[248:249], v16 offset:24576
    ds_read_b64_tr_b16 v[250:251], v16 offset:26112
    ds_read_b64_tr_b16 v[252:253], v16 offset:36864
    ds_read_b64_tr_b16 v[254:255], v16 offset:38400
    s_branch PW_48
PWW_52:
    ds_read_b64_tr_b16 v[128:129], v14 offset:0
    ds_read_b64_tr_b16 v[130:131], v14 offset:1536
    ds_read_b64_tr_b16 v[132:133], v14 offset:12288
    ds_read_b64_tr_b16 v[134:135], v14 offset:13824
    ds_read_b64_tr_b16 a[232:233], v15 offset:0
    ds_read_b64_tr_b16 a[234:235], v15 offset:1536
    ds_read_b64_tr_b16 a[236:237], v15 offset:12288
    ds_read_b64_tr_b16 a[238:239], v15 offset:13824
    ds_read_b64_tr_b16 a[240:241], v16 offset:0
    ds_read_b64_tr_b16 a[242:243], v16 offset:1536
    ds_read_b64_tr_b16 a[244:245], v16 offset:12288
    ds_read_b64_tr_b16 a[246:247], v16 offset:13824
    ds_read_b64_tr_b16 a[248:249], v14 offset:24576
    ds_read_b64_tr_b16 a[250:251], v14 offset:26112
    ds_read_b64_tr_b16 a[252:253], v14 offset:36864
    ds_read_b64_tr_b16 a[254:255], v14 offset:38400
    ds_read_b64_tr_b16 v[144:145], v15 offset:24576
    ds_read_b64_tr_b16 v[146:147], v15 offset:26112
    ds_read_b64_tr_b16 v[148:149], v15 offset:36864
    ds_read_b64_tr_b16 v[150:151], v15 offset:38400
    ds_read_b64_tr_b16 v[152:153], v16 offset:24576
    ds_read_b64_tr_b16 v[154:155], v16 offset:26112
    ds_read_b64_tr_b16 v[156:157], v16 offset:36864
    ds_read_b64_tr_b16 v[158:159], v16 offset:38400
PW_48:
    v_add_u32 v14, -98304, v14
    v_add_u32 v15, -98304, v15
    v_add_u32 v16, -98304, v16
    s_waitcnt lgkmcnt(0)
    s_barrier
    s_add_u32 s44, s50, 6291456
    s_add_u32 m0, s51, 98304
    s_nop 0
    buffer_load_dwordx4 v136, s[16:19], s44 offen  lds
    s_add_u32 m0, s51, 99328
    s_nop 0
    buffer_load_dwordx4 v137, s[16:19], s44 offen  lds
    s_add_u32 m0, s51, 100352
    s_nop 0
    buffer_load_dwordx4 v138, s[16:19], s44 offen  lds
    s_add_u32 s44, s50, 6389760
    s_add_u32 m0, s51, 101376
    v_xor_b32 v2, 64, v136
    buffer_load_dwordx4 v2, s[16:19], s44 offen  lds
    s_add_u32 m0, s51, 102400
    v_xor_b32 v2, 64, v137
    buffer_load_dwordx4 v2, s[16:19], s44 offen  lds
    s_add_u32 m0, s51, 103424
    v_xor_b32 v2, 64, v138
    buffer_load_dwordx4 v2, s[16:19], s44 offen  lds
    s_add_u32 s44, s50, 6291456
    s_add_u32 m0, s51, 122880
    s_nop 0
    buffer_load_dwordx4 v136, s[20:23], s44 offen  lds
    s_add_u32 m0, s51, 123904
    s_nop 0
    buffer_load_dwordx4 v137, s[20:23], s44 offen  lds
    s_add_u32 m0, s51, 124928
    s_nop 0
    buffer_load_dwordx4 v138, s[20:23], s44 offen  lds
    s_add_u32 s44, s50, 6389760
    s_add_u32 m0, s51, 125952
    v_xor_b32 v2, 64, v136
    buffer_load_dwordx4 v2, s[20:23], s44 offen  lds
    s_add_u32 m0, s51, 126976
    v_xor_b32 v2, 64, v137
    buffer_load_dwordx4 v2, s[20:23], s44 offen  lds
    s_add_u32 m0, s51, 128000
    v_xor_b32 v2, 64, v138
    buffer_load_dwordx4 v2, s[20:23], s44 offen  lds
    s_waitcnt vmcnt(24)
    s_barrier
    s_cmp_eq_u32 s34, 1
    s_cbranch_scc1 PWW_55
    s_cmp_eq_u32 s34, 2
    s_cbranch_scc1 PWW_56
    s_cmp_eq_u32 s34, 3
    s_cbranch_scc1 PWW_57
    ds_read_b64_tr_b16 v[104:105], v14 offset:0
    ds_read_b64_tr_b16 v[106:107], v14 offset:1536
    ds_read_b64_tr_b16 v[108:109], v14 offset:12288
    ds_read_b64_tr_b16 v[110:111], v14 offset:13824
    ds_read_b64_tr_b16 v[112:113], v15 offset:0
    ds_read_b64_tr_b16 v[114:115], v15 offset:1536
    ds_read_b64_tr_b16 v[116:117], v15 offset:12288
    ds_read_b64_tr_b16 v[118:119], v15 offset:13824
    ds_read_b64_tr_b16 v[120:121], v16 offset:0
    ds_read_b64_tr_b16 v[122:123], v16 offset:1536
    ds_read_b64_tr_b16 v[124:125], v16 offset:12288
    ds_read_b64_tr_b16 v[126:127], v16 offset:13824
    ds_read_b64_tr_b16 a[208:209], v14 offset:24576
    ds_read_b64_tr_b16 a[210:211], v14 offset:26112
    ds_read_b64_tr_b16 a[212:213], v14 offset:36864
    ds_read_b64_tr_b16 a[214:215], v14 offset:38400
    ds_read_b64_tr_b16 a[216:217], v15 offset:24576
    ds_read_b64_tr_b16 a[218:219], v15 offset:26112
    ds_read_b64_tr_b16 a[220:221], v15 offset:36864
    ds_read_b64_tr_b16 a[222:223], v15 offset:38400
    ds_read_b64_tr_b16 a[224:225], v16 offset:24576
    ds_read_b64_tr_b16 a[226:227], v16 offset:26112
    ds_read_b64_tr_b16 a[228:229], v16 offset:36864
    ds_read_b64_tr_b16 a[230:231], v16 offset:38400
    s_branch PW_53
PWW_55:
    ds_read_b64_tr_b16 a[88:89], v14 offset:0
    ds_read_b64_tr_b16 a[90:91], v14 offset:1536
    ds_read_b64_tr_b16 a[92:93], v14 offset:12288
    ds_read_b64_tr_b16 a[94:95], v14 offset:13824
    ds_read_b64_tr_b16 a[96:97], v15 offset:0
    ds_read_b64_tr_b16 a[98:99], v15 offset:1536
    ds_read_b64_tr_b16 a[100:101], v15 offset:12288
    ds_read_b64_tr_b16 a[102:103], v15 offset:13824
    ds_read_b64_tr_b16 a[104:105], v16 offset:0
    ds_read_b64_tr_b16 a[106:107], v16 offset:1536
    ds_read_b64_tr_b16 a[108:109], v16 offset:12288
    ds_read_b64_tr_b16 a[110:111], v16 offset:13824
    ds_read_b64_tr_b16 a[112:113], v14 offset:24576
    ds_read_b64_tr_b16 a[114:115], v14 offset:26112
    ds_read_b64_tr_b16 a[116:117], v14 offset:36864
    ds_read_b64_tr_b16 a[118:119], v14 offset:38400
    ds_read_b64_tr_b16 a[120:121], v15 offset:24576
    ds_read_b64_tr_b16 a[122:123], v15 offset:26112
    ds_read_b64_tr_b16 a[124:125], v15 offset:36864
    ds_read_b64_tr_b16 a[126:127], v15 offset:38400
    ds_read_b64_tr_b16 a[128:129], v16 offset:24576
    ds_read_b64_tr_b16 a[130:131], v16 offset:26112
    ds_read_b64_tr_b16 a[132:133], v16 offset:36864
    ds_read_b64_tr_b16 a[134:135], v16 offset:38400
    s_branch PW_53
PWW_56:
    ds_read_b64_tr_b16 v[24:25], v14 offset:0
    ds_read_b64_tr_b16 v[26:27], v14 offset:1536
    ds_read_b64_tr_b16 v[28:29], v14 offset:12288
    ds_read_b64_tr_b16 v[30:31], v14 offset:13824
    ds_read_b64_tr_b16 v[32:33], v15 offset:0
    ds_read_b64_tr_b16 v[34:35], v15 offset:1536
    ds_read_b64_tr_b16 v[36:37], v15 offset:12288
    ds_read_b64_tr_b16 v[38:39], v15 offset:13824
    ds_read_b64_tr_b16 v[40:41], v16 offset:0
    ds_read_b64_tr_b16 v[42:43], v16 offset:1536
    ds_read_b64_tr_b16 v[44:45], v16 offset:12288
    ds_read_b64_tr_b16 v[46:47], v16 offset:13824
    ds_read_b64_tr_b16 v[48:49], v14 offset:24576
    ds_read_b64_tr_b16 v[50:51], v14 offset:26112
    ds_read_b64_tr_b16 v[52:53], v14 offset:36864
    ds_read_b64_tr_b16 v[54:55], v14 offset:38400
    ds_read_b64_tr_b16 v[56:57], v15 offset:24576
    ds_read_b64_tr_b16 v[58:59], v15 offset:26112
    ds_read_b64_tr_b16 v[60:61], v15 offset:36864
    ds_read_b64_tr_b16 v[62:63], v15 offset:38400
    ds_read_b64_tr_b16 v[64:65], v16 offset:24576
    ds_read_b64_tr_b16 v[66:67], v16 offset:26112
    ds_read_b64_tr_b16 v[68:69], v16 offset:36864
    ds_read_b64_tr_b16 v[70:71], v16 offset:38400
    s_branch PW_53
PWW_57:
    ds_read_b64_tr_b16 v[160:161], v14 offset:0
    ds_read_b64_tr_b16 v[162:163], v14 offset:1536
    ds_read_b64_tr_b16 v[164:165], v14 offset:12288
    ds_read_b64_tr_b16 v[166:167], v14 offset:13824
    ds_read_b64_tr_b16 v[168:169], v15 offset:0
    ds_read_b64_tr_b16 v[170:171], v15 offset:1536
    ds_read_b64_tr_b16 v[172:173], v15 offset:12288
    ds_read_b64_tr_b16 v[174:175], v15 offset:13824
    ds_read_b64_tr_b16 v[176:177], v16 offset:0
    ds_read_b64_tr_b16 v[178:179], v16 offset:1536
    ds_read_b64_tr_b16 v[180:181], v16 offset:12288
    ds_read_b64_tr_b16 v[182:183], v16 offset:13824
    ds_read_b64_tr_b16 v[184:185], v14 offset:24576
    ds_read_b64_tr_b16 v[186:187], v14 offset:26112
    ds_read_b64_tr_b16 v[188:189], v14 offset:36864
    ds_read_b64_tr_b16 v[190:191], v14 offset:38400
    ds_read_b64_tr_b16 v[192:193], v15 offset:24576
    ds_read_b64_tr_b16 v[194:195], v15 offset:26112
    ds_read_b64_tr_b16 v[196:197], v15 offset:36864
    ds_read_b64_tr_b16 v[198:199], v15 offset:38400
    ds_read_b64_tr_b16 v[200:201], v16 offset:24576
    ds_read_b64_tr_b16 v[202:203], v16 offset:26112
    ds_read_b64_tr_b16 v[204:205], v16 offset:36864
    ds_read_b64_tr_b16 v[206:207], v16 offset:38400
PW_53:
    v_add_u32 v14, 49152, v14
    v_add_u32 v15, 49152, v15
    v_add_u32 v16, 49152, v16
    s_waitcnt lgkmcnt(0)
    s_barrier
    s_add_u32 s44, s50, 7077888
    s_add_u32 m0, s51, 0
    s_nop 0
    buffer_load_dwordx4 v136, s[16:19], s44 offen  lds
    s_add_u32 m0, s51, 1024
    s_nop 0
    buffer_load_dwordx4 v137, s[16:19], s44 offen  lds
    s_add_u32 m0, s51, 2048
    s_nop 0
    buffer_load_dwordx4 v138, s[16:19], s44 offen  lds
    s_add_u32 s44, s50, 7176192
    s_add_u32 m0, s51, 3072
    v_xor_b32 v2, 64, v136
    buffer_load_dwordx4 v2, s[16:19], s44 offen  lds
    s_add_u32 m0, s51, 4096
    v_xor_b32 v2, 64, v137
    buffer_load_dwordx4 v2, s[16:19], s44 offen  lds
    s_add_u32 m0, s51, 5120
    v_xor_b32 v2, 64, v138
    buffer_load_dwordx4 v2, s[16:19], s44 offen  lds
    s_add_u32 s44, s50, 7077888
    s_add_u32 m0, s51, 24576
    s_nop 0
    buffer_load_dwordx4 v136, s[20:23], s44 offen  lds
    s_add_u32 m0, s51, 25600
    s_nop 0
    buffer_load_dwordx4 v137, s[20:23], s44 offen  lds
    s_add_u32 m0, s51, 26624
    s_nop 0
    buffer_load_dwordx4 v138, s[20:23], s44 offen  lds
    s_add_u32 s44, s50, 7176192
    s_add_u32 m0, s51, 27648
    v_xor_b32 v2, 64, v136
    buffer_load_dwordx4 v2, s[20:23], s44 offen  lds
    s_add_u32 m0, s51, 28672
    v_xor_b32 v2, 64, v137
    buffer_load_dwordx4 v2, s[20:23], s44 offen  lds
    s_add_u32 m0, s51, 29696
    v_xor_b32 v2, 64, v138
    buffer_load_dwordx4 v2, s[20:23], s44 offen  lds
    s_waitcnt vmcnt(24)
    s_barrier
    s_cmp_eq_u32 s34, 1
    s_cbranch_scc1 PWW_60
    s_cmp_eq_u32 s34, 2
    s_cbranch_scc1 PWW_61
    s_cmp_eq_u32 s34, 3
    s_cbranch_scc1 PWW_62
    ds_read_b64_tr_b16 v[128:129], v14 offset:0
    ds_read_b64_tr_b16 v[130:131], v14 offset:1536
    ds_read_b64_tr_b16 v[132:133], v14 offset:12288
    ds_read_b64_tr_b16 v[134:135], v14 offset:13824
    ds_read_b64_tr_b16 a[232:233], v15 offset:0
    ds_read_b64_tr_b16 a[234:235], v15 offset:1536
    ds_read_b64_tr_b16 a[236:237], v15 offset:12288
    ds_read_b64_tr_b16 a[238:239], v15 offset:13824
    ds_read_b64_tr_b16 a[240:241], v16 offset:0
    ds_read_b64_tr_b16 a[242:243], v16 offset:1536
    ds_read_b64_tr_b16 a[244:245], v16 offset:12288
    ds_read_b64_tr_b16 a[246:247], v16 offset:13824
    ds_read_b64_tr_b16 a[248:249], v14 offset:24576
    ds_read_b64_tr_b16 a[250:251], v14 offset:26112
    ds_read_b64_tr_b16 a[252:253], v14 offset:36864
    ds_read_b64_tr_b16 a[254:255], v14 offset:38400
    ds_read_b64_tr_b16 v[144:145], v15 offset:24576
    ds_read_b64_tr_b16 v[146:147], v15 offset:26112
    ds_read_b64_tr_b16 v[148:149], v15 offset:36864
    ds_read_b64_tr_b16 v[150:151], v15 offset:38400
    ds_read_b64_tr_b16 v[152:153], v16 offset:24576
    ds_read_b64_tr_b16 v[154:155], v16 offset:26112
    ds_read_b64_tr_b16 v[156:157], v16 offset:36864
    ds_read_b64_tr_b16 v[158:159], v16 offset:38400
    s_branch PW_58
PWW_60:
    ds_read_b64_tr_b16 a[136:137], v14 offset:0
    ds_read_b64_tr_b16 a[138:139], v14 offset:1536
    ds_read_b64_tr_b16 a[140:141], v14 offset:12288
    ds_read_b64_tr_b16 a[142:143], v14 offset:13824
    ds_read_b64_tr_b16 a[144:145], v15 offset:0
    ds_read_b64_tr_b16 a[146:147], v15 offset:1536
    ds_read_b64_tr_b16 a[148:149], v15 offset:12288
    ds_read_b64_tr_b16 a[150:151], v15 offset:13824
    ds_read_b64_tr_b16 a[152:153], v16 offset:0
    ds_read_b64_tr_b16 a[154:155], v16 offset:1536
    ds_read_b64_tr_b16 a[156:157], v16 offset:12288
    ds_read_b64_tr_b16 a[158:159], v16 offset:13824
    ds_read_b64_tr_b16 a[160:161], v14 offset:24576
    ds_read_b64_tr_b16 a[162:163], v14 offset:26112
    ds_read_b64_tr_b16 a[164:165], v14 offset:36864
    ds_read_b64_tr_b16 a[166:167], v14 offset:38400
    ds_read_b64_tr_b16 a[168:169], v15 offset:24576
    ds_read_b64_tr_b16 a[170:171], v15 offset:26112
    ds_read_b64_tr_b16 a[172:173], v15 offset:36864
    ds_read_b64_tr_b16 a[174:175], v15 offset:38400
    ds_read_b64_tr_b16 a[176:177], v16 offset:24576
    ds_read_b64_tr_b16 a[178:179], v16 offset:26112
    ds_read_b64_tr_b16 a[180:181], v16 offset:36864
    ds_read_b64_tr_b16 a[182:183], v16 offset:38400
    s_branch PW_58
PWW_61:
    ds_read_b64_tr_b16 v[72:73], v14 offset:0
    ds_read_b64_tr_b16 v[74:75], v14 offset:1536
    ds_read_b64_tr_b16 v[76:77], v14 offset:12288
    ds_read_b64_tr_b16 v[78:79], v14 offset:13824
    ds_read_b64_tr_b16 a[0:1], v15 offset:0
    ds_read_b64_tr_b16 a[2:3], v15 offset:1536
    ds_read_b64_tr_b16 a[4:5], v15 offset:12288
    ds_read_b64_tr_b16 a[6:7], v15 offset:13824
    ds_read_b64_tr_b16 a[8:9], v16 offset:0
    ds_read_b64_tr_b16 a[10:11], v16 offset:1536
    ds_read_b64_tr_b16 a[12:13], v16 offset:12288
    ds_read_b64_tr_b16 a[14:15], v16 offset:13824
    ds_read_b64_tr_b16 a[16:17], v14 offset:24576
    ds_read_b64_tr_b16 a[18:19], v14 offset:26112
    ds_read_b64_tr_b16 a[20:21], v14 offset:36864
    ds_read_b64_tr_b16 a[22:23], v14 offset:38400
    ds_read_b64_tr_b16 a[24:25], v15 offset:24576
    ds_read_b64_tr_b16 a[26:27], v15 offset:26112
    ds_read_b64_tr_b16 a[28:29], v15 offset:36864
    ds_read_b64_tr_b16 a[30:31], v15 offset:38400
    ds_read_b64_tr_b16 a[32:33], v16 offset:24576
    ds_read_b64_tr_b16 a[34:35], v16 offset:26112
    ds_read_b64_tr_b16 a[36:37], v16 offset:36864
    ds_read_b64_tr_b16 a[38:39], v16 offset:38400
    s_branch PW_58
PWW_62:
    ds_read_b64_tr_b16 v[208:209], v14 offset:0
    ds_read_b64_tr_b16 v[210:211], v14 offset:1536
    ds_read_b64_tr_b16 v[212:213], v14 offset:12288
    ds_read_b64_tr_b16 v[214:215], v14 offset:13824
    ds_read_b64_tr_b16 v[216:217], v15 offset:0
    ds_read_b64_tr_b16 v[218:219], v15 offset:1536
    ds_read_b64_tr_b16 v[220:221], v15 offset:12288
    ds_read_b64_tr_b16 v[222:223], v15 offset:13824
    ds_read_b64_tr_b16 v[224:225], v16 offset:0
    ds_read_b64_tr_b16 v[226:227], v16 offset:1536
    ds_read_b64_tr_b16 v[228:229], v16 offset:12288
    ds_read_b64_tr_b16 v[230:231], v16 offset:13824
    ds_read_b64_tr_b16 v[232:233], v14 offset:24576
    ds_read_b64_tr_b16 v[234:235], v14 offset:26112
    ds_read_b64_tr_b16 v[236:237], v14 offset:36864
    ds_read_b64_tr_b16 v[238:239], v14 offset:38400
    ds_read_b64_tr_b16 v[240:241], v15 offset:24576
    ds_read_b64_tr_b16 v[242:243], v15 offset:26112
    ds_read_b64_tr_b16 v[244:245], v15 offset:36864
    ds_read_b64_tr_b16 v[246:247], v15 offset:38400
    ds_read_b64_tr_b16 v[248:249], v16 offset:24576
    ds_read_b64_tr_b16 v[250:251], v16 offset:26112
    ds_read_b64_tr_b16 v[252:253], v16 offset:36864
    ds_read_b64_tr_b16 v[254:255], v16 offset:38400
PW_58:
    v_add_u32 v14, 49152, v14
    v_add_u32 v15, 49152, v15
    v_add_u32 v16, 49152, v16
    s_waitcnt vmcnt(12)
    s_barrier
    s_cmp_eq_u32 s34, 1
    s_cbranch_scc1 PWW_65
    s_cmp_eq_u32 s34, 2
    s_cbranch_scc1 PWW_66
    s_cmp_eq_u32 s34, 3
    s_cbranch_scc1 PWW_67
    ds_read_b64_tr_b16 v[160:161], v14 offset:0
    ds_read_b64_tr_b16 v[162:163], v14 offset:1536
    ds_read_b64_tr_b16 v[164:165], v14 offset:12288
    ds_read_b64_tr_b16 v[166:167], v14 offset:13824
    ds_read_b64_tr_b16 v[168:169], v15 offset:0
    ds_read_b64_tr_b16 v[170:171], v15 offset:1536
    ds_read_b64_tr_b16 v[172:173], v15 offset:12288
    ds_read_b64_tr_b16 v[174:175], v15 offset:13824
    ds_read_b64_tr_b16 v[176:177], v16 offset:0
    ds_read_b64_tr_b16 v[178:179], v16 offset:1536
    ds_read_b64_tr_b16 v[180:181], v16 offset:12288
    ds_read_b64_tr_b16 v[182:183], v16 offset:13824
    ds_read_b64_tr_b16 v[184:185], v14 offset:24576
    ds_read_b64_tr_b16 v[186:187], v14 offset:26112
    ds_read_b64_tr_b16 v[188:189], v14 offset:36864
    ds_read_b64_tr_b16 v[190:191], v14 offset:38400
    ds_read_b64_tr_b16 v[192:193], v15 offset:24576
    ds_read_b64_tr_b16 v[194:195], v15 offset:26112
    ds_read_b64_tr_b16 v[196:197], v15 offset:36864
    ds_read_b64_tr_b16 v[198:199], v15 offset:38400
    ds_read_b64_tr_b16 v[200:201], v16 offset:24576
    ds_read_b64_tr_b16 v[202:203], v16 offset:26112
    ds_read_b64_tr_b16 v[204:205], v16 offset:36864
    ds_read_b64_tr_b16 v[206:207], v16 offset:38400
    s_branch PW_63
PWW_65:
    ds_read_b64_tr_b16 v[80:81], v14 offset:0
    ds_read_b64_tr_b16 v[82:83], v14 offset:1536
    ds_read_b64_tr_b16 v[84:85], v14 offset:12288
    ds_read_b64_tr_b16 v[86:87], v14 offset:13824
    ds_read_b64_tr_b16 v[88:89], v15 offset:0
    ds_read_b64_tr_b16 v[90:91], v15 offset:1536
    ds_read_b64_tr_b16 v[92:93], v15 offset:12288
    ds_read_b64_tr_b16 v[94:95], v15 offset:13824
    ds_read_b64_tr_b16 v[96:97], v16 offset:0
    ds_read_b64_tr_b16 v[98:99], v16 offset:1536
    ds_read_b64_tr_b16 v[100:101], v16 offset:12288
    ds_read_b64_tr_b16 v[102:103], v16 offset:13824
    ds_read_b64_tr_b16 a[184:185], v14 offset:24576
    ds_read_b64_tr_b16 a[186:187], v14 offset:26112
    ds_read_b64_tr_b16 a[188:189], v14 offset:36864
    ds_read_b64_tr_b16 a[190:191], v14 offset:38400
    ds_read_b64_tr_b16 a[192:193], v15 offset:24576
    ds_read_b64_tr_b16 a[194:195], v15 offset:26112
    ds_read_b64_tr_b16 a[196:197], v15 offset:36864
    ds_read_b64_tr_b16 a[198:199], v15 offset:38400
    ds_read_b64_tr_b16 a[200:201], v16 offset:24576
    ds_read_b64_tr_b16 a[202:203], v16 offset:26112
    ds_read_b64_tr_b16 a[204:205], v16 offset:36864
    ds_read_b64_tr_b16 a[206:207], v16 offset:38400
    s_branch PW_63
PWW_66:
    ds_read_b64_tr_b16 a[40:41], v14 offset:0
    ds_read_b64_tr_b16 a[42:43], v14 offset:1536
    ds_read_b64_tr_b16 a[44:45], v14 offset:12288
    ds_read_b64_tr_b16 a[46:47], v14 offset:13824
    ds_read_b64_tr_b16 a[48:49], v15 offset:0
    ds_read_b64_tr_b16 a[50:51], v15 offset:1536
    ds_read_b64_tr_b16 a[52:53], v15 offset:12288
    ds_read_b64_tr_b16 a[54:55], v15 offset:13824
    ds_read_b64_tr_b16 a[56:57], v16 offset:0
    ds_read_b64_tr_b16 a[58:59], v16 offset:1536
    ds_read_b64_tr_b16 a[60:61], v16 offset:12288
    ds_read_b64_tr_b16 a[62:63], v16 offset:13824
    ds_read_b64_tr_b16 a[64:65], v14 offset:24576
    ds_read_b64_tr_b16 a[66:67], v14 offset:26112
    ds_read_b64_tr_b16 a[68:69], v14 offset:36864
    ds_read_b64_tr_b16 a[70:71], v14 offset:38400
    ds_read_b64_tr_b16 a[72:73], v15 offset:24576
    ds_read_b64_tr_b16 a[74:75], v15 offset:26112
    ds_read_b64_tr_b16 a[76:77], v15 offset:36864
    ds_read_b64_tr_b16 a[78:79], v15 offset:38400
    ds_read_b64_tr_b16 a[80:81], v16 offset:24576
    ds_read_b64_tr_b16 a[82:83], v16 offset:26112
    ds_read_b64_tr_b16 a[84:85], v16 offset:36864
    ds_read_b64_tr_b16 a[86:87], v16 offset:38400
    s_branch PW_63
PWW_67:
    ds_read_b64_tr_b16 v[24:25], v14 offset:0
    ds_read_b64_tr_b16 v[26:27], v14 offset:1536
    ds_read_b64_tr_b16 v[28:29], v14 offset:12288
    ds_read_b64_tr_b16 v[30:31], v14 offset:13824
    ds_read_b64_tr_b16 v[32:33], v15 offset:0
    ds_read_b64_tr_b16 v[34:35], v15 offset:1536
    ds_read_b64_tr_b16 v[36:37], v15 offset:12288
    ds_read_b64_tr_b16 v[38:39], v15 offset:13824
    ds_read_b64_tr_b16 v[40:41], v16 offset:0
    ds_read_b64_tr_b16 v[42:43], v16 offset:1536
    ds_read_b64_tr_b16 v[44:45], v16 offset:12288
    ds_read_b64_tr_b16 v[46:47], v16 offset:13824
    ds_read_b64_tr_b16 v[48:49], v14 offset:24576
    ds_read_b64_tr_b16 v[50:51], v14 offset:26112
    ds_read_b64_tr_b16 v[52:53], v14 offset:36864
    ds_read_b64_tr_b16 v[54:55], v14 offset:38400
    ds_read_b64_tr_b16 v[56:57], v15 offset:24576
    ds_read_b64_tr_b16 v[58:59], v15 offset:26112
    ds_read_b64_tr_b16 v[60:61], v15 offset:36864
    ds_read_b64_tr_b16 v[62:63], v15 offset:38400
    ds_read_b64_tr_b16 v[64:65], v16 offset:24576
    ds_read_b64_tr_b16 v[66:67], v16 offset:26112
    ds_read_b64_tr_b16 v[68:69], v16 offset:36864
    ds_read_b64_tr_b16 v[70:71], v16 offset:38400
PW_63:
    v_add_u32 v14, -98304, v14
    v_add_u32 v15, -98304, v15
    v_add_u32 v16, -98304, v16
    s_waitcnt vmcnt(0)
    s_barrier
    s_cmp_eq_u32 s34, 1
    s_cbranch_scc1 PWW_70
    s_cmp_eq_u32 s34, 2
    s_cbranch_scc1 PWW_71
    s_cmp_eq_u32 s34, 3
    s_cbranch_scc1 PWW_72
    ds_read_b64_tr_b16 v[208:209], v14 offset:0
    ds_read_b64_tr_b16 v[210:211], v14 offset:1536
    ds_read_b64_tr_b16 v[212:213], v14 offset:12288
    ds_read_b64_tr_b16 v[214:215], v14 offset:13824
    ds_read_b64_tr_b16 v[216:217], v15 offset:0
    ds_read_b64_tr_b16 v[218:219], v15 offset:1536
    ds_read_b64_tr_b16 v[220:221], v15 offset:12288
    ds_read_b64_tr_b16 v[222:223], v15 offset:13824
    ds_read_b64_tr_b16 v[224:225], v16 offset:0
    ds_read_b64_tr_b16 v[226:227], v16 offset:1536
    ds_read_b64_tr_b16 v[228:229], v16 offset:12288
    ds_read_b64_tr_b16 v[230:231], v16 offset:13824
    ds_read_b64_tr_b16 v[232:233], v14 offset:24576
    ds_read_b64_tr_b16 v[234:235], v14 offset:26112
    ds_read_b64_tr_b16 v[236:237], v14 offset:36864
    ds_read_b64_tr_b16 v[238:239], v14 offset:38400
    ds_read_b64_tr_b16 v[240:241], v15 offset:24576
    ds_read_b64_tr_b16 v[242:243], v15 offset:26112
    ds_read_b64_tr_b16 v[244:245], v15 offset:36864
    ds_read_b64_tr_b16 v[246:247], v15 offset:38400
    ds_read_b64_tr_b16 v[248:249], v16 offset:24576
    ds_read_b64_tr_b16 v[250:251], v16 offset:26112
    ds_read_b64_tr_b16 v[252:253], v16 offset:36864
    ds_read_b64_tr_b16 v[254:255], v16 offset:38400
    s_branch PW_68
PWW_70:
    ds_read_b64_tr_b16 v[104:105], v14 offset:0
    ds_read_b64_tr_b16 v[106:107], v14 offset:1536
    ds_read_b64_tr_b16 v[108:109], v14 offset:12288
    ds_read_b64_tr_b16 v[110:111], v14 offset:13824
    ds_read_b64_tr_b16 v[112:113], v15 offset:0
    ds_read_b64_tr_b16 v[114:115], v15 offset:1536
    ds_read_b64_tr_b16 v[116:117], v15 offset:12288
    ds_read_b64_tr_b16 v[118:119], v15 offset:13824
    ds_read_b64_tr_b16 v[120:121], v16 offset:0
    ds_read_b64_tr_b16 v[122:123], v16 offset:1536
    ds_read_b64_tr_b16 v[124:125], v16 offset:12288
    ds_read_b64_tr_b16 v[126:127], v16 offset:13824
    ds_read_b64_tr_b16 a[208:209], v14 offset:24576
    ds_read_b64_tr_b16 a[210:211], v14 offset:26112
    ds_read_b64_tr_b16 a[212:213], v14 offset:36864
    ds_read_b64_tr_b16 a[214:215], v14 offset:38400
    ds_read_b64_tr_b16 a[216:217], v15 offset:24576
    ds_read_b64_tr_b16 a[218:219], v15 offset:26112
    ds_read_b64_tr_b16 a[220:221], v15 offset:36864
    ds_read_b64_tr_b16 a[222:223], v15 offset:38400
    ds_read_b64_tr_b16 a[224:225], v16 offset:24576
    ds_read_b64_tr_b16 a[226:227], v16 offset:26112
    ds_read_b64_tr_b16 a[228:229], v16 offset:36864
    ds_read_b64_tr_b16 a[230:231], v16 offset:38400
    s_branch PW_68
PWW_71:
    ds_read_b64_tr_b16 a[88:89], v14 offset:0
    ds_read_b64_tr_b16 a[90:91], v14 offset:1536
    ds_read_b64_tr_b16 a[92:93], v14 offset:12288
    ds_read_b64_tr_b16 a[94:95], v14 offset:13824
    ds_read_b64_tr_b16 a[96:97], v15 offset:0
    ds_read_b64_tr_b16 a[98:99], v15 offset:1536
    ds_read_b64_tr_b16 a[100:101], v15 offset:12288
    ds_read_b64_tr_b16 a[102:103], v15 offset:13824
    ds_read_b64_tr_b16 a[104:105], v16 offset:0
    ds_read_b64_tr_b16 a[106:107], v16 offset:1536
    ds_read_b64_tr_b16 a[108:109], v16 offset:12288
    ds_read_b64_tr_b16 a[110:111], v16 offset:13824
    ds_read_b64_tr_b16 a[112:113], v14 offset:24576
    ds_read_b64_tr_b16 a[114:115], v14 offset:26112
    ds_read_b64_tr_b16 a[116:117], v14 offset:36864
    ds_read_b64_tr_b16 a[118:119], v14 offset:38400
    ds_read_b64_tr_b16 a[120:121], v15 offset:24576
    ds_read_b64_tr_b16 a[122:123], v15 offset:26112
    ds_read_b64_tr_b16 a[124:125], v15 offset:36864
    ds_read_b64_tr_b16 a[126:127], v15 offset:38400
    ds_read_b64_tr_b16 a[128:129], v16 offset:24576
    ds_read_b64_tr_b16 a[130:131], v16 offset:26112
    ds_read_b64_tr_b16 a[132:133], v16 offset:36864
    ds_read_b64_tr_b16 a[134:135], v16 offset:38400
    s_branch PW_68
PWW_72:
    ds_read_b64_tr_b16 v[72:73], v14 offset:0
    ds_read_b64_tr_b16 v[74:75], v14 offset:1536
    ds_read_b64_tr_b16 v[76:77], v14 offset:12288
    ds_read_b64_tr_b16 v[78:79], v14 offset:13824
    ds_read_b64_tr_b16 a[0:1], v15 offset:0
    ds_read_b64_tr_b16 a[2:3], v15 offset:1536
    ds_read_b64_tr_b16 a[4:5], v15 offset:12288
    ds_read_b64_tr_b16 a[6:7], v15 offset:13824
    ds_read_b64_tr_b16 a[8:9], v16 offset:0
    ds_read_b64_tr_b16 a[10:11], v16 offset:1536
    ds_read_b64_tr_b16 a[12:13], v16 offset:12288
    ds_read_b64_tr_b16 a[14:15], v16 offset:13824
    ds_read_b64_tr_b16 a[16:17], v14 offset:24576
    ds_read_b64_tr_b16 a[18:19], v14 offset:26112
    ds_read_b64_tr_b16 a[20:21], v14 offset:36864
    ds_read_b64_tr_b16 a[22:23], v14 offset:38400
    ds_read_b64_tr_b16 a[24:25], v15 offset:24576
    ds_read_b64_tr_b16 a[26:27], v15 offset:26112
    ds_read_b64_tr_b16 a[28:29], v15 offset:36864
    ds_read_b64_tr_b16 a[30:31], v15 offset:38400
    ds_read_b64_tr_b16 a[32:33], v16 offset:24576
    ds_read_b64_tr_b16 a[34:35], v16 offset:26112
    ds_read_b64_tr_b16 a[36:37], v16 offset:36864
    ds_read_b64_tr_b16 a[38:39], v16 offset:38400
PW_68:
    v_add_u32 v14, 49152, v14
    v_add_u32 v15, 49152, v15
    v_add_u32 v16, 49152, v16
    s_waitcnt lgkmcnt(0)
    s_barrier
    s_mul_i32 s44, s40, 40960
    s_lshl_b32 s46, s34, 10
    s_add_u32 s46, s46, 114688
    s_add_u32 m0, s46, 0
    s_nop 0
    buffer_load_dwordx4 v11, s[24:27], s44 offen  lds
    s_add_u32 m0, s46, 4096
    s_add_u32 s44, s44, 128
    buffer_load_dwordx4 v11, s[24:27], s44 offen  lds
    s_add_u32 m0, s46, 8192
    s_add_u32 s44, s44, 128
    buffer_load_dwordx4 v11, s[24:27], s44 offen  lds
    s_add_u32 m0, s46, 12288
    s_add_u32 s44, s44, 128
    buffer_load_dwordx4 v11, s[24:27], s44 offen  lds
    s_add_u32 m0, s46, 16384
    s_add_u32 s44, s44, 128
    buffer_load_dwordx4 v11, s[24:27], s44 offen  lds
    s_add_u32 m0, s46, 20480
    s_add_u32 s44, s44, 128
    buffer_load_dwordx4 v11, s[24:27], s44 offen  lds
    s_add_u32 m0, s46, 24576
    s_add_u32 s44, s44, 128
    buffer_load_dwordx4 v11, s[24:27], s44 offen  lds
    s_add_u32 m0, s46, 28672
    s_add_u32 s44, s44, 128
    buffer_load_dwordx4 v11, s[24:27], s44 offen  lds
    s_add_u32 m0, s46, 32768
    s_add_u32 s44, s44, 128
    buffer_load_dwordx4 v11, s[24:27], s44 offen  lds
    s_add_u32 m0, s46, 36864
    s_add_u32 s44, s44, 128
    buffer_load_dwordx4 v11, s[24:27], s44 offen  lds
    ds_write_b128 v10, v[24:27] offset:0
    ds_write_b128 v10, v[28:31] offset:1024
    ds_write_b128 v10, v[32:35] offset:2048
    ds_write_b128 v10, v[36:39] offset:3072
    ds_write_b128 v10, v[40:43] offset:4096
    ds_write_b128 v10, v[44:47] offset:5120
    ds_write_b128 v10, v[48:51] offset:6144
    ds_write_b128 v10, v[52:55] offset:7168
    ds_write_b128 v10, v[56:59] offset:8192
    ds_write_b128 v10, v[60:63] offset:9216
    ds_write_b128 v10, v[64:67] offset:10240
    ds_write_b128 v10, v[68:71] offset:11264
    ds_write_b128 v10, v[72:75] offset:12288
    ds_write_b128 v10, v[76:79] offset:13312
    ds_write_b128 v10, v[80:83] offset:14336
    ds_write_b128 v10, v[84:87] offset:15360
    ds_write_b128 v10, v[88:91] offset:16384
    ds_write_b128 v10, v[92:95] offset:17408
    ds_write_b128 v10, v[96:99] offset:18432
    ds_write_b128 v10, v[100:103] offset:19456
    ds_write_b128 v10, v[104:107] offset:20480
    ds_write_b128 v10, v[108:111] offset:21504
    ds_write_b128 v10, v[112:115] offset:22528
    ds_write_b128 v10, v[116:119] offset:23552
    ds_write_b128 v10, v[120:123] offset:24576
    ds_write_b128 v10, v[124:127] offset:25600
    ds_write_b128 v10, v[128:131] offset:26624
    ds_write_b128 v10, v[132:135] offset:27648
    s_waitcnt vmcnt(10) lgkmcnt(0)
    v_and_b32 v2, 15, v1
    v_lshrrev_b32 v3, 4, v1
    v_lshlrev_b32 v4, 2, v3
    v_lshl_add_u32 v14, v2, 4, v4
    s_mul_i32 s44, s34, 768
    s_add_u32 s44, s44, 155648
    s_mov_b32 s58, s44
    v_add_u32 v14, s44, v14
    v_and_b32 v4, 1, v1
    v_lshlrev_b32 v4, 3, v4
    v_lshrrev_b32 v5, 2, v1
    v_lshl_add_u32 v15, v5, 4, v4
    v_add_u32 v15, 155648, v15
    s_lshl_b32 s44, s34, 10
    s_add_u32 s44, s44, 114688
    v_add_u32 v16, s44, v12
    s_and_b32 s45, s34, 1
    s_lshr_b32 s44, s34, 1
    s_lshl_b32 s44, s44, 10
    s_lshl_b32 s46, s45, 3
    s_add_u32 s44, s44, s46
    s_add_u32 s59, s44, 118784
    v_lshrrev_b32 v4, 1, v3
    v_lshlrev_b32 v4, 4, v4
    v_and_b32 v5, 7, v1
    v_lshl_add_u32 v4, v5, 1, v4
    v_bfe_u32 v5, v1, 3, 1
    v_add_u32 v4, v4, v5
    v_lshlrev_b32 v4, 4, v4
    v_and_b32 v5, 1, v3
    v_lshl_add_u32 v17, v5, 3, v4
    v_and_b32 v4, 8, v1
    v_cmp_ne_u32 s[88:89], 0, v4
    v_cmp_le_u32 s[90:91], 32, v1
    v_lshlrev_b32 v4, 4, v2
    v_lshl_add_u32 v4, v5, 3, v4
    v_lshrrev_b32 v5, 1, v3
    v_lshl_add_u32 v18, v5, 2, v4
    s_lshl_b32 s45, s45, 4
    v_lshlrev_b32 v4, 2, v3
    v_sub_u32 v19, v2, v4
    v_add_u32 v19, s45, v19
    s_mov_b32 s62, 0x3dd53b95
    s_mov_b32 s35, s40
    s_mov_b32 s42, 0
    v_mov_b32 v3, 128
WST_73:
    buffer_load_dwordx2 v[4:5], v3, s[12:15], 0 offen sc1
    s_waitcnt vmcnt(0)
    v_readfirstlane_b32 s44, v4
    v_readfirstlane_b32 s39, v5
    s_cmp_lg_u32 s44, 0
    s_cbranch_scc1 WSO_74
    s_sleep 4
    s_add_u32 s42, s42, 1
    s_cmp_lt_u32 s42, s37
    s_cbranch_scc1 WST_73
    s_mov_b32 s37, 1
WSO_74:
    s_cmp_lg_u32 s100, 0
    s_cbranch_scc1 WSE_76
    s_cmp_eq_u32 s44, 2
    s_cbranch_scc1 L_fallback
WSE_76:
    s_mul_i32 s44, s40, 0x11111111
    s_xor_b32 s39, s39, s44
    s_xor_b32 s39, s39, 0x11111111
    s_lshl_b32 s63, s34, 14
    s_lshl_b32 s44, s41, 7
    s_add_u32 s63, s63, s44
    s_lshl_b32 s44, s33, 2
    s_add_u32 s63, s63, s44
    s_add_u32 s63, s63, 1835008
    s_lshr_b32 s43, s63, 19
    s_and_b32 s43, s43, 28
    s_lshr_b32 s43, s39, s43
    s_and_b32 s43, s43, 1
    s_lshl_b32 s43, s43, 13
    s_add_u32 s63, s63, s43
    s_cmp_eq_u32 s33, 0
    s_cselect_b32 s92, 0x3ff, 0
    s_mov_b32 s93, 0
    s_lshr_b32 s43, s35, 1
    s_add_u32 s43, s43, 3
    s_bfe_u32 s53, s43, 0x10001
    s_lshl_b32 s53, s53, 21
    s_and_b32 s43, s43, 1
    s_mul_i32 s43, s43, 262144
    s_add_u32 s53, s53, s43
    s_add_u32 s53, s53, s61
    s_lshr_b32 s43, s53, 19
    s_and_b32 s43, s43, 28
    s_lshr_b32 s43, s39, s43
    s_and_b32 s43, s43, 1
    s_lshl_b32 s43, s43, 13
    s_add_u32 s53, s53, s43
    v_lshlrev_b32 v6, 9, v1
    v_mov_b32 v7, 0
    s_mov_b64 s[64:65], 0
    s_waitcnt vmcnt(0)
L_S_loop:
    s_barrier
    s_lshl_b32 s95, s85, 12
    v_add_u32 v4, s95, v0
    v_xor_b32 v5, 64, v4
    ds_read_b128 v[72:75], v4 offset:8192
    ds_read_b128 v[76:79], v4 offset:10240
    s_waitcnt lgkmcnt(0)
    v_mfma_f32_16x16x32_bf16 v[24:27], a[40:43], v[72:75], 0
    ds_read_b128 v[80:83], v5 offset:8192
    v_mfma_f32_16x16x32_bf16 v[28:31], a[40:43], v[76:79], 0
    ds_read_b128 v[84:87], v5 offset:10240
    v_mfma_f32_16x16x32_bf16 v[32:35], a[48:51], v[72:75], 0
    v_mfma_f32_16x16x32_bf16 v[36:39], a[48:51], v[76:79], 0
    ds_read_b128 v[88:91], v10 offset:14336
    v_mfma_f32_16x16x32_bf16 v[40:43], a[56:59], v[72:75], 0
    v_mfma_f32_16x16x32_bf16 v[44:47], a[56:59], v[76:79], 0
    ds_read_b128 v[92:95], v10 offset:15360
    v_mfma_f32_16x16x32_bf16 v[48:51], a[64:67], v[72:75], 0
    v_mfma_f32_16x16x32_bf16 v[52:55], a[64:67], v[76:79], 0
    ds_read_b128 v[96:99], v10 offset:16384
    v_mfma_f32_16x16x32_bf16 v[56:59], a[72:75], v[72:75], 0
    v_mfma_f32_16x16x32_bf16 v[60:63], a[72:75], v[76:79], 0
    ds_read_b128 v[100:103], v10 offset:17408
    v_mfma_f32_16x16x32_bf16 v[64:67], a[80:83], v[72:75], 0
    v_mfma_f32_16x16x32_bf16 v[68:71], a[80:83], v[76:79], 0
    s_waitcnt lgkmcnt(4)
    v_mfma_f32_16x16x32_bf16 v[24:27], a[44:47], v[80:83], v[24:27]
    ds_read_b128 v[72:75], v4 offset:12288
    v_mfma_f32_16x16x32_bf16 v[28:31], a[44:47], v[84:87], v[28:31]
    ds_read_b128 v[76:79], v4 offset:14336
    v_mfma_f32_16x16x32_bf16 v[32:35], a[52:55], v[80:83], v[32:35]
    v_mfma_f32_16x16x32_bf16 v[36:39], a[52:55], v[84:87], v[36:39]
    ds_read_b128 v[104:107], v10 offset:18432
    v_mfma_f32_16x16x32_bf16 v[40:43], a[60:63], v[80:83], v[40:43]
    v_mfma_f32_16x16x32_bf16 v[44:47], a[60:63], v[84:87], v[44:47]
    ds_read_b128 v[108:111], v10 offset:19456
    v_mfma_f32_16x16x32_bf16 v[48:51], a[68:71], v[80:83], v[48:51]
    v_mfma_f32_16x16x32_bf16 v[52:55], a[68:71], v[84:87], v[52:55]
    ds_read_b128 v[112:115], v10 offset:20480
    v_mfma_f32_16x16x32_bf16 v[56:59], a[76:79], v[80:83], v[56:59]
    v_mfma_f32_16x16x32_bf16 v[60:63], a[76:79], v[84:87], v[60:63]
    ds_read_b128 v[116:119], v10 offset:21504
    v_mfma_f32_16x16x32_bf16 v[64:67], a[84:87], v[80:83], v[64:67]
    v_mfma_f32_16x16x32_bf16 v[68:71], a[84:87], v[84:87], v[68:71]
    s_waitcnt lgkmcnt(4)
    v_mfma_f32_16x16x32_bf16 v[24:27], a[88:91], v[72:75], v[24:27]
    ds_read_b128 v[80:83], v5 offset:12288
    v_mfma_f32_16x16x32_bf16 v[28:31], a[88:91], v[76:79], v[28:31]
    ds_read_b128 v[84:87], v5 offset:14336
    v_mfma_f32_16x16x32_bf16 v[32:35], a[96:99], v[72:75], v[32:35]
    v_mfma_f32_16x16x32_bf16 v[36:39], a[96:99], v[76:79], v[36:39]
    ds_read_b128 v[120:123], v10 offset:22528
    v_mfma_f32_16x16x32_bf16 v[40:43], a[104:107], v[72:75], v[40:43]
    v_mfma_f32_16x16x32_bf16 v[44:47], a[104:107], v[76:79], v[44:47]
    ds_read_b128 v[124:127], v10 offset:23552
    v_mfma_f32_16x16x32_bf16 v[48:51], a[112:115], v[72:75], v[48:51]
    v_mfma_f32_16x16x32_bf16 v[52:55], a[112:115], v[76:79], v[52:55]
    ds_read_b128 v[128:131], v10 offset:24576
    v_mfma_f32_16x16x32_bf16 v[56:59], a[120:123], v[72:75], v[56:59]
    v_mfma_f32_16x16x32_bf16 v[60:63], a[120:123], v[76:79], v[60:63]
    ds_read_b128 v[132:135], v10 offset:25600
    v_mfma_f32_16x16x32_bf16 v[64:67], a[128:131], v[72:75], v[64:67]
    v_mfma_f32_16x16x32_bf16 v[68:71], a[128:131], v[76:79], v[68:71]
    s_waitcnt lgkmcnt(4)
    v_mfma_f32_16x16x32_bf16 v[24:27], a[92:95], v[80:83], v[24:27]
    s_lshl_b32 s95, s86, 12
    v_add_u32 v4, s95, v0
    v_xor_b32 v5, 64, v4
    ds_read_b128 v[72:75], v4 offset:16384
    v_mfma_f32_16x16x32_bf16 v[28:31], a[92:95], v[84:87], v[28:31]
    ds_read_b128 v[76:79], v4 offset:18432
    v_mfma_f32_16x16x32_bf16 v[32:35], a[100:103], v[80:83], v[32:35]
    v_mfma_f32_16x16x32_bf16 v[36:39], a[100:103], v[84:87], v[36:39]
    ds_read_b128 v[136:139], v10 offset:26624
    v_mfma_f32_16x16x32_bf16 v[40:43], a[108:111], v[80:83], v[40:43]
    v_mfma_f32_16x16x32_bf16 v[44:47], a[108:111], v[84:87], v[44:47]
    ds_read_b128 v[140:143], v10 offset:27648
    v_mfma_f32_16x16x32_bf16 v[48:51], a[116:119], v[80:83], v[48:51]
    v_mfma_f32_16x16x32_bf16 v[52:55], a[116:119], v[84:87], v[52:55]
    v_mfma_f32_16x16x32_bf16 v[56:59], a[124:127], v[80:83], v[56:59]
    v_mfma_f32_16x16x32_bf16 v[60:63], a[124:127], v[84:87], v[60:63]
    v_mfma_f32_16x16x32_bf16 v[64:67], a[132:135], v[80:83], v[64:67]
    v_mfma_f32_16x16x32_bf16 v[68:71], a[132:135], v[84:87], v[68:71]
    s_waitcnt vmcnt(0)
    s_mov_b64 exec, s[64:65]
    buffer_store_dword v7, v6, s[8:11], s60 offen sc1
    s_mov_b64 exec, -1
    s_waitcnt lgkmcnt(2)
    v_mfma_f32_16x16x32_bf16 v[24:27], a[136:139], v[72:75], v[24:27]
    ds_read_b128 v[80:83], v5 offset:16384
    v_mfma_f32_16x16x32_bf16 v[28:31], a[136:139], v[76:79], v[28:31]
    ds_read_b128 v[84:87], v5 offset:18432
    v_mfma_f32_16x16x32_bf16 v[32:35], a[144:147], v[72:75], v[32:35]
    v_mfma_f32_16x16x32_bf16 v[36:39], a[144:147], v[76:79], v[36:39]
    v_mfma_f32_16x16x32_bf16 v[40:43], a[152:155], v[72:75], v[40:43]
    v_mfma_f32_16x16x32_bf16 v[44:47], a[152:155], v[76:79], v[44:47]
    v_mfma_f32_16x16x32_bf16 v[48:51], a[160:163], v[72:75], v[48:51]
    v_mfma_f32_16x16x32_bf16 v[52:55], a[160:163], v[76:79], v[52:55]
    v_mfma_f32_16x16x32_bf16 v[56:59], a[168:171], v[72:75], v[56:59]
    v_mfma_f32_16x16x32_bf16 v[60:63], a[168:171], v[76:79], v[60:63]
    v_mfma_f32_16x16x32_bf16 v[64:67], a[176:179], v[72:75], v[64:67]
    v_mfma_f32_16x16x32_bf16 v[68:71], a[176:179], v[76:79], v[68:71]
    s_waitcnt lgkmcnt(0)
    v_mfma_f32_16x16x32_bf16 v[24:27], a[140:143], v[80:83], v[24:27]
    ds_read_b128 v[72:75], v4 offset:20480
    v_mfma_f32_16x16x32_bf16 v[28:31], a[140:143], v[84:87], v[28:31]
    ds_read_b128 v[76:79], v4 offset:22528
    v_mfma_f32_16x16x32_bf16 v[32:35], a[148:151], v[80:83], v[32:35]
    v_mfma_f32_16x16x32_bf16 v[36:39], a[148:151], v[84:87], v[36:39]
    v_mfma_f32_16x16x32_bf16 v[40:43], a[156:159], v[80:83], v[40:43]
    v_mfma_f32_16x16x32_bf16 v[44:47], a[156:159], v[84:87], v[44:47]
    v_mfma_f32_16x16x32_bf16 v[48:51], a[164:167], v[80:83], v[48:51]
    v_mfma_f32_16x16x32_bf16 v[52:55], a[164:167], v[84:87], v[52:55]
    v_mfma_f32_16x16x32_bf16 v[56:59], a[172:175], v[80:83], v[56:59]
    v_mfma_f32_16x16x32_bf16 v[60:63], a[172:175], v[84:87], v[60:63]
    v_mfma_f32_16x16x32_bf16 v[64:67], a[180:183], v[80:83], v[64:67]
    v_mfma_f32_16x16x32_bf16 v[68:71], a[180:183], v[84:87], v[68:71]
    s_waitcnt lgkmcnt(0)
    v_mfma_f32_16x16x32_bf16 v[24:27], v[88:91], v[72:75], v[24:27]
    ds_read_b128 v[80:83], v5 offset:20480
    v_mfma_f32_16x16x32_bf16 v[28:31], v[88:91], v[76:79], v[28:31]
    ds_read_b128 v[84:87], v5 offset:22528
    v_mfma_f32_16x16x32_bf16 v[32:35], v[96:99], v[72:75], v[32:35]
    v_mfma_f32_16x16x32_bf16 v[36:39], v[96:99], v[76:79], v[36:39]
    v_mfma_f32_16x16x32_bf16 v[40:43], v[104:107], v[72:75], v[40:43]
    v_mfma_f32_16x16x32_bf16 v[44:47], v[104:107], v[76:79], v[44:47]
    v_mfma_f32_16x16x32_bf16 v[48:51], a[184:187], v[72:75], v[48:51]
    v_mfma_f32_16x16x32_bf16 v[52:55], a[184:187], v[76:79], v[52:55]
    v_mfma_f32_16x16x32_bf16 v[56:59], a[192:195], v[72:75], v[56:59]
    v_mfma_f32_16x16x32_bf16 v[60:63], a[192:195], v[76:79], v[60:63]
    v_mfma_f32_16x16x32_bf16 v[64:67], a[200:203], v[72:75], v[64:67]
    v_mfma_f32_16x16x32_bf16 v[68:71], a[200:203], v[76:79], v[68:71]
    s_waitcnt lgkmcnt(0)
    v_mfma_f32_16x16x32_bf16 v[24:27], v[92:95], v[80:83], v[24:27]
    ds_read_b128 v[72:75], v4 offset:24576
    v_mfma_f32_16x16x32_bf16 v[28:31], v[92:95], v[84:87], v[28:31]
    ds_read_b128 v[76:79], v4 offset:26624
    v_mfma_f32_16x16x32_bf16 v[32:35], v[100:103], v[80:83], v[32:35]
    v_mfma_f32_16x16x32_bf16 v[36:39], v[100:103], v[84:87], v[36:39]
    v_mfma_f32_16x16x32_bf16 v[40:43], v[108:111], v[80:83], v[40:43]
    v_mfma_f32_16x16x32_bf16 v[44:47], v[108:111], v[84:87], v[44:47]
    v_mfma_f32_16x16x32_bf16 v[48:51], a[188:191], v[80:83], v[48:51]
    v_mfma_f32_16x16x32_bf16 v[52:55], a[188:191], v[84:87], v[52:55]
    v_mfma_f32_16x16x32_bf16 v[56:59], a[196:199], v[80:83], v[56:59]
    v_mfma_f32_16x16x32_bf16 v[60:63], a[196:199], v[84:87], v[60:63]
    v_mfma_f32_16x16x32_bf16 v[64:67], a[204:207], v[80:83], v[64:67]
    v_mfma_f32_16x16x32_bf16 v[68:71], a[204:207], v[84:87], v[68:71]
    s_waitcnt lgkmcnt(0)
    v_mfma_f32_16x16x32_bf16 v[24:27], v[112:115], v[72:75], v[24:27]
    ds_read_b128 v[80:83], v5 offset:24576
    v_mfma_f32_16x16x32_bf16 v[28:31], v[112:115], v[76:79], v[28:31]
    ds_read_b128 v[84:87], v5 offset:26624
    v_mfma_f32_16x16x32_bf16 v[32:35], v[120:123], v[72:75], v[32:35]
    v_mfma_f32_16x16x32_bf16 v[36:39], v[120:123], v[76:79], v[36:39]
    v_mfma_f32_16x16x32_bf16 v[40:43], v[128:131], v[72:75], v[40:43]
    v_mfma_f32_16x16x32_bf16 v[44:47], v[128:131], v[76:79], v[44:47]
    v_mfma_f32_16x16x32_bf16 v[48:51], a[208:211], v[72:75], v[48:51]
    v_mfma_f32_16x16x32_bf16 v[52:55], a[208:211], v[76:79], v[52:55]
    v_mfma_f32_16x16x32_bf16 v[56:59], a[216:219], v[72:75], v[56:59]
    v_mfma_f32_16x16x32_bf16 v[60:63], a[216:219], v[76:79], v[60:63]
    v_mfma_f32_16x16x32_bf16 v[64:67], a[224:227], v[72:75], v[64:67]
    v_mfma_f32_16x16x32_bf16 v[68:71], a[224:227], v[76:79], v[68:71]
    s_waitcnt lgkmcnt(0)
    v_mfma_f32_16x16x32_bf16 v[24:27], v[116:119], v[80:83], v[24:27]
    s_lshl_b32 s95, s87, 12
    v_add_u32 v4, s95, v0
    v_xor_b32 v5, 64, v4
    ds_read_b128 v[72:75], v4 offset:28672
    v_mfma_f32_16x16x32_bf16 v[28:31], v[116:119], v[84:87], v[28:31]
    ds_read_b128 v[76:79], v4 offset:30720
    v_mfma_f32_16x16x32_bf16 v[32:35], v[124:127], v[80:83], v[32:35]
    v_mfma_f32_16x16x32_bf16 v[36:39], v[124:127], v[84:87], v[36:39]
    v_mfma_f32_16x16x32_bf16 v[40:43], v[132:135], v[80:83], v[40:43]
    v_mfma_f32_16x16x32_bf16 v[44:47], v[132:135], v[84:87], v[44:47]
    v_mfma_f32_16x16x32_bf16 v[48:51], a[212:215], v[80:83], v[48:51]
    v_mfma_f32_16x16x32_bf16 v[52:55], a[212:215], v[84:87], v[52:55]
    v_mfma_f32_16x16x32_bf16 v[56:59], a[220:223], v[80:83], v[56:59]
    v_mfma_f32_16x16x32_bf16 v[60:63], a[220:223], v[84:87], v[60:63]
    v_mfma_f32_16x16x32_bf16 v[64:67], a[228:231], v[80:83], v[64:67]
    v_mfma_f32_16x16x32_bf16 v[68:71], a[228:231], v[84:87], v[68:71]
    s_mov_b32 exec_hi, 0xff
    buffer_store_dwordx4 v[20:23], v12, s[8:11], s53 offen sc1
    s_mov_b64 exec, -1
    s_waitcnt lgkmcnt(0)
    v_mfma_f32_16x16x32_bf16 v[24:27], v[136:139], v[72:75], v[24:27]
    ds_read_b128 v[80:83], v5 offset:28672
    v_mfma_f32_16x16x32_bf16 v[28:31], v[136:139], v[76:79], v[28:31]
    ds_read_b128 v[84:87], v5 offset:30720
    v_mfma_f32_16x16x32_bf16 v[32:35], a[232:235], v[72:75], v[32:35]
    s_lshr_b32 s43, s35, 1
    v_mfma_f32_16x16x32_bf16 v[36:39], a[232:235], v[76:79], v[36:39]
    s_add_u32 s43, s43, 0
    v_mfma_f32_16x16x32_bf16 v[40:43], a[240:243], v[72:75], v[40:43]
    s_bfe_u32 s52, s43, 0x10001
    v_mfma_f32_16x16x32_bf16 v[44:47], a[240:243], v[76:79], v[44:47]
    s_lshl_b32 s52, s52, 21
    v_mfma_f32_16x16x32_bf16 v[48:51], a[248:251], v[72:75], v[48:51]
    s_and_b32 s43, s43, 1
    v_mfma_f32_16x16x32_bf16 v[52:55], a[248:251], v[76:79], v[52:55]
    s_mul_i32 s43, s43, 262144
    v_mfma_f32_16x16x32_bf16 v[56:59], v[144:147], v[72:75], v[56:59]
    s_add_u32 s52, s52, s43
    v_mfma_f32_16x16x32_bf16 v[60:63], v[144:147], v[76:79], v[60:63]
    s_add_u32 s52, s52, s61
    v_mfma_f32_16x16x32_bf16 v[64:67], v[152:155], v[72:75], v[64:67]
    s_lshr_b32 s43, s52, 19
    v_mfma_f32_16x16x32_bf16 v[68:71], v[152:155], v[76:79], v[68:71]
    s_and_b32 s43, s43, 28
    s_waitcnt lgkmcnt(0)
    v_mfma_f32_16x16x32_bf16 v[24:27], v[140:143], v[80:83], v[24:27]
    ds_read_b128 v[72:75], v4 offset:32768
    v_mfma_f32_16x16x32_bf16 v[28:31], v[140:143], v[84:87], v[28:31]
    ds_read_b128 v[76:79], v4 offset:34816
    v_mfma_f32_16x16x32_bf16 v[32:35], a[236:239], v[80:83], v[32:35]
    s_lshr_b32 s43, s39, s43
    v_mfma_f32_16x16x32_bf16 v[36:39], a[236:239], v[84:87], v[36:39]
    s_and_b32 s43, s43, 1
    v_mfma_f32_16x16x32_bf16 v[40:43], a[244:247], v[80:83], v[40:43]
    s_lshl_b32 s43, s43, 13
    v_mfma_f32_16x16x32_bf16 v[44:47], a[244:247], v[84:87], v[44:47]
    s_add_u32 s52, s52, s43
    v_mfma_f32_16x16x32_bf16 v[48:51], a[252:255], v[80:83], v[48:51]
    s_lshr_b32 s43, s35, 1
    v_mfma_f32_16x16x32_bf16 v[52:55], a[252:255], v[84:87], v[52:55]
    s_add_u32 s43, s43, 3
    v_mfma_f32_16x16x32_bf16 v[56:59], v[148:151], v[80:83], v[56:59]
    s_bfe_u32 s53, s43, 0x10001
    v_mfma_f32_16x16x32_bf16 v[60:63], v[148:151], v[84:87], v[60:63]
    s_lshl_b32 s53, s53, 21
    v_mfma_f32_16x16x32_bf16 v[64:67], v[156:159], v[80:83], v[64:67]
    s_and_b32 s43, s43, 1
    v_mfma_f32_16x16x32_bf16 v[68:71], v[156:159], v[84:87], v[68:71]
    s_mul_i32 s43, s43, 262144
    s_waitcnt lgkmcnt(0)
    v_mfma_f32_16x16x32_bf16 v[24:27], v[160:163], v[72:75], v[24:27]
    ds_read_b128 v[80:83], v5 offset:32768
    v_mfma_f32_16x16x32_bf16 v[28:31], v[160:163], v[76:79], v[28:31]
    ds_read_b128 v[84:87], v5 offset:34816
    v_mfma_f32_16x16x32_bf16 v[32:35], v[168:171], v[72:75], v[32:35]
    s_add_u32 s53, s53, s43
    v_mfma_f32_16x16x32_bf16 v[36:39], v[168:171], v[76:79], v[36:39]
    s_add_u32 s53, s53, s61
    ds_read_b128 v[88:91], v10 offset:0
    v_mfma_f32_16x16x32_bf16 v[40:43], v[176:179], v[72:75], v[40:43]
    s_lshr_b32 s43, s53, 19
    v_mfma_f32_16x16x32_bf16 v[44:47], v[176:179], v[76:79], v[44:47]
    s_and_b32 s43, s43, 28
    ds_read_b128 v[92:95], v10 offset:1024
    v_mfma_f32_16x16x32_bf16 v[48:51], v[184:187], v[72:75], v[48:51]
    s_lshr_b32 s43, s39, s43
    v_mfma_f32_16x16x32_bf16 v[52:55], v[184:187], v[76:79], v[52:55]
    s_and_b32 s43, s43, 1
    ds_read_b128 v[96:99], v10 offset:2048
    v_mfma_f32_16x16x32_bf16 v[56:59], v[192:195], v[72:75], v[56:59]
    s_lshl_b32 s43, s43, 13
    v_mfma_f32_16x16x32_bf16 v[60:63], v[192:195], v[76:79], v[60:63]
    s_add_u32 s53, s53, s43
    ds_read_b128 v[100:103], v10 offset:3072
    v_mfma_f32_16x16x32_bf16 v[64:67], v[200:203], v[72:75], v[64:67]
    s_add_u32 s44, s35, 1
    v_mfma_f32_16x16x32_bf16 v[68:71], v[200:203], v[76:79], v[68:71]
    v_mov_b32 v7, s44
    s_waitcnt lgkmcnt(4)
    v_mfma_f32_16x16x32_bf16 v[24:27], v[164:167], v[80:83], v[24:27]
    ds_read_b128 v[72:75], v4 offset:36864
    v_mfma_f32_16x16x32_bf16 v[28:31], v[164:167], v[84:87], v[28:31]
    ds_read_b128 v[76:79], v4 offset:38912
    v_mfma_f32_16x16x32_bf16 v[32:35], v[172:175], v[80:83], v[32:35]
    s_lshr_b32 s44, s35, 1
    v_mfma_f32_16x16x32_bf16 v[36:39], v[172:175], v[84:87], v[36:39]
    s_and_b32 s44, s44, 3
    ds_read_b128 v[104:107], v10 offset:4096
    v_mfma_f32_16x16x32_bf16 v[40:43], v[180:183], v[80:83], v[40:43]
    s_mul_i32 s44, s44, 10240
    v_mfma_f32_16x16x32_bf16 v[44:47], v[180:183], v[84:87], v[44:47]
    s_mul_i32 s47, s32, 40960
    ds_read_b128 v[108:111], v10 offset:5120
    v_mfma_f32_16x16x32_bf16 v[48:51], v[188:191], v[80:83], v[48:51]
    s_add_u32 s47, s47, s44
    v_mfma_f32_16x16x32_bf16 v[52:55], v[188:191], v[84:87], v[52:55]
    s_add_u32 s47, s47, 14680064
    ds_read_b128 v[112:115], v10 offset:6144
    v_mfma_f32_16x16x32_bf16 v[56:59], v[196:199], v[80:83], v[56:59]
    s_lshl_b32 s44, s85, 10
    v_mfma_f32_16x16x32_bf16 v[60:63], v[196:199], v[84:87], v[60:63]
    s_add_u32 s48, s47, s44
    ds_read_b128 v[116:119], v10 offset:7168
    v_mfma_f32_16x16x32_bf16 v[64:67], v[204:207], v[80:83], v[64:67]
    s_lshl_b32 s44, s84, 10
    v_mfma_f32_16x16x32_bf16 v[68:71], v[204:207], v[84:87], v[68:71]
    s_add_u32 s47, s47, s44
    s_waitcnt lgkmcnt(4)
    v_mfma_f32_16x16x32_bf16 v[24:27], v[208:211], v[72:75], v[24:27]
    ds_read_b128 v[80:83], v5 offset:36864
    v_mfma_f32_16x16x32_bf16 v[28:31], v[208:211], v[76:79], v[28:31]
    ds_read_b128 v[84:87], v5 offset:38912
    v_mfma_f32_16x16x32_bf16 v[32:35], v[216:219], v[72:75], v[32:35]
    s_not_b64 s[66:67], s[88:89]
    v_mfma_f32_16x16x32_bf16 v[36:39], v[216:219], v[76:79], v[36:39]
    s_add_u32 s54, s52, 131072
    ds_read_b128 v[120:123], v10 offset:8192
    v_mfma_f32_16x16x32_bf16 v[40:43], v[224:227], v[72:75], v[40:43]
    s_and_b32 s45, s34, 1
    v_mfma_f32_16x16x32_bf16 v[44:47], v[224:227], v[76:79], v[44:47]
    s_mul_i32 s55, s45, 6144
    ds_read_b128 v[124:127], v10 offset:9216
    v_mfma_f32_16x16x32_bf16 v[48:51], v[232:235], v[72:75], v[48:51]
    s_and_b32 s44, s35, 3
    v_mfma_f32_16x16x32_bf16 v[52:55], v[232:235], v[76:79], v[52:55]
    s_lshl_b32 s44, s44, 5
    ds_read_b128 v[128:131], v10 offset:10240
    v_mfma_f32_16x16x32_bf16 v[56:59], v[240:243], v[72:75], v[56:59]
    s_add_u32 s44, s44, s36
    v_mfma_f32_16x16x32_bf16 v[60:63], v[240:243], v[76:79], v[60:63]
    s_mul_i32 s44, s44, 2560
    ds_read_b128 v[132:135], v10 offset:11264
    v_mfma_f32_16x16x32_bf16 v[64:67], v[248:251], v[72:75], v[64:67]
    s_add_u32 s44, s44, 15728640
    v_mfma_f32_16x16x32_bf16 v[68:71], v[248:251], v[76:79], v[68:71]
    s_lshl_b32 s50, s45, 10
    s_waitcnt lgkmcnt(4)
    v_mfma_f32_16x16x32_bf16 v[24:27], v[212:215], v[80:83], v[24:27]
    s_lshl_b32 s95, s84, 12
    v_add_u32 v4, s95, v0
    v_xor_b32 v5, 64, v4
    ds_read_b128 v[72:75], v4 offset:0
    v_mfma_f32_16x16x32_bf16 v[28:31], v[212:215], v[84:87], v[28:31]
    ds_read_b128 v[76:79], v4 offset:2048
    v_mfma_f32_16x16x32_bf16 v[32:35], v[220:223], v[80:83], v[32:35]
    s_add_u32 s50, s50, s44
    v_mfma_f32_16x16x32_bf16 v[36:39], v[220:223], v[84:87], v[36:39]
    s_lshl_b32 s51, s45, 8
    ds_read_b128 v[136:139], v10 offset:12288
    v_mfma_f32_16x16x32_bf16 v[40:43], v[228:231], v[80:83], v[40:43]
    s_add_u32 s51, s51, s44
    v_mfma_f32_16x16x32_bf16 v[44:47], v[228:231], v[84:87], v[44:47]
    s_add_u32 s56, s35, 2
    ds_read_b128 v[140:143], v10 offset:13312
    v_mfma_f32_16x16x32_bf16 v[48:51], v[236:239], v[80:83], v[48:51]
    s_min_u32 s56, s56, 63
    v_mfma_f32_16x16x32_bf16 v[52:55], v[236:239], v[84:87], v[52:55]
    s_mul_i32 s56, s56, 40960
    v_mfma_f32_16x16x32_bf16 v[56:59], v[244:247], v[80:83], v[56:59]
    s_lshl_b32 s49, s33, 2
    v_mfma_f32_16x16x32_bf16 v[60:63], v[244:247], v[84:87], v[60:63]
    s_add_u32 s49, s49, s34
    v_mfma_f32_16x16x32_bf16 v[64:67], v[252:255], v[80:83], v[64:67]
    s_mul_i32 s49, s49, 1280
    v_mfma_f32_16x16x32_bf16 v[68:71], v[252:255], v[84:87], v[68:71]
    s_add_u32 s49, s49, s56
    s_waitcnt lgkmcnt(2)
    v_mfma_f32_16x16x32_bf16 v[24:27], v[88:91], v[72:75], v[24:27]
    ds_read_b128 v[80:83], v5 offset:0
    v_mfma_f32_16x16x32_bf16 v[28:31], v[88:91], v[76:79], v[28:31]
    ds_read_b128 v[84:87], v5 offset:2048
    v_mfma_f32_16x16x32_bf16 v[32:35], v[96:99], v[72:75], v[32:35]
    v_lshlrev_b32 v2, 3, v12
    v_mfma_f32_16x16x32_bf16 v[36:39], v[96:99], v[76:79], v[36:39]
    s_lshl_b32 s57, s45, 11
    v_mfma_f32_16x16x32_bf16 v[40:43], v[104:107], v[72:75], v[40:43]
    s_add_u32 s57, s57, 114688
    v_mfma_f32_16x16x32_bf16 v[44:47], v[104:107], v[76:79], v[44:47]
    s_lshl_b32 s45, s45, 1
    v_mfma_f32_16x16x32_bf16 v[48:51], v[112:115], v[72:75], v[48:51]
    s_sub_u32 s45, s45, s34
    v_mfma_f32_16x16x32_bf16 v[52:55], v[112:115], v[76:79], v[52:55]
    s_mul_i32 s45, s45, 10240
    v_mfma_f32_16x16x32_bf16 v[56:59], v[120:123], v[72:75], v[56:59]
    s_add_u32 s56, s56, s45
    v_mfma_f32_16x16x32_bf16 v[60:63], v[120:123], v[76:79], v[60:63]
    v_mfma_f32_16x16x32_bf16 v[64:67], v[128:131], v[72:75], v[64:67]
    v_mfma_f32_16x16x32_bf16 v[68:71], v[128:131], v[76:79], v[68:71]
    s_waitcnt lgkmcnt(0)
    v_mfma_f32_16x16x32_bf16 v[24:27], v[92:95], v[80:83], v[24:27]
    ds_read_b128 v[72:75], v4 offset:4096
    v_mfma_f32_16x16x32_bf16 v[28:31], v[92:95], v[84:87], v[28:31]
    ds_read_b128 v[76:79], v4 offset:6144
    v_mfma_f32_16x16x32_bf16 v[32:35], v[100:103], v[80:83], v[32:35]
    v_mfma_f32_16x16x32_bf16 v[36:39], v[100:103], v[84:87], v[36:39]
    v_mfma_f32_16x16x32_bf16 v[40:43], v[108:111], v[80:83], v[40:43]
    v_mfma_f32_16x16x32_bf16 v[44:47], v[108:111], v[84:87], v[44:47]
    v_mfma_f32_16x16x32_bf16 v[48:51], v[116:119], v[80:83], v[48:51]
    v_mfma_f32_16x16x32_bf16 v[52:55], v[116:119], v[84:87], v[52:55]
    v_mfma_f32_16x16x32_bf16 v[56:59], v[124:127], v[80:83], v[56:59]
    v_mfma_f32_16x16x32_bf16 v[60:63], v[124:127], v[84:87], v[60:63]
    v_mfma_f32_16x16x32_bf16 v[64:67], v[132:135], v[80:83], v[64:67]
    v_mfma_f32_16x16x32_bf16 v[68:71], v[132:135], v[84:87], v[68:71]
    s_mov_b64 exec, 0x3ff
    buffer_load_dword v2, v2, s[24:27], s49 offen
    s_mov_b64 exec, -1
    s_waitcnt lgkmcnt(0)
    v_mfma_f32_16x16x32_bf16 v[24:27], v[136:139], v[72:75], v[24:27]
    ds_read_b128 v[80:83], v5 offset:4096
    v_mfma_f32_16x16x32_bf16 v[28:31], v[136:139], v[76:79], v[28:31]
    ds_read_b128 v[84:87], v5 offset:6144
    v_mfma_f32_16x16x32_bf16 v[32:35], a[0:3], v[72:75], v[32:35]
    v_add_u32 v3, s59, v12
    v_mfma_f32_16x16x32_bf16 v[36:39], a[0:3], v[76:79], v[36:39]
    v_mfma_f32_16x16x32_bf16 v[40:43], a[8:11], v[72:75], v[40:43]
    v_mfma_f32_16x16x32_bf16 v[44:47], a[8:11], v[76:79], v[44:47]
    v_mfma_f32_16x16x32_bf16 v[48:51], a[16:19], v[72:75], v[48:51]
    v_mfma_f32_16x16x32_bf16 v[52:55], a[16:19], v[76:79], v[52:55]
    s_waitcnt lgkmcnt(0)
    s_barrier
    v_mfma_f32_16x16x32_bf16 v[24:27], v[140:143], v[80:83], v[24:27]
    v_mfma_f32_16x16x32_bf16 v[28:31], v[140:143], v[84:87], v[28:31]
    v_mfma_f32_16x16x32_bf16 v[32:35], a[4:7], v[80:83], v[32:35]
    v_mfma_f32_16x16x32_bf16 v[36:39], a[4:7], v[84:87], v[36:39]
    v_mfma_f32_16x16x32_bf16 v[40:43], a[12:15], v[80:83], v[40:43]
    v_mfma_f32_16x16x32_bf16 v[44:47], a[12:15], v[84:87], v[44:47]
    v_mfma_f32_16x16x32_bf16 v[56:59], a[24:27], v[72:75], v[56:59]
    v_mfma_f32_16x16x32_bf16 v[60:63], a[24:27], v[76:79], v[60:63]
    v_mfma_f32_16x16x32_bf16 v[64:67], a[32:35], v[72:75], v[64:67]
    v_cvt_pk_bf16_f32 v24, v24, v25
    v_cvt_pk_bf16_f32 v25, v26, v27
    v_mfma_f32_16x16x32_bf16 v[68:71], a[32:35], v[76:79], v[68:71]
    v_cvt_pk_bf16_f32 v26, v32, v33
    v_cvt_pk_bf16_f32 v27, v34, v35
    v_mfma_f32_16x16x32_bf16 v[48:51], a[20:23], v[80:83], v[48:51]
    v_cvt_pk_bf16_f32 v28, v28, v29
    v_cvt_pk_bf16_f32 v29, v30, v31
    v_mfma_f32_16x16x32_bf16 v[52:55], a[20:23], v[84:87], v[52:55]
    v_cvt_pk_bf16_f32 v30, v36, v37
    v_cvt_pk_bf16_f32 v31, v38, v39
    v_mfma_f32_16x16x32_bf16 v[56:59], a[28:31], v[80:83], v[56:59]
    ds_write_b128 v16, v[24:27] offset:0
    v_cvt_pk_bf16_f32 v40, v40, v41
    v_mfma_f32_16x16x32_bf16 v[60:63], a[28:31], v[84:87], v[60:63]
    v_cvt_pk_bf16_f32 v41, v42, v43
    ds_write_b128 v16, v[28:31] offset:6144
    v_mfma_f32_16x16x32_bf16 v[64:67], a[36:39], v[80:83], v[64:67]
    v_cvt_pk_bf16_f32 v44, v44, v45
    v_cvt_pk_bf16_f32 v45, v46, v47
    v_mfma_f32_16x16x32_bf16 v[68:71], a[36:39], v[84:87], v[68:71]
    ds_write_b64 v3, v[40:41] offset:0
    ds_write_b64 v3, v[44:45] offset:6144
    v_mov_b32 v72, 0
    v_mov_b32 v73, 0
    v_mov_b32 v74, 0
    v_mov_b32 v75, 0
    v_mov_b32 v76, 0
    v_mov_b32 v77, 0
    v_mov_b32 v78, 0
    v_mov_b32 v79, 0
    s_waitcnt lgkmcnt(0)
    s_mov_b32 s42, 0
    buffer_load_dwordx4 v[24:27], v12, s[8:11], s47 offen offset:0 sc1
    buffer_load_dwordx4 v[28:31], v12, s[8:11], s47 offen offset:1024 sc1
    buffer_load_dwordx4 v[32:35], v12, s[8:11], s48 offen offset:2048 sc1
    v_cvt_pk_bf16_f32 v48, v48, v49
    v_cvt_pk_bf16_f32 v49, v50, v51
    v_cvt_pk_bf16_f32 v50, v56, v57
    v_cvt_pk_bf16_f32 v51, v58, v59
    v_cvt_pk_bf16_f32 v64, v64, v65
    v_cvt_pk_bf16_f32 v65, v66, v67
    ds_write_b128 v16, v[48:51] offset:12288
    ds_write_b64 v3, v[64:65] offset:12288
    v_cvt_pk_bf16_f32 v52, v52, v53
    v_cvt_pk_bf16_f32 v53, v54, v55
    v_cvt_pk_bf16_f32 v54, v60, v61
    v_cvt_pk_bf16_f32 v55, v62, v63
    v_cvt_pk_bf16_f32 v68, v68, v69
    v_cvt_pk_bf16_f32 v69, v70, v71
    ds_write_b128 v16, v[52:55] offset:18432
    ds_write_b64 v3, v[68:69] offset:18432
    v_mov_b32 v80, 0
    v_mov_b32 v81, 0
    v_mov_b32 v82, 0
    v_mov_b32 v83, 0
    v_mov_b32 v84, 0
    v_mov_b32 v85, 0
    v_mov_b32 v86, 0
    v_mov_b32 v87, 0
    v_mov_b32 v66, 0
    v_mov_b32 v67, 0
    v_mov_b32 v70, 0
    v_mov_b32 v71, 0
    s_waitcnt lgkmcnt(0)
    v_mov_b32 v64, 0
    v_mov_b32 v65, 0
    v_mov_b32 v68, 0
    v_mov_b32 v69, 0
    s_lshl_b32 s44, s84, 10
    s_add_u32 s44, s44, 139264
    v_add_u32 v3, s44, v12
    s_lshl_b32 s44, s85, 10
    s_add_u32 s44, s44, 139264
    v_add_u32 v4, s44, v12
    s_lshl_b32 s44, s86, 10
    s_add_u32 s44, s44, 139264
    v_add_u32 v5, s44, v12
    s_lshl_b32 s44, s87, 10
    s_add_u32 s44, s44, 139264
    v_add_u32 v8, s44, v12
    s_branch PM_77_e
PM_77:
    buffer_load_dwordx4 v[24:27], v12, s[8:11], s47 offen offset:0 sc1
    buffer_load_dwordx4 v[28:31], v12, s[8:11], s47 offen offset:1024 sc1
    buffer_load_dwordx4 v[32:35], v12, s[8:11], s48 offen offset:2048 sc1
PM_77_e:
    s_add_u32 s42, s42, 1
    s_cmp_gt_u32 s42, s37
    s_cselect_b32 s37, 0, s37
    s_cselect_b32 s98, -1, -2
    s_waitcnt vmcnt(2)
    v_max3_u32 v2, v24, v25, v26
    v_max_u32 v2, v2, v27
    s_waitcnt vmcnt(1)
    v_max3_u32 v2, v2, v28, v29
    v_max3_u32 v2, v2, v30, v31
    s_waitcnt vmcnt(0)
    v_max3_u32 v2, v2, v32, v33
    v_max3_u32 v2, v2, v34, v35
    v_cmp_lt_u32 vcc, s98, v2
    s_cbranch_vccnz PM_77
PMO_78:
    v_smfmac_f32_16x16x64_bf16 v[64:67], v[24:27], v[88:95], v9
    ds_write_b128 v3, v[24:27] offset:0
    v_smfmac_f32_16x16x64_bf16 v[68:71], v[24:27], v[96:103], v9
    ds_write_b128 v3, v[28:31] offset:1024
    v_smfmac_f32_16x16x64_bf16 v[72:75], v[24:27], v[104:111], v9
    ds_write_b128 v4, v[32:35] offset:2048
    v_smfmac_f32_16x16x64_bf16 v[76:79], v[24:27], v[112:119], v9
    v_smfmac_f32_16x16x64_bf16 v[80:83], v[24:27], v[120:127], v9
    v_smfmac_f32_16x16x64_bf16 v[84:87], v[24:27], v[128:135], v9
    v_smfmac_f32_16x16x64_bf16 v[64:67], v[28:31], v[136:143], v9
    v_smfmac_f32_16x16x64_bf16 v[68:71], v[28:31], a[0:7], v9
    v_smfmac_f32_16x16x64_bf16 v[72:75], v[28:31], a[8:15], v9
    s_waitcnt lgkmcnt(0)
    s_barrier
    ds_read_b128 v[36:39], v4 offset:3072
    ds_read_b128 v[40:43], v5 offset:4096
    v_smfmac_f32_16x16x64_bf16 v[76:79], v[28:31], a[16:23], v9
    ds_read_b128 v[56:59], v8 offset:8192
    v_smfmac_f32_16x16x64_bf16 v[80:83], v[28:31], a[24:31], v9
    ds_read_b128 v[60:63], v8 offset:9216
    v_smfmac_f32_16x16x64_bf16 v[84:87], v[28:31], a[32:39], v9
    ds_read_b128 v[44:47], v5 offset:5120
    v_smfmac_f32_16x16x64_bf16 v[64:67], v[32:35], a[40:47], v9
    ds_read_b128 v[48:51], v5 offset:6144
    v_smfmac_f32_16x16x64_bf16 v[68:71], v[32:35], a[48:55], v9
    ds_read_b128 v[52:55], v8 offset:7168
    v_smfmac_f32_16x16x64_bf16 v[72:75], v[32:35], a[56:63], v9
    ds_read_b128 v[88:91], v10 offset:14336
    v_smfmac_f32_16x16x64_bf16 v[76:79], v[32:35], a[64:71], v9
    ds_read_b128 v[92:95], v10 offset:15360
    v_smfmac_f32_16x16x64_bf16 v[80:83], v[32:35], a[72:79], v9
    ds_read_b128 v[96:99], v10 offset:16384
    v_smfmac_f32_16x16x64_bf16 v[84:87], v[32:35], a[80:87], v9
    ds_read_b128 v[100:103], v10 offset:17408
    s_waitcnt lgkmcnt(10)
    v_smfmac_f32_16x16x64_bf16 v[64:67], v[36:39], a[88:95], v9
    ds_read_b128 v[104:107], v10 offset:18432
    v_smfmac_f32_16x16x64_bf16 v[68:71], v[36:39], a[96:103], v9
    ds_read_b128 v[108:111], v10 offset:19456
    v_smfmac_f32_16x16x64_bf16 v[72:75], v[36:39], a[104:111], v9
    ds_read_b128 v[112:115], v10 offset:20480
    s_waitcnt lgkmcnt(12)
    v_smfmac_f32_16x16x64_bf16 v[64:67], v[40:43], a[136:143], v9
    ds_read_b128 v[116:119], v10 offset:21504
    v_smfmac_f32_16x16x64_bf16 v[68:71], v[40:43], a[144:151], v9
    ds_read_b128 v[120:123], v10 offset:22528
    v_smfmac_f32_16x16x64_bf16 v[72:75], v[40:43], a[152:159], v9
    ds_read_b128 v[124:127], v10 offset:23552
    s_waitcnt lgkmcnt(14)
    v_smfmac_f32_16x16x64_bf16 v[64:67], v[56:59], v[160:167], v9
    ds_read_b128 v[128:131], v10 offset:24576
    v_smfmac_f32_16x16x64_bf16 v[68:71], v[56:59], v[168:175], v9
    ds_read_b128 v[132:135], v10 offset:25600
    v_smfmac_f32_16x16x64_bf16 v[72:75], v[56:59], v[176:183], v9
    ds_read_b128 v[136:139], v10 offset:26624
    s_waitcnt lgkmcnt(15)
    v_smfmac_f32_16x16x64_bf16 v[64:67], v[60:63], v[208:215], v9
    ds_read_b128 v[140:143], v10 offset:27648
    v_smfmac_f32_16x16x64_bf16 v[68:71], v[60:63], v[216:223], v9
    v_smfmac_f32_16x16x64_bf16 v[72:75], v[60:63], v[224:231], v9
    s_waitcnt lgkmcnt(12)
    v_smfmac_f32_16x16x64_bf16 v[64:67], v[44:47], v[88:95], v9
    s_waitcnt lgkmcnt(10)
    v_smfmac_f32_16x16x64_bf16 v[68:71], v[44:47], v[96:103], v9
    s_waitcnt lgkmcnt(8)
    v_smfmac_f32_16x16x64_bf16 v[72:75], v[44:47], v[104:111], v9
    s_waitcnt lgkmcnt(6)
    v_smfmac_f32_16x16x64_bf16 v[64:67], v[48:51], v[112:119], v9
    s_waitcnt lgkmcnt(4)
    v_smfmac_f32_16x16x64_bf16 v[68:71], v[48:51], v[120:127], v9
    s_waitcnt lgkmcnt(2)
    v_smfmac_f32_16x16x64_bf16 v[72:75], v[48:51], v[128:135], v9
    s_waitcnt lgkmcnt(0)
    v_smfmac_f32_16x16x64_bf16 v[64:67], v[52:55], v[136:143], v9
    ds_read_b128 v[88:91], v13 offset:12288
    v_smfmac_f32_16x16x64_bf16 v[68:71], v[52:55], a[232:239], v9
    ds_read_b128 v[112:115], v13 offset:18432
    v_smfmac_f32_16x16x64_bf16 v[72:75], v[52:55], a[240:247], v9
    ds_read_b128 v[92:95], v13 offset:13312
    v_smfmac_f32_16x16x64_bf16 v[76:79], v[36:39], a[112:119], v9
    ds_read_b128 v[116:119], v13 offset:19456
    v_smfmac_f32_16x16x64_bf16 v[80:83], v[36:39], a[120:127], v9
    ds_read_b128 v[96:99], v13 offset:14336
    v_add_f32 v64, v64, v65
    v_smfmac_f32_16x16x64_bf16 v[84:87], v[36:39], a[128:135], v9
    ds_read_b128 v[120:123], v13 offset:20480
    v_add_f32 v66, v66, v67
    v_smfmac_f32_16x16x64_bf16 v[76:79], v[40:43], a[160:167], v9
    ds_read_b128 v[100:103], v13 offset:15360
    v_cvt_pk_bf16_f32 v64, v64, v66
    v_smfmac_f32_16x16x64_bf16 v[80:83], v[40:43], a[168:175], v9
    ds_write_b32 v14, v64 offset:0
    v_add_f32 v68, v68, v69
    v_smfmac_f32_16x16x64_bf16 v[84:87], v[40:43], a[176:183], v9
    ds_read_b128 v[124:127], v13 offset:21504
    v_add_f32 v70, v70, v71
    v_smfmac_f32_16x16x64_bf16 v[76:79], v[44:47], a[184:191], v9
    ds_read_b128 v[104:107], v13 offset:16384
    v_cvt_pk_bf16_f32 v68, v68, v70
    v_smfmac_f32_16x16x64_bf16 v[80:83], v[44:47], a[192:199], v9
    ds_write_b32 v14, v68 offset:256
    v_add_f32 v72, v72, v73
    v_smfmac_f32_16x16x64_bf16 v[84:87], v[44:47], a[200:207], v9
    ds_read_b128 v[128:131], v13 offset:22528
    v_add_f32 v74, v74, v75
    v_smfmac_f32_16x16x64_bf16 v[76:79], v[48:51], a[208:215], v9
    ds_read_b128 v[108:111], v13 offset:17408
    v_cvt_pk_bf16_f32 v72, v72, v74
    v_smfmac_f32_16x16x64_bf16 v[80:83], v[48:51], a[216:223], v9
    ds_write_b32 v14, v72 offset:512
    v_smfmac_f32_16x16x64_bf16 v[84:87], v[48:51], a[224:231], v9
    ds_read_b128 v[132:135], v13 offset:23552
    v_smfmac_f32_16x16x64_bf16 v[76:79], v[52:55], a[248:255], v9
    v_smfmac_f32_16x16x64_bf16 v[76:79], v[56:59], v[184:191], v9
    v_smfmac_f32_16x16x64_bf16 v[76:79], v[60:63], v[232:239], v9
    s_cmp_ge_u32 s34, 2
    s_waitcnt lgkmcnt(1)
    s_barrier
    s_cbranch_scc1 L_S_b
    ds_read_b64_tr_b16 v[24:25], v15 offset:0
    ds_read_b64_tr_b16 v[26:27], v15 offset:256
    v_smfmac_f32_16x16x64_bf16 v[80:83], v[52:55], v[144:151], v9
    ds_read_b64_tr_b16 v[28:29], v15 offset:768
    ds_read_b64_tr_b16 v[30:31], v15 offset:1024
    v_smfmac_f32_16x16x64_bf16 v[80:83], v[56:59], v[192:199], v9
    ds_read_b64_tr_b16 v[32:33], v15 offset:1536
    ds_read_b64_tr_b16 v[34:35], v15 offset:1792
    v_smfmac_f32_16x16x64_bf16 v[80:83], v[60:63], v[240:247], v9
    ds_read_b64_tr_b16 v[64:65], v15 offset:2304
    ds_read_b64_tr_b16 v[66:67], v15 offset:2560
    v_add_f32 v76, v76, v77
    v_smfmac_f32_16x16x64_bf16 v[84:87], v[52:55], v[152:159], v9
    ds_read_b64_tr_b16 v[68:69], v15 offset:512
    ds_read_b64_tr_b16 v[70:71], v15 offset:1280
    v_add_f32 v78, v78, v79
    v_smfmac_f32_16x16x64_bf16 v[84:87], v[56:59], v[200:207], v9
    ds_read_b64_tr_b16 v[72:73], v15 offset:2048
    ds_read_b64_tr_b16 v[74:75], v15 offset:2816
    v_cvt_pk_bf16_f32 v76, v76, v78
    v_smfmac_f32_16x16x64_bf16 v[84:87], v[60:63], v[248:255], v9
    ds_write_b32 v14, v76 offset:3072
    v_add_f32 v80, v80, v81
    s_waitcnt lgkmcnt(13)
    s_waitcnt lgkmcnt(11)
    v_mfma_f32_16x16x32_bf16 v[136:139], v[88:91], v[24:27], 0
    v_add_f32 v82, v82, v83
    v_cvt_pk_bf16_f32 v80, v80, v82
    v_mfma_f32_16x16x32_bf16 v[140:143], v[112:115], v[24:27], 0
    ds_write_b32 v14, v80 offset:3328
    v_add_f32 v84, v84, v85
    v_add_f32 v86, v86, v87
    s_waitcnt lgkmcnt(10)
    v_mfma_f32_16x16x32_bf16 v[136:139], v[92:95], v[28:31], v[136:139]
    v_cvt_pk_bf16_f32 v84, v84, v86
    ds_write_b32 v14, v84 offset:3584
    v_mfma_f32_16x16x32_bf16 v[140:143], v[116:119], v[28:31], v[140:143]
    s_waitcnt lgkmcnt(9)
    v_mfma_f32_16x16x32_bf16 v[136:139], v[96:99], v[32:35], v[136:139]
    v_mfma_f32_16x16x32_bf16 v[140:143], v[120:123], v[32:35], v[140:143]
    s_waitcnt lgkmcnt(0)
    s_barrier
    ds_read_b64_tr_b16 v[36:37], v15 offset:3072
    ds_read_b64_tr_b16 v[38:39], v15 offset:3328
    ds_read_b64_tr_b16 v[40:41], v15 offset:3840
    ds_read_b64_tr_b16 v[42:43], v15 offset:4096
    v_mfma_f32_16x16x32_bf16 v[136:139], v[100:103], v[64:67], v[136:139]
    ds_read_b64_tr_b16 v[44:45], v15 offset:4608
    ds_read_b64_tr_b16 v[46:47], v15 offset:4864
    v_mfma_f32_16x16x32_bf16 v[140:143], v[124:127], v[64:67], v[140:143]
    ds_read_b64_tr_b16 v[48:49], v15 offset:5376
    ds_read_b64_tr_b16 v[50:51], v15 offset:5632
    v_mfma_f32_16x16x32_bf16 v[136:139], v[104:107], v[68:71], v[136:139]
    ds_read_b64_tr_b16 v[52:53], v15 offset:3584
    ds_read_b64_tr_b16 v[54:55], v15 offset:4352
    v_mfma_f32_16x16x32_bf16 v[140:143], v[128:131], v[68:71], v[140:143]
    ds_read_b64_tr_b16 v[56:57], v15 offset:5120
    ds_read_b64_tr_b16 v[58:59], v15 offset:5888
    v_mfma_f32_16x16x32_bf16 v[136:139], v[108:111], v[72:75], v[136:139]
    v_mfma_f32_16x16x32_bf16 v[140:143], v[132:135], v[72:75], v[140:143]
    s_waitcnt lgkmcnt(10)
    v_mfma_f32_16x16x32_bf16 v[60:63], v[36:39], v[24:27], 0
    v_subrev_u32 v3, s58, v14
    s_waitcnt lgkmcnt(8)
    v_mfma_f32_16x16x32_bf16 v[60:63], v[40:43], v[28:31], v[60:63]
    s_waitcnt lgkmcnt(6)
    v_mfma_f32_16x16x32_bf16 v[60:63], v[44:47], v[32:35], v[60:63]
    s_waitcnt lgkmcnt(4)
    v_mfma_f32_16x16x32_bf16 v[60:63], v[48:51], v[64:67], v[60:63]
    v_cndmask_b32 v76, v136, v140, s[88:89]
    v_cndmask_b32 v77, v137, v141, s[88:89]
    s_waitcnt lgkmcnt(2)
    v_mfma_f32_16x16x32_bf16 v[60:63], v[52:55], v[68:71], v[60:63]
    v_cndmask_b32 v78, v138, v142, s[88:89]
    v_cndmask_b32 v79, v139, v143, s[88:89]
    s_waitcnt lgkmcnt(0)
    v_mfma_f32_16x16x32_bf16 v[60:63], v[56:59], v[72:75], v[60:63]
    v_max3_f32 v82, v76, v77, v78
    v_max_f32 v82, v82, v79
    s_nop 1
    v_max_f32_dpp v82, v82, v82 row_ror:8 row_mask:0xf bank_mask:0xf
    v_mov_b32 v83, v82
    s_nop 1
    v_permlane32_swap_b32 v82, v83
    v_max_f32 v82, v82, v83
    v_max3_f32 v82, v82, v60, v61
    v_max3_f32 v82, v82, v62, v63
    v_mov_b32 v83, v82
    v_cndmask_b32 v60, v60, v62, s[90:91]
    v_cndmask_b32 v61, v61, v63, s[90:91]
    v_permlane16_swap_b32 v82, v83
    v_cndmask_b32 v80, v60, v61, s[88:89]
    v_max_f32 v82, v82, v83
    v_mul_f32 v82, s62, v82
    v_fma_f32 v80, v80, s62, -v82
    v_fma_f32 v76, v76, s62, -v82
    v_fma_f32 v77, v77, s62, -v82
    v_fma_f32 v78, v78, s62, -v82
    v_fma_f32 v79, v79, s62, -v82
    v_exp_f32 v80, v80
    v_exp_f32 v76, v76
    v_exp_f32 v77, v77
    v_exp_f32 v78, v78
    v_exp_f32 v79, v79
    v_add_f32 v82, v80, v76
    v_add_f32 v82, v82, v77
    v_add_f32 v82, v82, v78
    v_add_f32 v82, v82, v79
    s_nop 1
    v_add_f32_dpp v82, v82, v82 row_ror:8 row_mask:0xf bank_mask:0xf
    v_mov_b32 v83, v82
    s_nop 1
    v_permlane16_swap_b32 v82, v83
    v_add_f32 v82, v82, v83
    v_mov_b32 v83, v82
    s_nop 1
    v_permlane32_swap_b32 v82, v83
    v_add_f32 v82, v82, v83
    v_rcp_f32 v82, v82
    s_nop 0
    v_mul_f32 v80, v80, v82
    v_mul_f32 v76, v76, v82
    v_mul_f32 v77, v77, v82
    v_mul_f32 v78, v78, v82
    v_mul_f32 v79, v79, v82
    v_cvt_pk_bf16_f32 v84, v76, v77
    v_cvt_pk_bf16_f32 v85, v78, v79
    v_mov_b32_dpp v83, v80 row_ror:8 row_mask:0xf bank_mask:0xf
    buffer_store_dwordx2 v[84:85], v17, s[8:11], s52 offen sc1
    v_cvt_pk_bf16_f32 v86, v80, v83
    buffer_store_dwordx2 v[84:85], v17, s[8:11], s54 offen sc1
    s_mov_b64 exec, s[66:67]
    buffer_store_dword v86, v3, s[8:11], s52 offen offset:512 sc1
    buffer_store_dword v86, v3, s[8:11], s54 offen offset:512 sc1
    s_mov_b64 exec, -1
    s_add_u32 m0, s57, 24576
    s_add_u32 s44, s56, 768
    buffer_load_dwordx4 v11, s[24:27], s44 offen lds
    s_add_u32 m0, s57, 25600
    s_add_u32 s44, s56, 11008
    buffer_load_dwordx4 v11, s[24:27], s44 offen lds
    s_add_u32 m0, s57, 28672
    s_add_u32 s44, s56, 896
    buffer_load_dwordx4 v11, s[24:27], s44 offen lds
    s_add_u32 m0, s57, 29696
    s_add_u32 s44, s56, 11136
    buffer_load_dwordx4 v11, s[24:27], s44 offen lds
    s_add_u32 m0, s57, 32768
    s_add_u32 s44, s56, 1024
    buffer_load_dwordx4 v11, s[24:27], s44 offen lds
    s_add_u32 m0, s57, 33792
    s_add_u32 s44, s56, 11264
    buffer_load_dwordx4 v11, s[24:27], s44 offen lds
    s_add_u32 m0, s57, 36864
    s_add_u32 s44, s56, 1152
    buffer_load_dwordx4 v11, s[24:27], s44 offen lds
    s_add_u32 m0, s57, 37888
    s_add_u32 s44, s56, 11392
    buffer_load_dwordx4 v11, s[24:27], s44 offen lds
    s_waitcnt vmcnt(0)
    s_branch L_S_e
L_S_b:
    v_add_u32 v3, s55, v13
    v_smfmac_f32_16x16x64_bf16 v[80:83], v[52:55], v[144:151], v9
    ds_read_b128 v[24:27], v3 offset:0
    v_smfmac_f32_16x16x64_bf16 v[80:83], v[56:59], v[192:199], v9
    ds_read_b128 v[28:31], v3 offset:1024
    v_smfmac_f32_16x16x64_bf16 v[80:83], v[60:63], v[240:247], v9
    ds_read_b128 v[32:35], v3 offset:2048
    v_add_f32 v76, v76, v77
    v_smfmac_f32_16x16x64_bf16 v[84:87], v[52:55], v[152:159], v9
    ds_read_b128 v[64:67], v3 offset:3072
    v_add_f32 v78, v78, v79
    v_smfmac_f32_16x16x64_bf16 v[84:87], v[56:59], v[200:207], v9
    ds_read_b128 v[68:71], v3 offset:4096
    v_cvt_pk_bf16_f32 v76, v76, v78
    v_smfmac_f32_16x16x64_bf16 v[84:87], v[60:63], v[248:255], v9
    ds_read_b128 v[72:75], v3 offset:5120
    ds_write_b32 v14, v76 offset:3072
    v_add_f32 v80, v80, v81
    v_add_f32 v82, v82, v83
    v_cvt_pk_bf16_f32 v80, v80, v82
    ds_write_b32 v14, v80 offset:3328
    s_nop 1
    v_add_f32 v84, v84, v85
    v_add_f32 v86, v86, v87
    v_cvt_pk_bf16_f32 v84, v84, v86
    ds_write_b32 v14, v84 offset:3584
    s_waitcnt lgkmcnt(0)
    s_barrier
    v_mfma_f32_16x16x32_bf16 v[136:139], v[88:91], v[24:27], 0
    s_add_u32 m0, s57, 0
    s_add_u32 s44, s56, 0
    buffer_load_dwordx4 v11, s[24:27], s44 offen lds
    v_mfma_f32_16x16x32_bf16 v[140:143], v[112:115], v[24:27], 0
    s_add_u32 m0, s57, 1024
    s_add_u32 s44, s56, 10240
    buffer_load_dwordx4 v11, s[24:27], s44 offen lds
    v_mfma_f32_16x16x32_bf16 v[136:139], v[92:95], v[28:31], v[136:139]
    s_add_u32 m0, s57, 4096
    s_add_u32 s44, s56, 128
    buffer_load_dwordx4 v11, s[24:27], s44 offen lds
    v_mfma_f32_16x16x32_bf16 v[140:143], v[116:119], v[28:31], v[140:143]
    s_add_u32 m0, s57, 5120
    s_add_u32 s44, s56, 10368
    buffer_load_dwordx4 v11, s[24:27], s44 offen lds
    v_mfma_f32_16x16x32_bf16 v[136:139], v[96:99], v[32:35], v[136:139]
    v_mfma_f32_16x16x32_bf16 v[140:143], v[120:123], v[32:35], v[140:143]
    ds_read_b64_tr_b16 v[36:37], v15 offset:3072
    ds_read_b64_tr_b16 v[38:39], v15 offset:3328
    v_mfma_f32_16x16x32_bf16 v[136:139], v[100:103], v[64:67], v[136:139]
    ds_read_b64_tr_b16 v[40:41], v15 offset:3840
    ds_read_b64_tr_b16 v[42:43], v15 offset:4096
    v_mfma_f32_16x16x32_bf16 v[140:143], v[124:127], v[64:67], v[140:143]
    ds_read_b64_tr_b16 v[44:45], v15 offset:4608
    ds_read_b64_tr_b16 v[46:47], v15 offset:4864
    v_mfma_f32_16x16x32_bf16 v[136:139], v[104:107], v[68:71], v[136:139]
    ds_read_b64_tr_b16 v[48:49], v15 offset:5376
    ds_read_b64_tr_b16 v[50:51], v15 offset:5632
    v_mfma_f32_16x16x32_bf16 v[140:143], v[128:131], v[68:71], v[140:143]
    ds_read_b64_tr_b16 v[52:53], v15 offset:3584
    ds_read_b64_tr_b16 v[54:55], v15 offset:4352
    v_mfma_f32_16x16x32_bf16 v[136:139], v[108:111], v[72:75], v[136:139]
    ds_read_b64_tr_b16 v[56:57], v15 offset:5120
    ds_read_b64_tr_b16 v[58:59], v15 offset:5888
    v_mfma_f32_16x16x32_bf16 v[140:143], v[132:135], v[72:75], v[140:143]
    v_mov_b32 v83, 0xff7fffff
    s_waitcnt lgkmcnt(10)
    v_mfma_f32_16x16x32_bf16 v[60:63], v[36:39], v[24:27], 0
    s_waitcnt lgkmcnt(8)
    v_mfma_f32_16x16x32_bf16 v[60:63], v[40:43], v[28:31], v[60:63]
    s_waitcnt lgkmcnt(6)
    v_mfma_f32_16x16x32_bf16 v[60:63], v[44:47], v[32:35], v[60:63]
    s_waitcnt lgkmcnt(4)
    v_mfma_f32_16x16x32_bf16 v[60:63], v[48:51], v[64:67], v[60:63]
    s_waitcnt lgkmcnt(2)
    v_mfma_f32_16x16x32_bf16 v[60:63], v[52:55], v[68:71], v[60:63]
    s_waitcnt lgkmcnt(0)
    v_mfma_f32_16x16x32_bf16 v[60:63], v[56:59], v[72:75], v[60:63]
    v_cmp_le_i32 s[64:65], 0, v19
    v_cmp_le_i32 s[66:67], 1, v19
    s_nop 0
    v_cndmask_b32 v136, v83, v136, s[64:65]
    v_cndmask_b32 v137, v83, v137, s[66:67]
    v_cmp_le_i32 s[64:65], 2, v19
    v_cmp_le_i32 s[66:67], 3, v19
    s_nop 0
    v_cndmask_b32 v138, v83, v138, s[64:65]
    v_cndmask_b32 v139, v83, v139, s[66:67]
    v_cmp_le_i32 s[64:65], 16, v19
    v_cmp_le_i32 s[66:67], 17, v19
    s_nop 0
    v_cndmask_b32 v140, v83, v140, s[64:65]
    v_cndmask_b32 v141, v83, v141, s[66:67]
    v_cmp_le_i32 s[64:65], 18, v19
    v_cmp_le_i32 s[66:67], 19, v19
    s_nop 0
    v_cndmask_b32 v142, v83, v142, s[64:65]
    v_cndmask_b32 v143, v83, v143, s[66:67]
    v_cndmask_b32 v60, v60, v62, s[90:91]
    v_cndmask_b32 v61, v61, v63, s[90:91]
    v_max3_f32 v82, v60, v61, v136
    v_max3_f32 v82, v82, v137, v138
    v_max3_f32 v82, v82, v139, v140
    v_max3_f32 v82, v82, v141, v142
    v_max_f32 v82, v82, v143
    v_mov_b32 v83, v82
    s_nop 1
    v_permlane16_swap_b32 v82, v83
    v_max_f32 v82, v82, v83
    v_mov_b32 v83, v82
    s_nop 1
    v_permlane32_swap_b32 v82, v83
    v_max_f32 v82, v82, v83
    v_mul_f32 v82, s62, v82
    v_fma_f32 v60, v60, s62, -v82
    v_fma_f32 v61, v61, s62, -v82
    v_fma_f32 v136, v136, s62, -v82
    v_fma_f32 v137, v137, s62, -v82
    v_fma_f32 v138, v138, s62, -v82
    v_fma_f32 v139, v139, s62, -v82
    v_fma_f32 v140, v140, s62, -v82
    v_fma_f32 v141, v141, s62, -v82
    v_fma_f32 v142, v142, s62, -v82
    v_fma_f32 v143, v143, s62, -v82
    v_exp_f32 v60, v60
    v_exp_f32 v61, v61
    v_exp_f32 v136, v136
    v_exp_f32 v137, v137
    v_exp_f32 v138, v138
    v_exp_f32 v139, v139
    v_exp_f32 v140, v140
    v_exp_f32 v141, v141
    v_exp_f32 v142, v142
    v_exp_f32 v143, v143
    v_add_f32 v82, v60, v61
    v_add_f32 v82, v82, v136
    v_add_f32 v82, v82, v137
    v_add_f32 v82, v82, v138
    v_add_f32 v82, v82, v139
    v_add_f32 v82, v82, v140
    v_add_f32 v82, v82, v141
    v_add_f32 v82, v82, v142
    v_add_f32 v82, v82, v143
    v_mov_b32 v83, v82
    s_nop 1
    v_permlane16_swap_b32 v82, v83
    v_add_f32 v82, v82, v83
    v_mov_b32 v83, v82
    s_nop 1
    v_permlane32_swap_b32 v82, v83
    v_add_f32 v82, v82, v83
    v_rcp_f32 v82, v82
    s_nop 0
    v_mul_f32 v60, v60, v82
    v_mul_f32 v61, v61, v82
    v_mul_f32 v136, v136, v82
    v_mul_f32 v137, v137, v82
    v_mul_f32 v138, v138, v82
    v_mul_f32 v139, v139, v82
    v_mul_f32 v140, v140, v82
    v_mul_f32 v141, v141, v82
    v_mul_f32 v142, v142, v82
    v_mul_f32 v143, v143, v82
    s_add_u32 m0, s57, 8192
    s_add_u32 s44, s56, 256
    buffer_load_dwordx4 v11, s[24:27], s44 offen lds
    s_add_u32 m0, s57, 9216
    s_add_u32 s44, s56, 10496
    buffer_load_dwordx4 v11, s[24:27], s44 offen lds
    s_add_u32 m0, s57, 12288
    s_add_u32 s44, s56, 384
    buffer_load_dwordx4 v11, s[24:27], s44 offen lds
    s_add_u32 m0, s57, 13312
    s_add_u32 s44, s56, 10624
    buffer_load_dwordx4 v11, s[24:27], s44 offen lds
    s_add_u32 m0, s57, 16384
    s_add_u32 s44, s56, 512
    buffer_load_dwordx4 v11, s[24:27], s44 offen lds
    s_add_u32 m0, s57, 17408
    s_add_u32 s44, s56, 10752
    buffer_load_dwordx4 v11, s[24:27], s44 offen lds
    s_add_u32 m0, s57, 20480
    s_add_u32 s44, s56, 640
    buffer_load_dwordx4 v11, s[24:27], s44 offen lds
    s_add_u32 m0, s57, 21504
    s_add_u32 s44, s56, 10880
    buffer_load_dwordx4 v11, s[24:27], s44 offen lds
    v_cvt_pk_bf16_f32 v84, v136, v137
    v_cvt_pk_bf16_f32 v85, v140, v141
    v_cvt_pk_bf16_f32 v86, v138, v139
    v_cvt_pk_bf16_f32 v87, v142, v143
    v_cvt_pk_bf16_f32 v83, v60, v61
    buffer_store_dwordx4 v[84:87], v12, s[8:11], s50 offen sc1
    buffer_store_dword v83, v18, s[8:11], s51 offen offset:2048 sc1
    s_mov_b64 s[64:65], 1
    s_waitcnt vmcnt(2)
L_S_e:
    s_add_u32 s35, s35, 2
    s_cmp_lt_u32 s35, 64
    s_cbranch_scc1 L_S_loop
    s_cmp_lt_u32 s34, 2
    s_cbranch_scc1 L_end
    s_waitcnt vmcnt(0)
    s_mov_b64 exec, 1
    buffer_store_dword v7, v6, s[8:11], s60 offen sc1
    s_endpgm
L_V:
    s_and_b32 s36, s33, 7
    s_lshl_b32 s44, s41, 3
    s_add_u32 s36, s36, s44
    v_lshlrev_b32 v12, 4, v1
    s_mul_i32 s44, s34, 28672
    v_add_u32 v10, s44, v12
    v_add_u32 v13, 114688, v12
    v_and_b32 v4, 1, v1
    v_cmp_eq_u32 vcc, 0, v4
    v_mov_b32 v4, 0xeeee
    v_mov_b32 v5, 0x4444
    v_cndmask_b32 v9, v4, v5, vcc
    s_mul_i32 s84, s34, 3
    s_min_u32 s84, s84, 8
    s_sub_u32 s44, s84, 10
    s_cmp_ge_u32 s34, 3
    s_cselect_b32 s85, s44, s84
    s_cmp_ge_u32 s34, 2
    s_cselect_b32 s86, s44, s84
    s_cmp_ge_u32 s34, 1
    s_cselect_b32 s87, s44, s84
    s_mov_b32 s24, s68
    s_mov_b32 s25, s69
    s_mov_b32 s26, 2621440
    s_mov_b32 s27, 0x20000
    v_lshrrev_b32 v2, 3, v1
    v_and_b32 v3, 7, v1
    v_xor_b32 v3, v3, v2
    s_lshl_b32 s44, s34, 3
    v_add_u32 v2, s44, v2
    v_mul_u32_u24 v11, 1280, v2
    v_lshl_add_u32 v11, v3, 4, v11
    v_and_b32 v2, 15, v1
    v_lshrrev_b32 v3, 4, v1
    v_and_b32 v4, 7, v1
    v_xor_b32 v3, v3, v4
    v_lshlrev_b32 v3, 4, v3
    v_lshl_add_u32 v0, v2, 7, v3
    v_xor_b32 v5, 64, v0
    v_add_u32 v0, 114688, v0
    v_add_u32 v5, 114688, v5
    s_lshl_b32 s44, s40, 5
    s_add_u32 s44, s44, s36
    s_lshl_b32 s60, s44, 7
    s_add_u32 s60, s60, 15007744
    s_mul_i32 s61, s34, 163840
    s_lshl_b32 s44, s36, 8
    s_add_u32 s61, s61, s44
    v_and_b32 v2, 15, v1
    v_lshrrev_b32 v3, 4, v1
    v_lshlrev_b32 v4, 14, v3
    v_lshl_add_u32 v8, v2, 4, v4
    v_mov_b32 v20, -1
    v_mov_b32 v21, -1
    v_mov_b32 v22, -1
    v_mov_b32 v23, -1
    s_mov_b32 s16, s76
    s_mov_b32 s17, s77
    s_mov_b32 s18, 7864320
    s_mov_b32 s19, 0x20000
    s_mov_b32 s20, s78
    s_mov_b32 s21, s79
    s_mov_b32 s22, 7864320
    s_mov_b32 s23, 0x20000
    s_mul_i32 s50, s36, 384
    s_mul_i32 s44, s34, 393216
    s_add_u32 s50, s50, s44
    s_mul_i32 s51, s34, 12288
    s_mul_i32 s52, s36, 245760
    s_mul_i32 s53, s34, 10240
    s_add_u32 s52, s52, s53
    s_mul_i32 s54, s34, 320
    v_add_u32 v2, 0, v1
    v_mul_u32_u24 v3, 2731, v2
    v_lshrrev_b32 v3, 16, v3
    v_mul_u32_u24 v4, 24, v3
    v_sub_u32 v4, v2, v4
    v_lshlrev_b32 v4, 4, v4
    v_and_b32 v5, 2, v3
    v_lshlrev_b32 v5, 4, v5
    v_xor_b32 v4, v4, v5
    v_mul_u32_u24 v3, 12288, v3
    v_add_u32 v136, v4, v3
    v_add_u32 v2, 64, v1
    v_mul_u32_u24 v3, 2731, v2
    v_lshrrev_b32 v3, 16, v3
    v_mul_u32_u24 v4, 24, v3
    v_sub_u32 v4, v2, v4
    v_lshlrev_b32 v4, 4, v4
    v_and_b32 v5, 2, v3
    v_lshlrev_b32 v5, 4, v5
    v_xor_b32 v4, v4, v5
    v_mul_u32_u24 v3, 12288, v3
    v_add_u32 v137, v4, v3
    v_add_u32 v2, 128, v1
    v_mul_u32_u24 v3, 2731, v2
    v_lshrrev_b32 v3, 16, v3
    v_mul_u32_u24 v4, 24, v3
    v_sub_u32 v4, v2, v4
    v_lshlrev_b32 v4, 4, v4
    v_and_b32 v5, 2, v3
    v_lshlrev_b32 v5, 4, v5
    v_xor_b32 v4, v4, v5
    v_mul_u32_u24 v3, 12288, v3
    v_add_u32 v138, v4, v3
    v_lshrrev_b32 v2, 4, v1
    v_bfe_u32 v3, v1, 2, 2
    v_lshl_add_u32 v2, v2, 3, v3
    v_mul_u32_u24 v2, 384, v2
    v_and_b32 v3, 3, v1
    v_lshl_add_u32 v2, v3, 3, v2
    v_and_b32 v3, 24, v1
    v_lshlrev_b32 v3, 2, v3
    s_mul_i32 s44, s34, 96
    v_xad_u32 v14, s44, v3, v2
    s_add_u32 s44, s44, 32
    v_xad_u32 v15, s44, v3, v2
    s_add_u32 s44, s44, 32
    v_xad_u32 v16, s44, v3, v2
    v_mul_u32_u24 v3, 21846, v1
    v_lshrrev_b32 v3, 16, v3
    v_mul_u32_u24 v4, 3, v3
    v_sub_u32 v4, v1, v4
    v_mul_u32_u24 v3, 12288, v3
    v_lshl_add_u32 v19, v4, 7, v3
    v_lshlrev_b32 v7, 7, v1
    s_add_u32 s44, s50, 0
    s_add_u32 m0, s51, 0
    s_nop 0
    buffer_load_dwordx4 v136, s[16:19], s44 offen  lds
    s_add_u32 m0, s51, 1024
    s_nop 0
    buffer_load_dwordx4 v137, s[16:19], s44 offen  lds
    s_add_u32 m0, s51, 2048
    s_nop 0
    buffer_load_dwordx4 v138, s[16:19], s44 offen  lds
    s_add_u32 s44, s50, 98304
    s_add_u32 m0, s51, 3072
    v_xor_b32 v2, 64, v136
    buffer_load_dwordx4 v2, s[16:19], s44 offen  lds
    s_add_u32 m0, s51, 4096
    v_xor_b32 v2, 64, v137
    buffer_load_dwordx4 v2, s[16:19], s44 offen  lds
    s_add_u32 m0, s51, 5120
    v_xor_b32 v2, 64, v138
    buffer_load_dwordx4 v2, s[16:19], s44 offen  lds
    s_add_u32 s44, s50, 196608
    s_add_u32 m0, s51, 6144
    s_nop 0
    buffer_load_dwordx4 v136, s[16:19], s44 offen  lds
    s_add_u32 m0, s51, 7168
    s_nop 0
    buffer_load_dwordx4 v137, s[16:19], s44 offen  lds
    s_add_u32 m0, s51, 8192
    s_nop 0
    buffer_load_dwordx4 v138, s[16:19], s44 offen  lds
    s_add_u32 s44, s50, 294912
    s_add_u32 m0, s51, 9216
    v_xor_b32 v2, 64, v136
    buffer_load_dwordx4 v2, s[16:19], s44 offen  lds
    s_add_u32 m0, s51, 10240
    v_xor_b32 v2, 64, v137
    buffer_load_dwordx4 v2, s[16:19], s44 offen  lds
    s_add_u32 m0, s51, 11264
    v_xor_b32 v2, 64, v138
    buffer_load_dwordx4 v2, s[16:19], s44 offen  lds
    s_add_u32 s44, s50, 1572864
    s_add_u32 m0, s51, 49152
    s_nop 0
    buffer_load_dwordx4 v136, s[16:19], s44 offen  lds
    s_add_u32 m0, s51, 50176
    s_nop 0
    buffer_load_dwordx4 v137, s[16:19], s44 offen  lds
    s_add_u32 m0, s51, 51200
    s_nop 0
    buffer_load_dwordx4 v138, s[16:19], s44 offen  lds
    s_add_u32 s44, s50, 1671168
    s_add_u32 m0, s51, 52224
    v_xor_b32 v2, 64, v136
    buffer_load_dwordx4 v2, s[16:19], s44 offen  lds
    s_add_u32 m0, s51, 53248
    v_xor_b32 v2, 64, v137
    buffer_load_dwordx4 v2, s[16:19], s44 offen  lds
    s_add_u32 m0, s51, 54272
    v_xor_b32 v2, 64, v138
    buffer_load_dwordx4 v2, s[16:19], s44 offen  lds
    s_add_u32 s44, s50, 1769472
    s_add_u32 m0, s51, 55296
    s_nop 0
    buffer_load_dwordx4 v136, s[16:19], s44 offen  lds
    s_add_u32 m0, s51, 56320
    s_nop 0
    buffer_load_dwordx4 v137, s[16:19], s44 offen  lds
    s_add_u32 m0, s51, 57344
    s_nop 0
    buffer_load_dwordx4 v138, s[16:19], s44 offen  lds
    s_add_u32 s44, s50, 1867776
    s_add_u32 m0, s51, 58368
    v_xor_b32 v2, 64, v136
    buffer_load_dwordx4 v2, s[16:19], s44 offen  lds
    s_add_u32 m0, s51, 59392
    v_xor_b32 v2, 64, v137
    buffer_load_dwordx4 v2, s[16:19], s44 offen  lds
    s_add_u32 m0, s51, 60416
    v_xor_b32 v2, 64, v138
    buffer_load_dwordx4 v2, s[16:19], s44 offen  lds
    s_add_u32 s44, s50, 3145728
    s_add_u32 m0, s51, 98304
    s_nop 0
    buffer_load_dwordx4 v136, s[16:19], s44 offen  lds
    s_add_u32 m0, s51, 99328
    s_nop 0
    buffer_load_dwordx4 v137, s[16:19], s44 offen  lds
    s_add_u32 m0, s51, 100352
    s_nop 0
    buffer_load_dwordx4 v138, s[16:19], s44 offen  lds
    s_add_u32 s44, s50, 3244032
    s_add_u32 m0, s51, 101376
    v_xor_b32 v2, 64, v136
    buffer_load_dwordx4 v2, s[16:19], s44 offen  lds
    s_add_u32 m0, s51, 102400
    v_xor_b32 v2, 64, v137
    buffer_load_dwordx4 v2, s[16:19], s44 offen  lds
    s_add_u32 m0, s51, 103424
    v_xor_b32 v2, 64, v138
    buffer_load_dwordx4 v2, s[16:19], s44 offen  lds
    s_add_u32 s44, s50, 3342336
    s_add_u32 m0, s51, 104448
    s_nop 0
    buffer_load_dwordx4 v136, s[16:19], s44 offen  lds
    s_add_u32 m0, s51, 105472
    s_nop 0
    buffer_load_dwordx4 v137, s[16:19], s44 offen  lds
    s_add_u32 m0, s51, 106496
    s_nop 0
    buffer_load_dwordx4 v138, s[16:19], s44 offen  lds
    s_add_u32 s44, s50, 3440640
    s_add_u32 m0, s51, 107520
    v_xor_b32 v2, 64, v136
    buffer_load_dwordx4 v2, s[16:19], s44 offen  lds
    s_add_u32 m0, s51, 108544
    v_xor_b32 v2, 64, v137
    buffer_load_dwordx4 v2, s[16:19], s44 offen  lds
    s_add_u32 m0, s51, 109568
    v_xor_b32 v2, 64, v138
    buffer_load_dwordx4 v2, s[16:19], s44 offen  lds
    v_add_u32 v2, 0, v1
    v_mul_u32_u24 v3, 820, v2
    v_lshrrev_b32 v3, 16, v3
    v_mul_u32_u24 v4, 80, v3
    v_sub_u32 v4, v2, v4
    v_lshlrev_b32 v4, 4, v4
    v_lshlrev_b32 v5, 5, v3
    v_xor_b32 v4, v4, v5
    v_mul_u32_u24 v3, 1280, v3
    v_add_u32 v139, v4, v3
    v_add_u32 v2, 64, v1
    v_mul_u32_u24 v3, 820, v2
    v_lshrrev_b32 v3, 16, v3
    v_mul_u32_u24 v4, 80, v3
    v_sub_u32 v4, v2, v4
    v_lshlrev_b32 v4, 4, v4
    v_lshlrev_b32 v5, 5, v3
    v_xor_b32 v4, v4, v5
    v_mul_u32_u24 v3, 1280, v3
    v_add_u32 v140, v4, v3
    v_add_u32 v2, 128, v1
    v_mul_u32_u24 v3, 820, v2
    v_lshrrev_b32 v3, 16, v3
    v_mul_u32_u24 v4, 80, v3
    v_sub_u32 v4, v2, v4
    v_lshlrev_b32 v4, 4, v4
    v_lshlrev_b32 v5, 5, v3
    v_xor_b32 v4, v4, v5
    v_mul_u32_u24 v3, 1280, v3
    v_add_u32 v141, v4, v3
    v_add_u32 v2, 192, v1
    v_mul_u32_u24 v3, 820, v2
    v_lshrrev_b32 v3, 16, v3
    v_mul_u32_u24 v4, 80, v3
    v_sub_u32 v4, v2, v4
    v_lshlrev_b32 v4, 4, v4
    v_lshlrev_b32 v5, 5, v3
    v_xor_b32 v4, v4, v5
    v_mul_u32_u24 v3, 1280, v3
    v_add_u32 v142, v4, v3
    v_add_u32 v2, 256, v1
    v_mul_u32_u24 v3, 820, v2
    v_lshrrev_b32 v3, 16, v3
    v_mul_u32_u24 v4, 80, v3
    v_sub_u32 v4, v2, v4
    v_lshlrev_b32 v4, 4, v4
    v_lshlrev_b32 v5, 5, v3
    v_xor_b32 v4, v4, v5
    v_mul_u32_u24 v3, 1280, v3
    v_add_u32 v143, v4, v3
    v_lshrrev_b32 v2, 2, v1
    v_mul_u32_u24 v17, 1280, v2
    v_and_b32 v3, 3, v1
    v_lshl_add_u32 v17, v3, 3, v17
    v_add_u32 v17, 98304, v17
    v_and_b32 v18, 7, v2
    v_lshlrev_b32 v18, 5, v18
    s_waitcnt vmcnt(24)
    s_barrier
    s_cmp_eq_u32 s34, 1
    s_cbranch_scc1 PWW_81
    s_cmp_eq_u32 s34, 2
    s_cbranch_scc1 PWW_82
    s_cmp_eq_u32 s34, 3
    s_cbranch_scc1 PWW_83
    ds_read_b64_tr_b16 v[24:25], v14 offset:0
    ds_read_b64_tr_b16 v[26:27], v14 offset:1536
    ds_read_b64_tr_b16 v[28:29], v14 offset:12288
    ds_read_b64_tr_b16 v[30:31], v14 offset:13824
    ds_read_b64_tr_b16 v[32:33], v15 offset:0
    ds_read_b64_tr_b16 v[34:35], v15 offset:1536
    ds_read_b64_tr_b16 v[36:37], v15 offset:12288
    ds_read_b64_tr_b16 v[38:39], v15 offset:13824
    ds_read_b64_tr_b16 v[40:41], v16 offset:0
    ds_read_b64_tr_b16 v[42:43], v16 offset:1536
    ds_read_b64_tr_b16 v[44:45], v16 offset:12288
    ds_read_b64_tr_b16 v[46:47], v16 offset:13824
    ds_read_b64_tr_b16 v[48:49], v14 offset:24576
    ds_read_b64_tr_b16 v[50:51], v14 offset:26112
    ds_read_b64_tr_b16 v[52:53], v14 offset:36864
    ds_read_b64_tr_b16 v[54:55], v14 offset:38400
    ds_read_b64_tr_b16 v[56:57], v15 offset:24576
    ds_read_b64_tr_b16 v[58:59], v15 offset:26112
    ds_read_b64_tr_b16 v[60:61], v15 offset:36864
    ds_read_b64_tr_b16 v[62:63], v15 offset:38400
    ds_read_b64_tr_b16 v[64:65], v16 offset:24576
    ds_read_b64_tr_b16 v[66:67], v16 offset:26112
    ds_read_b64_tr_b16 v[68:69], v16 offset:36864
    ds_read_b64_tr_b16 v[70:71], v16 offset:38400
    s_branch PW_79
PWW_81:
    ds_read_b64_tr_b16 a[112:113], v14 offset:0
    ds_read_b64_tr_b16 a[114:115], v14 offset:1536
    ds_read_b64_tr_b16 a[116:117], v14 offset:12288
    ds_read_b64_tr_b16 a[118:119], v14 offset:13824
    ds_read_b64_tr_b16 a[120:121], v15 offset:0
    ds_read_b64_tr_b16 a[122:123], v15 offset:1536
    ds_read_b64_tr_b16 a[124:125], v15 offset:12288
    ds_read_b64_tr_b16 a[126:127], v15 offset:13824
    ds_read_b64_tr_b16 a[128:129], v16 offset:0
    ds_read_b64_tr_b16 a[130:131], v16 offset:1536
    ds_read_b64_tr_b16 a[132:133], v16 offset:12288
    ds_read_b64_tr_b16 a[134:135], v16 offset:13824
    ds_read_b64_tr_b16 a[136:137], v14 offset:24576
    ds_read_b64_tr_b16 a[138:139], v14 offset:26112
    ds_read_b64_tr_b16 a[140:141], v14 offset:36864
    ds_read_b64_tr_b16 a[142:143], v14 offset:38400
    ds_read_b64_tr_b16 a[144:145], v15 offset:24576
    ds_read_b64_tr_b16 a[146:147], v15 offset:26112
    ds_read_b64_tr_b16 a[148:149], v15 offset:36864
    ds_read_b64_tr_b16 a[150:151], v15 offset:38400
    ds_read_b64_tr_b16 a[152:153], v16 offset:24576
    ds_read_b64_tr_b16 a[154:155], v16 offset:26112
    ds_read_b64_tr_b16 a[156:157], v16 offset:36864
    ds_read_b64_tr_b16 a[158:159], v16 offset:38400
    s_branch PW_79
PWW_82:
    ds_read_b64_tr_b16 a[40:41], v14 offset:0
    ds_read_b64_tr_b16 a[42:43], v14 offset:1536
    ds_read_b64_tr_b16 a[44:45], v14 offset:12288
    ds_read_b64_tr_b16 a[46:47], v14 offset:13824
    ds_read_b64_tr_b16 a[48:49], v15 offset:0
    ds_read_b64_tr_b16 a[50:51], v15 offset:1536
    ds_read_b64_tr_b16 a[52:53], v15 offset:12288
    ds_read_b64_tr_b16 a[54:55], v15 offset:13824
    ds_read_b64_tr_b16 a[56:57], v16 offset:0
    ds_read_b64_tr_b16 a[58:59], v16 offset:1536
    ds_read_b64_tr_b16 a[60:61], v16 offset:12288
    ds_read_b64_tr_b16 a[62:63], v16 offset:13824
    ds_read_b64_tr_b16 a[64:65], v14 offset:24576
    ds_read_b64_tr_b16 a[66:67], v14 offset:26112
    ds_read_b64_tr_b16 a[68:69], v14 offset:36864
    ds_read_b64_tr_b16 a[70:71], v14 offset:38400
    ds_read_b64_tr_b16 a[72:73], v15 offset:24576
    ds_read_b64_tr_b16 a[74:75], v15 offset:26112
    ds_read_b64_tr_b16 a[76:77], v15 offset:36864
    ds_read_b64_tr_b16 a[78:79], v15 offset:38400
    ds_read_b64_tr_b16 a[80:81], v16 offset:24576
    ds_read_b64_tr_b16 a[82:83], v16 offset:26112
    ds_read_b64_tr_b16 a[84:85], v16 offset:36864
    ds_read_b64_tr_b16 a[86:87], v16 offset:38400
    s_branch PW_79
PWW_83:
    ds_read_b64_tr_b16 v[72:73], v14 offset:0
    ds_read_b64_tr_b16 v[74:75], v14 offset:1536
    ds_read_b64_tr_b16 v[76:77], v14 offset:12288
    ds_read_b64_tr_b16 v[78:79], v14 offset:13824
    ds_read_b64_tr_b16 a[0:1], v15 offset:0
    ds_read_b64_tr_b16 a[2:3], v15 offset:1536
    ds_read_b64_tr_b16 a[4:5], v15 offset:12288
    ds_read_b64_tr_b16 a[6:7], v15 offset:13824
    ds_read_b64_tr_b16 a[8:9], v16 offset:0
    ds_read_b64_tr_b16 a[10:11], v16 offset:1536
    ds_read_b64_tr_b16 a[12:13], v16 offset:12288
    ds_read_b64_tr_b16 a[14:15], v16 offset:13824
    ds_read_b64_tr_b16 a[16:17], v14 offset:24576
    ds_read_b64_tr_b16 a[18:19], v14 offset:26112
    ds_read_b64_tr_b16 a[20:21], v14 offset:36864
    ds_read_b64_tr_b16 a[22:23], v14 offset:38400
    ds_read_b64_tr_b16 a[24:25], v15 offset:24576
    ds_read_b64_tr_b16 a[26:27], v15 offset:26112
    ds_read_b64_tr_b16 a[28:29], v15 offset:36864
    ds_read_b64_tr_b16 a[30:31], v15 offset:38400
    ds_read_b64_tr_b16 a[32:33], v16 offset:24576
    ds_read_b64_tr_b16 a[34:35], v16 offset:26112
    ds_read_b64_tr_b16 a[36:37], v16 offset:36864
    ds_read_b64_tr_b16 a[38:39], v16 offset:38400
PW_79:
    v_add_u32 v14, 49152, v14
    v_add_u32 v15, 49152, v15
    v_add_u32 v16, 49152, v16
    s_waitcnt lgkmcnt(0)
    s_barrier
    s_add_u32 s44, s50, 4718592
    s_add_u32 m0, s51, 0
    s_nop 0
    buffer_load_dwordx4 v136, s[16:19], s44 offen  lds
    s_add_u32 m0, s51, 1024
    s_nop 0
    buffer_load_dwordx4 v137, s[16:19], s44 offen  lds
    s_add_u32 m0, s51, 2048
    s_nop 0
    buffer_load_dwordx4 v138, s[16:19], s44 offen  lds
    s_add_u32 s44, s50, 4816896
    s_add_u32 m0, s51, 3072
    v_xor_b32 v2, 64, v136
    buffer_load_dwordx4 v2, s[16:19], s44 offen  lds
    s_add_u32 m0, s51, 4096
    v_xor_b32 v2, 64, v137
    buffer_load_dwordx4 v2, s[16:19], s44 offen  lds
    s_add_u32 m0, s51, 5120
    v_xor_b32 v2, 64, v138
    buffer_load_dwordx4 v2, s[16:19], s44 offen  lds
    s_add_u32 s44, s50, 4915200
    s_add_u32 m0, s51, 6144
    s_nop 0
    buffer_load_dwordx4 v136, s[16:19], s44 offen  lds
    s_add_u32 m0, s51, 7168
    s_nop 0
    buffer_load_dwordx4 v137, s[16:19], s44 offen  lds
    s_add_u32 m0, s51, 8192
    s_nop 0
    buffer_load_dwordx4 v138, s[16:19], s44 offen  lds
    s_add_u32 s44, s50, 5013504
    s_add_u32 m0, s51, 9216
    v_xor_b32 v2, 64, v136
    buffer_load_dwordx4 v2, s[16:19], s44 offen  lds
    s_add_u32 m0, s51, 10240
    v_xor_b32 v2, 64, v137
    buffer_load_dwordx4 v2, s[16:19], s44 offen  lds
    s_add_u32 m0, s51, 11264
    v_xor_b32 v2, 64, v138
    buffer_load_dwordx4 v2, s[16:19], s44 offen  lds
    s_waitcnt vmcnt(24)
    s_barrier
    s_cmp_eq_u32 s34, 1
    s_cbranch_scc1 PWW_86
    s_cmp_eq_u32 s34, 2
    s_cbranch_scc1 PWW_87
    s_cmp_eq_u32 s34, 3
    s_cbranch_scc1 PWW_88
    ds_read_b64_tr_b16 v[72:73], v14 offset:0
    ds_read_b64_tr_b16 v[74:75], v14 offset:1536
    ds_read_b64_tr_b16 v[76:77], v14 offset:12288
    ds_read_b64_tr_b16 v[78:79], v14 offset:13824
    ds_read_b64_tr_b16 a[0:1], v15 offset:0
    ds_read_b64_tr_b16 a[2:3], v15 offset:1536
    ds_read_b64_tr_b16 a[4:5], v15 offset:12288
    ds_read_b64_tr_b16 a[6:7], v15 offset:13824
    ds_read_b64_tr_b16 a[8:9], v16 offset:0
    ds_read_b64_tr_b16 a[10:11], v16 offset:1536
    ds_read_b64_tr_b16 a[12:13], v16 offset:12288
    ds_read_b64_tr_b16 a[14:15], v16 offset:13824
    ds_read_b64_tr_b16 a[16:17], v14 offset:24576
    ds_read_b64_tr_b16 a[18:19], v14 offset:26112
    ds_read_b64_tr_b16 a[20:21], v14 offset:36864
    ds_read_b64_tr_b16 a[22:23], v14 offset:38400
    ds_read_b64_tr_b16 a[24:25], v15 offset:24576
    ds_read_b64_tr_b16 a[26:27], v15 offset:26112
    ds_read_b64_tr_b16 a[28:29], v15 offset:36864
    ds_read_b64_tr_b16 a[30:31], v15 offset:38400
    ds_read_b64_tr_b16 a[32:33], v16 offset:24576
    ds_read_b64_tr_b16 a[34:35], v16 offset:26112
    ds_read_b64_tr_b16 a[36:37], v16 offset:36864
    ds_read_b64_tr_b16 a[38:39], v16 offset:38400
    s_branch PW_84
PWW_86:
    ds_read_b64_tr_b16 a[160:161], v14 offset:0
    ds_read_b64_tr_b16 a[162:163], v14 offset:1536
    ds_read_b64_tr_b16 a[164:165], v14 offset:12288
    ds_read_b64_tr_b16 a[166:167], v14 offset:13824
    ds_read_b64_tr_b16 a[168:169], v15 offset:0
    ds_read_b64_tr_b16 a[170:171], v15 offset:1536
    ds_read_b64_tr_b16 a[172:173], v15 offset:12288
    ds_read_b64_tr_b16 a[174:175], v15 offset:13824
    ds_read_b64_tr_b16 a[176:177], v16 offset:0
    ds_read_b64_tr_b16 a[178:179], v16 offset:1536
    ds_read_b64_tr_b16 a[180:181], v16 offset:12288
    ds_read_b64_tr_b16 a[182:183], v16 offset:13824
    ds_read_b64_tr_b16 v[24:25], v14 offset:24576
    ds_read_b64_tr_b16 v[26:27], v14 offset:26112
    ds_read_b64_tr_b16 v[28:29], v14 offset:36864
    ds_read_b64_tr_b16 v[30:31], v14 offset:38400
    ds_read_b64_tr_b16 v[32:33], v15 offset:24576
    ds_read_b64_tr_b16 v[34:35], v15 offset:26112
    ds_read_b64_tr_b16 v[36:37], v15 offset:36864
    ds_read_b64_tr_b16 v[38:39], v15 offset:38400
    ds_read_b64_tr_b16 v[40:41], v16 offset:24576
    ds_read_b64_tr_b16 v[42:43], v16 offset:26112
    ds_read_b64_tr_b16 v[44:45], v16 offset:36864
    ds_read_b64_tr_b16 v[46:47], v16 offset:38400
    s_branch PW_84
PWW_87:
    ds_read_b64_tr_b16 a[88:89], v14 offset:0
    ds_read_b64_tr_b16 a[90:91], v14 offset:1536
    ds_read_b64_tr_b16 a[92:93], v14 offset:12288
    ds_read_b64_tr_b16 a[94:95], v14 offset:13824
    ds_read_b64_tr_b16 a[96:97], v15 offset:0
    ds_read_b64_tr_b16 a[98:99], v15 offset:1536
    ds_read_b64_tr_b16 a[100:101], v15 offset:12288
    ds_read_b64_tr_b16 a[102:103], v15 offset:13824
    ds_read_b64_tr_b16 a[104:105], v16 offset:0
    ds_read_b64_tr_b16 a[106:107], v16 offset:1536
    ds_read_b64_tr_b16 a[108:109], v16 offset:12288
    ds_read_b64_tr_b16 a[110:111], v16 offset:13824
    ds_read_b64_tr_b16 a[112:113], v14 offset:24576
    ds_read_b64_tr_b16 a[114:115], v14 offset:26112
    ds_read_b64_tr_b16 a[116:117], v14 offset:36864
    ds_read_b64_tr_b16 a[118:119], v14 offset:38400
    ds_read_b64_tr_b16 a[120:121], v15 offset:24576
    ds_read_b64_tr_b16 a[122:123], v15 offset:26112
    ds_read_b64_tr_b16 a[124:125], v15 offset:36864
    ds_read_b64_tr_b16 a[126:127], v15 offset:38400
    ds_read_b64_tr_b16 a[128:129], v16 offset:24576
    ds_read_b64_tr_b16 a[130:131], v16 offset:26112
    ds_read_b64_tr_b16 a[132:133], v16 offset:36864
    ds_read_b64_tr_b16 a[134:135], v16 offset:38400
    s_branch PW_84
PWW_88:
    ds_read_b64_tr_b16 a[40:41], v14 offset:0
    ds_read_b64_tr_b16 a[42:43], v14 offset:1536
    ds_read_b64_tr_b16 a[44:45], v14 offset:12288
    ds_read_b64_tr_b16 a[46:47], v14 offset:13824
    ds_read_b64_tr_b16 a[48:49], v15 offset:0
    ds_read_b64_tr_b16 a[50:51], v15 offset:1536
    ds_read_b64_tr_b16 a[52:53], v15 offset:12288
    ds_read_b64_tr_b16 a[54:55], v15 offset:13824
    ds_read_b64_tr_b16 a[56:57], v16 offset:0
    ds_read_b64_tr_b16 a[58:59], v16 offset:1536
    ds_read_b64_tr_b16 a[60:61], v16 offset:12288
    ds_read_b64_tr_b16 a[62:63], v16 offset:13824
    ds_read_b64_tr_b16 a[64:65], v14 offset:24576
    ds_read_b64_tr_b16 a[66:67], v14 offset:26112
    ds_read_b64_tr_b16 a[68:69], v14 offset:36864
    ds_read_b64_tr_b16 a[70:71], v14 offset:38400
    ds_read_b64_tr_b16 a[72:73], v15 offset:24576
    ds_read_b64_tr_b16 a[74:75], v15 offset:26112
    ds_read_b64_tr_b16 a[76:77], v15 offset:36864
    ds_read_b64_tr_b16 a[78:79], v15 offset:38400
    ds_read_b64_tr_b16 a[80:81], v16 offset:24576
    ds_read_b64_tr_b16 a[82:83], v16 offset:26112
    ds_read_b64_tr_b16 a[84:85], v16 offset:36864
    ds_read_b64_tr_b16 a[86:87], v16 offset:38400
PW_84:
    v_add_u32 v14, 49152, v14
    v_add_u32 v15, 49152, v15
    v_add_u32 v16, 49152, v16
    s_waitcnt lgkmcnt(0)
    s_barrier
    s_add_u32 s44, s50, 6291456
    s_add_u32 m0, s51, 49152
    s_nop 0
    buffer_load_dwordx4 v136, s[16:19], s44 offen  lds
    s_add_u32 m0, s51, 50176
    s_nop 0
    buffer_load_dwordx4 v137, s[16:19], s44 offen  lds
    s_add_u32 m0, s51, 51200
    s_nop 0
    buffer_load_dwordx4 v138, s[16:19], s44 offen  lds
    s_add_u32 s44, s50, 6389760
    s_add_u32 m0, s51, 52224
    v_xor_b32 v2, 64, v136
    buffer_load_dwordx4 v2, s[16:19], s44 offen  lds
    s_add_u32 m0, s51, 53248
    v_xor_b32 v2, 64, v137
    buffer_load_dwordx4 v2, s[16:19], s44 offen  lds
    s_add_u32 m0, s51, 54272
    v_xor_b32 v2, 64, v138
    buffer_load_dwordx4 v2, s[16:19], s44 offen  lds
    s_add_u32 s44, s50, 6488064
    s_add_u32 m0, s51, 55296
    s_nop 0
    buffer_load_dwordx4 v136, s[16:19], s44 offen  lds
    s_add_u32 m0, s51, 56320
    s_nop 0
    buffer_load_dwordx4 v137, s[16:19], s44 offen  lds
    s_add_u32 m0, s51, 57344
    s_nop 0
    buffer_load_dwordx4 v138, s[16:19], s44 offen  lds
    s_add_u32 s44, s50, 6586368
    s_add_u32 m0, s51, 58368
    v_xor_b32 v2, 64, v136
    buffer_load_dwordx4 v2, s[16:19], s44 offen  lds
    s_add_u32 m0, s51, 59392
    v_xor_b32 v2, 64, v137
    buffer_load_dwordx4 v2, s[16:19], s44 offen  lds
    s_add_u32 m0, s51, 60416
    v_xor_b32 v2, 64, v138
    buffer_load_dwordx4 v2, s[16:19], s44 offen  lds
    s_waitcnt vmcnt(24)
    s_barrier
    s_cmp_eq_u32 s34, 1
    s_cbranch_scc1 PWW_91
    s_cmp_eq_u32 s34, 2
    s_cbranch_scc1 PWW_92
    s_cmp_eq_u32 s34, 3
    s_cbranch_scc1 PWW_93
    ds_read_b64_tr_b16 a[40:41], v14 offset:0
    ds_read_b64_tr_b16 a[42:43], v14 offset:1536
    ds_read_b64_tr_b16 a[44:45], v14 offset:12288
    ds_read_b64_tr_b16 a[46:47], v14 offset:13824
    ds_read_b64_tr_b16 a[48:49], v15 offset:0
    ds_read_b64_tr_b16 a[50:51], v15 offset:1536
    ds_read_b64_tr_b16 a[52:53], v15 offset:12288
    ds_read_b64_tr_b16 a[54:55], v15 offset:13824
    ds_read_b64_tr_b16 a[56:57], v16 offset:0
    ds_read_b64_tr_b16 a[58:59], v16 offset:1536
    ds_read_b64_tr_b16 a[60:61], v16 offset:12288
    ds_read_b64_tr_b16 a[62:63], v16 offset:13824
    ds_read_b64_tr_b16 a[64:65], v14 offset:24576
    ds_read_b64_tr_b16 a[66:67], v14 offset:26112
    ds_read_b64_tr_b16 a[68:69], v14 offset:36864
    ds_read_b64_tr_b16 a[70:71], v14 offset:38400
    ds_read_b64_tr_b16 a[72:73], v15 offset:24576
    ds_read_b64_tr_b16 a[74:75], v15 offset:26112
    ds_read_b64_tr_b16 a[76:77], v15 offset:36864
    ds_read_b64_tr_b16 a[78:79], v15 offset:38400
    ds_read_b64_tr_b16 a[80:81], v16 offset:24576
    ds_read_b64_tr_b16 a[82:83], v16 offset:26112
    ds_read_b64_tr_b16 a[84:85], v16 offset:36864
    ds_read_b64_tr_b16 a[86:87], v16 offset:38400
    s_branch PW_89
PWW_91:
    ds_read_b64_tr_b16 v[48:49], v14 offset:0
    ds_read_b64_tr_b16 v[50:51], v14 offset:1536
    ds_read_b64_tr_b16 v[52:53], v14 offset:12288
    ds_read_b64_tr_b16 v[54:55], v14 offset:13824
    ds_read_b64_tr_b16 v[56:57], v15 offset:0
    ds_read_b64_tr_b16 v[58:59], v15 offset:1536
    ds_read_b64_tr_b16 v[60:61], v15 offset:12288
    ds_read_b64_tr_b16 v[62:63], v15 offset:13824
    ds_read_b64_tr_b16 v[64:65], v16 offset:0
    ds_read_b64_tr_b16 v[66:67], v16 offset:1536
    ds_read_b64_tr_b16 v[68:69], v16 offset:12288
    ds_read_b64_tr_b16 v[70:71], v16 offset:13824
    ds_read_b64_tr_b16 v[72:73], v14 offset:24576
    ds_read_b64_tr_b16 v[74:75], v14 offset:26112
    ds_read_b64_tr_b16 v[76:77], v14 offset:36864
    ds_read_b64_tr_b16 v[78:79], v14 offset:38400
    ds_read_b64_tr_b16 a[0:1], v15 offset:24576
    ds_read_b64_tr_b16 a[2:3], v15 offset:26112
    ds_read_b64_tr_b16 a[4:5], v15 offset:36864
    ds_read_b64_tr_b16 a[6:7], v15 offset:38400
    ds_read_b64_tr_b16 a[8:9], v16 offset:24576
    ds_read_b64_tr_b16 a[10:11], v16 offset:26112
    ds_read_b64_tr_b16 a[12:13], v16 offset:36864
    ds_read_b64_tr_b16 a[14:15], v16 offset:38400
    s_branch PW_89
PWW_92:
    ds_read_b64_tr_b16 a[136:137], v14 offset:0
    ds_read_b64_tr_b16 a[138:139], v14 offset:1536
    ds_read_b64_tr_b16 a[140:141], v14 offset:12288
    ds_read_b64_tr_b16 a[142:143], v14 offset:13824
    ds_read_b64_tr_b16 a[144:145], v15 offset:0
    ds_read_b64_tr_b16 a[146:147], v15 offset:1536
    ds_read_b64_tr_b16 a[148:149], v15 offset:12288
    ds_read_b64_tr_b16 a[150:151], v15 offset:13824
    ds_read_b64_tr_b16 a[152:153], v16 offset:0
    ds_read_b64_tr_b16 a[154:155], v16 offset:1536
    ds_read_b64_tr_b16 a[156:157], v16 offset:12288
    ds_read_b64_tr_b16 a[158:159], v16 offset:13824
    ds_read_b64_tr_b16 a[160:161], v14 offset:24576
    ds_read_b64_tr_b16 a[162:163], v14 offset:26112
    ds_read_b64_tr_b16 a[164:165], v14 offset:36864
    ds_read_b64_tr_b16 a[166:167], v14 offset:38400
    ds_read_b64_tr_b16 a[168:169], v15 offset:24576
    ds_read_b64_tr_b16 a[170:171], v15 offset:26112
    ds_read_b64_tr_b16 a[172:173], v15 offset:36864
    ds_read_b64_tr_b16 a[174:175], v15 offset:38400
    ds_read_b64_tr_b16 a[176:177], v16 offset:24576
    ds_read_b64_tr_b16 a[178:179], v16 offset:26112
    ds_read_b64_tr_b16 a[180:181], v16 offset:36864
    ds_read_b64_tr_b16 a[182:183], v16 offset:38400
    s_branch PW_89
PWW_93:
    ds_read_b64_tr_b16 a[88:89], v14 offset:0
    ds_read_b64_tr_b16 a[90:91], v14 offset:1536
    ds_read_b64_tr_b16 a[92:93], v14 offset:12288
    ds_read_b64_tr_b16 a[94:95], v14 offset:13824
    ds_read_b64_tr_b16 a[96:97], v15 offset:0
    ds_read_b64_tr_b16 a[98:99], v15 offset:1536
    ds_read_b64_tr_b16 a[100:101], v15 offset:12288
    ds_read_b64_tr_b16 a[102:103], v15 offset:13824
    ds_read_b64_tr_b16 a[104:105], v16 offset:0
    ds_read_b64_tr_b16 a[106:107], v16 offset:1536
    ds_read_b64_tr_b16 a[108:109], v16 offset:12288
    ds_read_b64_tr_b16 a[110:111], v16 offset:13824
    ds_read_b64_tr_b16 a[112:113], v14 offset:24576
    ds_read_b64_tr_b16 a[114:115], v14 offset:26112
    ds_read_b64_tr_b16 a[116:117], v14 offset:36864
    ds_read_b64_tr_b16 a[118:119], v14 offset:38400
    ds_read_b64_tr_b16 a[120:121], v15 offset:24576
    ds_read_b64_tr_b16 a[122:123], v15 offset:26112
    ds_read_b64_tr_b16 a[124:125], v15 offset:36864
    ds_read_b64_tr_b16 a[126:127], v15 offset:38400
    ds_read_b64_tr_b16 a[128:129], v16 offset:24576
    ds_read_b64_tr_b16 a[130:131], v16 offset:26112
    ds_read_b64_tr_b16 a[132:133], v16 offset:36864
    ds_read_b64_tr_b16 a[134:135], v16 offset:38400
PW_89:
    v_add_u32 v14, -98304, v14
    v_add_u32 v15, -98304, v15
    v_add_u32 v16, -98304, v16
    s_waitcnt lgkmcnt(0)
    s_barrier
    s_add_u32 m0, s53, 98304
    s_add_u32 s44, s52, 0
    buffer_load_dwordx4 v139, s[20:23], s44 offen  lds
    s_add_u32 m0, s53, 99328
    s_nop 0
    buffer_load_dwordx4 v140, s[20:23], s44 offen  lds
    s_add_u32 m0, s53, 100352
    s_nop 0
    buffer_load_dwordx4 v141, s[20:23], s44 offen  lds
    s_add_u32 m0, s53, 101376
    s_nop 0
    buffer_load_dwordx4 v142, s[20:23], s44 offen  lds
    s_add_u32 m0, s53, 102400
    s_nop 0
    buffer_load_dwordx4 v143, s[20:23], s44 offen  lds
    s_add_u32 m0, s53, 103424
    s_add_u32 s44, s52, 5120
    v_xor_b32 v2, 128, v139
    buffer_load_dwordx4 v2, s[20:23], s44 offen  lds
    s_add_u32 m0, s53, 104448
    v_xor_b32 v2, 128, v140
    buffer_load_dwordx4 v2, s[20:23], s44 offen  lds
    s_add_u32 m0, s53, 105472
    v_xor_b32 v2, 128, v141
    buffer_load_dwordx4 v2, s[20:23], s44 offen  lds
    s_add_u32 m0, s53, 106496
    v_xor_b32 v2, 128, v142
    buffer_load_dwordx4 v2, s[20:23], s44 offen  lds
    s_add_u32 m0, s53, 107520
    v_xor_b32 v2, 128, v143
    buffer_load_dwordx4 v2, s[20:23], s44 offen  lds
    s_waitcnt vmcnt(22)
    s_barrier
    s_cmp_eq_u32 s34, 1
    s_cbranch_scc1 PWW_96
    s_cmp_eq_u32 s34, 2
    s_cbranch_scc1 PWW_97
    s_cmp_eq_u32 s34, 3
    s_cbranch_scc1 PWW_98
    ds_read_b64_tr_b16 a[88:89], v14 offset:0
    ds_read_b64_tr_b16 a[90:91], v14 offset:1536
    ds_read_b64_tr_b16 a[92:93], v14 offset:12288
    ds_read_b64_tr_b16 a[94:95], v14 offset:13824
    ds_read_b64_tr_b16 a[96:97], v15 offset:0
    ds_read_b64_tr_b16 a[98:99], v15 offset:1536
    ds_read_b64_tr_b16 a[100:101], v15 offset:12288
    ds_read_b64_tr_b16 a[102:103], v15 offset:13824
    ds_read_b64_tr_b16 a[104:105], v16 offset:0
    ds_read_b64_tr_b16 a[106:107], v16 offset:1536
    ds_read_b64_tr_b16 a[108:109], v16 offset:12288
    ds_read_b64_tr_b16 a[110:111], v16 offset:13824
    ds_read_b64_tr_b16 a[112:113], v14 offset:24576
    ds_read_b64_tr_b16 a[114:115], v14 offset:26112
    ds_read_b64_tr_b16 a[116:117], v14 offset:36864
    ds_read_b64_tr_b16 a[118:119], v14 offset:38400
    ds_read_b64_tr_b16 a[120:121], v15 offset:24576
    ds_read_b64_tr_b16 a[122:123], v15 offset:26112
    ds_read_b64_tr_b16 a[124:125], v15 offset:36864
    ds_read_b64_tr_b16 a[126:127], v15 offset:38400
    ds_read_b64_tr_b16 a[128:129], v16 offset:24576
    ds_read_b64_tr_b16 a[130:131], v16 offset:26112
    ds_read_b64_tr_b16 a[132:133], v16 offset:36864
    ds_read_b64_tr_b16 a[134:135], v16 offset:38400
    s_branch PW_94
PWW_96:
    ds_read_b64_tr_b16 a[16:17], v14 offset:0
    ds_read_b64_tr_b16 a[18:19], v14 offset:1536
    ds_read_b64_tr_b16 a[20:21], v14 offset:12288
    ds_read_b64_tr_b16 a[22:23], v14 offset:13824
    ds_read_b64_tr_b16 a[24:25], v15 offset:0
    ds_read_b64_tr_b16 a[26:27], v15 offset:1536
    ds_read_b64_tr_b16 a[28:29], v15 offset:12288
    ds_read_b64_tr_b16 a[30:31], v15 offset:13824
    ds_read_b64_tr_b16 a[32:33], v16 offset:0
    ds_read_b64_tr_b16 a[34:35], v16 offset:1536
    ds_read_b64_tr_b16 a[36:37], v16 offset:12288
    ds_read_b64_tr_b16 a[38:39], v16 offset:13824
    ds_read_b64_tr_b16 a[40:41], v14 offset:24576
    ds_read_b64_tr_b16 a[42:43], v14 offset:26112
    ds_read_b64_tr_b16 a[44:45], v14 offset:36864
    ds_read_b64_tr_b16 a[46:47], v14 offset:38400
    ds_read_b64_tr_b16 a[48:49], v15 offset:24576
    ds_read_b64_tr_b16 a[50:51], v15 offset:26112
    ds_read_b64_tr_b16 a[52:53], v15 offset:36864
    ds_read_b64_tr_b16 a[54:55], v15 offset:38400
    ds_read_b64_tr_b16 a[56:57], v16 offset:24576
    ds_read_b64_tr_b16 a[58:59], v16 offset:26112
    ds_read_b64_tr_b16 a[60:61], v16 offset:36864
    ds_read_b64_tr_b16 a[62:63], v16 offset:38400
    s_branch PW_94
PWW_97:
    ds_read_b64_tr_b16 v[24:25], v14 offset:0
    ds_read_b64_tr_b16 v[26:27], v14 offset:1536
    ds_read_b64_tr_b16 v[28:29], v14 offset:12288
    ds_read_b64_tr_b16 v[30:31], v14 offset:13824
    ds_read_b64_tr_b16 v[32:33], v15 offset:0
    ds_read_b64_tr_b16 v[34:35], v15 offset:1536
    ds_read_b64_tr_b16 v[36:37], v15 offset:12288
    ds_read_b64_tr_b16 v[38:39], v15 offset:13824
    ds_read_b64_tr_b16 v[40:41], v16 offset:0
    ds_read_b64_tr_b16 v[42:43], v16 offset:1536
    ds_read_b64_tr_b16 v[44:45], v16 offset:12288
    ds_read_b64_tr_b16 v[46:47], v16 offset:13824
    ds_read_b64_tr_b16 v[48:49], v14 offset:24576
    ds_read_b64_tr_b16 v[50:51], v14 offset:26112
    ds_read_b64_tr_b16 v[52:53], v14 offset:36864
    ds_read_b64_tr_b16 v[54:55], v14 offset:38400
    ds_read_b64_tr_b16 v[56:57], v15 offset:24576
    ds_read_b64_tr_b16 v[58:59], v15 offset:26112
    ds_read_b64_tr_b16 v[60:61], v15 offset:36864
    ds_read_b64_tr_b16 v[62:63], v15 offset:38400
    ds_read_b64_tr_b16 v[64:65], v16 offset:24576
    ds_read_b64_tr_b16 v[66:67], v16 offset:26112
    ds_read_b64_tr_b16 v[68:69], v16 offset:36864
    ds_read_b64_tr_b16 v[70:71], v16 offset:38400
    s_branch PW_94
PWW_98:
    ds_read_b64_tr_b16 a[136:137], v14 offset:0
    ds_read_b64_tr_b16 a[138:139], v14 offset:1536
    ds_read_b64_tr_b16 a[140:141], v14 offset:12288
    ds_read_b64_tr_b16 a[142:143], v14 offset:13824
    ds_read_b64_tr_b16 a[144:145], v15 offset:0
    ds_read_b64_tr_b16 a[146:147], v15 offset:1536
    ds_read_b64_tr_b16 a[148:149], v15 offset:12288
    ds_read_b64_tr_b16 a[150:151], v15 offset:13824
    ds_read_b64_tr_b16 a[152:153], v16 offset:0
    ds_read_b64_tr_b16 a[154:155], v16 offset:1536
    ds_read_b64_tr_b16 a[156:157], v16 offset:12288
    ds_read_b64_tr_b16 a[158:159], v16 offset:13824
    ds_read_b64_tr_b16 a[160:161], v14 offset:24576
    ds_read_b64_tr_b16 a[162:163], v14 offset:26112
    ds_read_b64_tr_b16 a[164:165], v14 offset:36864
    ds_read_b64_tr_b16 a[166:167], v14 offset:38400
    ds_read_b64_tr_b16 a[168:169], v15 offset:24576
    ds_read_b64_tr_b16 a[170:171], v15 offset:26112
    ds_read_b64_tr_b16 a[172:173], v15 offset:36864
    ds_read_b64_tr_b16 a[174:175], v15 offset:38400
    ds_read_b64_tr_b16 a[176:177], v16 offset:24576
    ds_read_b64_tr_b16 a[178:179], v16 offset:26112
    ds_read_b64_tr_b16 a[180:181], v16 offset:36864
    ds_read_b64_tr_b16 a[182:183], v16 offset:38400
PW_94:
    v_add_u32 v14, 49152, v14
    v_add_u32 v15, 49152, v15
    v_add_u32 v16, 49152, v16
    s_waitcnt lgkmcnt(0)
    s_barrier
    s_add_u32 m0, s53, 0
    s_add_u32 s44, s52, 40960
    buffer_load_dwordx4 v139, s[20:23], s44 offen  lds
    s_add_u32 m0, s53, 1024
    s_nop 0
    buffer_load_dwordx4 v140, s[20:23], s44 offen  lds
    s_add_u32 m0, s53, 2048
    s_nop 0
    buffer_load_dwordx4 v141, s[20:23], s44 offen  lds
    s_add_u32 m0, s53, 3072
    s_nop 0
    buffer_load_dwordx4 v142, s[20:23], s44 offen  lds
    s_add_u32 m0, s53, 4096
    s_nop 0
    buffer_load_dwordx4 v143, s[20:23], s44 offen  lds
    s_add_u32 m0, s53, 5120
    s_add_u32 s44, s52, 46080
    v_xor_b32 v2, 128, v139
    buffer_load_dwordx4 v2, s[20:23], s44 offen  lds
    s_add_u32 m0, s53, 6144
    v_xor_b32 v2, 128, v140
    buffer_load_dwordx4 v2, s[20:23], s44 offen  lds
    s_add_u32 m0, s53, 7168
    v_xor_b32 v2, 128, v141
    buffer_load_dwordx4 v2, s[20:23], s44 offen  lds
    s_add_u32 m0, s53, 8192
    v_xor_b32 v2, 128, v142
    buffer_load_dwordx4 v2, s[20:23], s44 offen  lds
    s_add_u32 m0, s53, 9216
    v_xor_b32 v2, 128, v143
    buffer_load_dwordx4 v2, s[20:23], s44 offen  lds
    s_waitcnt vmcnt(20)
    s_barrier
    s_cmp_eq_u32 s34, 1
    s_cbranch_scc1 PWW_101
    s_cmp_eq_u32 s34, 2
    s_cbranch_scc1 PWW_102
    s_cmp_eq_u32 s34, 3
    s_cbranch_scc1 PWW_103
    ds_read_b64_tr_b16 a[136:137], v14 offset:0
    ds_read_b64_tr_b16 a[138:139], v14 offset:1536
    ds_read_b64_tr_b16 a[140:141], v14 offset:12288
    ds_read_b64_tr_b16 a[142:143], v14 offset:13824
    ds_read_b64_tr_b16 a[144:145], v15 offset:0
    ds_read_b64_tr_b16 a[146:147], v15 offset:1536
    ds_read_b64_tr_b16 a[148:149], v15 offset:12288
    ds_read_b64_tr_b16 a[150:151], v15 offset:13824
    ds_read_b64_tr_b16 a[152:153], v16 offset:0
    ds_read_b64_tr_b16 a[154:155], v16 offset:1536
    ds_read_b64_tr_b16 a[156:157], v16 offset:12288
    ds_read_b64_tr_b16 a[158:159], v16 offset:13824
    ds_read_b64_tr_b16 a[160:161], v14 offset:24576
    ds_read_b64_tr_b16 a[162:163], v14 offset:26112
    ds_read_b64_tr_b16 a[164:165], v14 offset:36864
    ds_read_b64_tr_b16 a[166:167], v14 offset:38400
    ds_read_b64_tr_b16 a[168:169], v15 offset:24576
    ds_read_b64_tr_b16 a[170:171], v15 offset:26112
    ds_read_b64_tr_b16 a[172:173], v15 offset:36864
    ds_read_b64_tr_b16 a[174:175], v15 offset:38400
    ds_read_b64_tr_b16 a[176:177], v16 offset:24576
    ds_read_b64_tr_b16 a[178:179], v16 offset:26112
    ds_read_b64_tr_b16 a[180:181], v16 offset:36864
    ds_read_b64_tr_b16 a[182:183], v16 offset:38400
    s_branch PW_99
PWW_101:
    ds_read_b64_tr_b16 a[64:65], v14 offset:0
    ds_read_b64_tr_b16 a[66:67], v14 offset:1536
    ds_read_b64_tr_b16 a[68:69], v14 offset:12288
    ds_read_b64_tr_b16 a[70:71], v14 offset:13824
    ds_read_b64_tr_b16 a[72:73], v15 offset:0
    ds_read_b64_tr_b16 a[74:75], v15 offset:1536
    ds_read_b64_tr_b16 a[76:77], v15 offset:12288
    ds_read_b64_tr_b16 a[78:79], v15 offset:13824
    ds_read_b64_tr_b16 a[80:81], v16 offset:0
    ds_read_b64_tr_b16 a[82:83], v16 offset:1536
    ds_read_b64_tr_b16 a[84:85], v16 offset:12288
    ds_read_b64_tr_b16 a[86:87], v16 offset:13824
    ds_read_b64_tr_b16 a[88:89], v14 offset:24576
    ds_read_b64_tr_b16 a[90:91], v14 offset:26112
    ds_read_b64_tr_b16 a[92:93], v14 offset:36864
    ds_read_b64_tr_b16 a[94:95], v14 offset:38400
    ds_read_b64_tr_b16 a[96:97], v15 offset:24576
    ds_read_b64_tr_b16 a[98:99], v15 offset:26112
    ds_read_b64_tr_b16 a[100:101], v15 offset:36864
    ds_read_b64_tr_b16 a[102:103], v15 offset:38400
    ds_read_b64_tr_b16 a[104:105], v16 offset:24576
    ds_read_b64_tr_b16 a[106:107], v16 offset:26112
    ds_read_b64_tr_b16 a[108:109], v16 offset:36864
    ds_read_b64_tr_b16 a[110:111], v16 offset:38400
    s_branch PW_99
PWW_102:
    ds_read_b64_tr_b16 v[72:73], v14 offset:0
    ds_read_b64_tr_b16 v[74:75], v14 offset:1536
    ds_read_b64_tr_b16 v[76:77], v14 offset:12288
    ds_read_b64_tr_b16 v[78:79], v14 offset:13824
    ds_read_b64_tr_b16 a[0:1], v15 offset:0
    ds_read_b64_tr_b16 a[2:3], v15 offset:1536
    ds_read_b64_tr_b16 a[4:5], v15 offset:12288
    ds_read_b64_tr_b16 a[6:7], v15 offset:13824
    ds_read_b64_tr_b16 a[8:9], v16 offset:0
    ds_read_b64_tr_b16 a[10:11], v16 offset:1536
    ds_read_b64_tr_b16 a[12:13], v16 offset:12288
    ds_read_b64_tr_b16 a[14:15], v16 offset:13824
    ds_read_b64_tr_b16 a[16:17], v14 offset:24576
    ds_read_b64_tr_b16 a[18:19], v14 offset:26112
    ds_read_b64_tr_b16 a[20:21], v14 offset:36864
    ds_read_b64_tr_b16 a[22:23], v14 offset:38400
    ds_read_b64_tr_b16 a[24:25], v15 offset:24576
    ds_read_b64_tr_b16 a[26:27], v15 offset:26112
    ds_read_b64_tr_b16 a[28:29], v15 offset:36864
    ds_read_b64_tr_b16 a[30:31], v15 offset:38400
    ds_read_b64_tr_b16 a[32:33], v16 offset:24576
    ds_read_b64_tr_b16 a[34:35], v16 offset:26112
    ds_read_b64_tr_b16 a[36:37], v16 offset:36864
    ds_read_b64_tr_b16 a[38:39], v16 offset:38400
    s_branch PW_99
PWW_103:
    ds_read_b64_tr_b16 v[24:25], v14 offset:0
    ds_read_b64_tr_b16 v[26:27], v14 offset:1536
    ds_read_b64_tr_b16 v[28:29], v14 offset:12288
    ds_read_b64_tr_b16 v[30:31], v14 offset:13824
    ds_read_b64_tr_b16 v[32:33], v15 offset:0
    ds_read_b64_tr_b16 v[34:35], v15 offset:1536
    ds_read_b64_tr_b16 v[36:37], v15 offset:12288
    ds_read_b64_tr_b16 v[38:39], v15 offset:13824
    ds_read_b64_tr_b16 v[40:41], v16 offset:0
    ds_read_b64_tr_b16 v[42:43], v16 offset:1536
    ds_read_b64_tr_b16 v[44:45], v16 offset:12288
    ds_read_b64_tr_b16 v[46:47], v16 offset:13824
    ds_read_b64_tr_b16 v[48:49], v14 offset:24576
    ds_read_b64_tr_b16 v[50:51], v14 offset:26112
    ds_read_b64_tr_b16 v[52:53], v14 offset:36864
    ds_read_b64_tr_b16 v[54:55], v14 offset:38400
    ds_read_b64_tr_b16 v[56:57], v15 offset:24576
    ds_read_b64_tr_b16 v[58:59], v15 offset:26112
    ds_read_b64_tr_b16 v[60:61], v15 offset:36864
    ds_read_b64_tr_b16 v[62:63], v15 offset:38400
    ds_read_b64_tr_b16 v[64:65], v16 offset:24576
    ds_read_b64_tr_b16 v[66:67], v16 offset:26112
    ds_read_b64_tr_b16 v[68:69], v16 offset:36864
    ds_read_b64_tr_b16 v[70:71], v16 offset:38400
PW_99:
    v_add_u32 v14, 49152, v14
    v_add_u32 v15, 49152, v15
    v_add_u32 v16, 49152, v16
    s_waitcnt lgkmcnt(0)
    s_barrier
    s_add_u32 m0, s53, 49152
    s_add_u32 s44, s52, 81920
    buffer_load_dwordx4 v139, s[20:23], s44 offen  lds
    s_add_u32 m0, s53, 50176
    s_nop 0
    buffer_load_dwordx4 v140, s[20:23], s44 offen  lds
    s_add_u32 m0, s53, 51200
    s_nop 0
    buffer_load_dwordx4 v141, s[20:23], s44 offen  lds
    s_add_u32 m0, s53, 52224
    s_nop 0
    buffer_load_dwordx4 v142, s[20:23], s44 offen  lds
    s_add_u32 m0, s53, 53248
    s_nop 0
    buffer_load_dwordx4 v143, s[20:23], s44 offen  lds
    s_add_u32 m0, s53, 54272
    s_add_u32 s44, s52, 87040
    v_xor_b32 v2, 128, v139
    buffer_load_dwordx4 v2, s[20:23], s44 offen  lds
    s_add_u32 m0, s53, 55296
    v_xor_b32 v2, 128, v140
    buffer_load_dwordx4 v2, s[20:23], s44 offen  lds
    s_add_u32 m0, s53, 56320
    v_xor_b32 v2, 128, v141
    buffer_load_dwordx4 v2, s[20:23], s44 offen  lds
    s_add_u32 m0, s53, 57344
    v_xor_b32 v2, 128, v142
    buffer_load_dwordx4 v2, s[20:23], s44 offen  lds
    s_add_u32 m0, s53, 58368
    v_xor_b32 v2, 128, v143
    buffer_load_dwordx4 v2, s[20:23], s44 offen  lds
    s_waitcnt vmcnt(20)
    s_barrier
    s_add_u32 s44, s54, 0
    v_xad_u32 v2, s44, v18, v17
    ds_read_b64_tr_b16 a[184:185], v2 offset:0
    ds_read_b64_tr_b16 a[186:187], v2 offset:20480
    s_add_u32 s44, s54, 32
    v_xad_u32 v3, s44, v18, v17
    ds_read_b64_tr_b16 a[208:209], v3 offset:0
    ds_read_b64_tr_b16 a[210:211], v3 offset:20480
    s_add_u32 s44, s54, 64
    v_xad_u32 v2, s44, v18, v17
    ds_read_b64_tr_b16 a[232:233], v2 offset:0
    ds_read_b64_tr_b16 a[234:235], v2 offset:20480
    s_add_u32 s44, s54, 96
    v_xad_u32 v3, s44, v18, v17
    ds_read_b64_tr_b16 v[80:81], v3 offset:0
    ds_read_b64_tr_b16 v[82:83], v3 offset:20480
    s_add_u32 s44, s54, 128
    v_xad_u32 v2, s44, v18, v17
    ds_read_b64_tr_b16 v[104:105], v2 offset:0
    ds_read_b64_tr_b16 v[106:107], v2 offset:20480
    s_add_u32 s44, s54, 160
    v_xad_u32 v3, s44, v18, v17
    ds_read_b64_tr_b16 v[128:129], v3 offset:0
    ds_read_b64_tr_b16 v[130:131], v3 offset:20480
    s_add_u32 s44, s54, 192
    v_xad_u32 v2, s44, v18, v17
    ds_read_b64_tr_b16 v[160:161], v2 offset:0
    ds_read_b64_tr_b16 v[162:163], v2 offset:20480
    s_add_u32 s44, s54, 224
    v_xad_u32 v3, s44, v18, v17
    ds_read_b64_tr_b16 v[184:185], v3 offset:0
    ds_read_b64_tr_b16 v[186:187], v3 offset:20480
    s_add_u32 s44, s54, 256
    v_xad_u32 v2, s44, v18, v17
    ds_read_b64_tr_b16 v[208:209], v2 offset:0
    ds_read_b64_tr_b16 v[210:211], v2 offset:20480
    s_add_u32 s44, s54, 288
    v_xad_u32 v3, s44, v18, v17
    ds_read_b64_tr_b16 v[232:233], v3 offset:0
    ds_read_b64_tr_b16 v[234:235], v3 offset:20480
    v_add_u32 v17, -98304, v17
    s_waitcnt lgkmcnt(0)
    s_barrier
    s_add_u32 m0, s53, 98304
    s_add_u32 s44, s52, 122880
    buffer_load_dwordx4 v139, s[20:23], s44 offen  lds
    s_add_u32 m0, s53, 99328
    s_nop 0
    buffer_load_dwordx4 v140, s[20:23], s44 offen  lds
    s_add_u32 m0, s53, 100352
    s_nop 0
    buffer_load_dwordx4 v141, s[20:23], s44 offen  lds
    s_add_u32 m0, s53, 101376
    s_nop 0
    buffer_load_dwordx4 v142, s[20:23], s44 offen  lds
    s_add_u32 m0, s53, 102400
    s_nop 0
    buffer_load_dwordx4 v143, s[20:23], s44 offen  lds
    s_add_u32 m0, s53, 103424
    s_add_u32 s44, s52, 128000
    v_xor_b32 v2, 128, v139
    buffer_load_dwordx4 v2, s[20:23], s44 offen  lds
    s_add_u32 m0, s53, 104448
    v_xor_b32 v2, 128, v140
    buffer_load_dwordx4 v2, s[20:23], s44 offen  lds
    s_add_u32 m0, s53, 105472
    v_xor_b32 v2, 128, v141
    buffer_load_dwordx4 v2, s[20:23], s44 offen  lds
    s_add_u32 m0, s53, 106496
    v_xor_b32 v2, 128, v142
    buffer_load_dwordx4 v2, s[20:23], s44 offen  lds
    s_add_u32 m0, s53, 107520
    v_xor_b32 v2, 128, v143
    buffer_load_dwordx4 v2, s[20:23], s44 offen  lds
    s_waitcnt vmcnt(20)
    s_barrier
    s_add_u32 s44, s54, 0
    v_xad_u32 v2, s44, v18, v17
    ds_read_b64_tr_b16 a[188:189], v2 offset:0
    ds_read_b64_tr_b16 a[190:191], v2 offset:20480
    s_add_u32 s44, s54, 32
    v_xad_u32 v3, s44, v18, v17
    ds_read_b64_tr_b16 a[212:213], v3 offset:0
    ds_read_b64_tr_b16 a[214:215], v3 offset:20480
    s_add_u32 s44, s54, 64
    v_xad_u32 v2, s44, v18, v17
    ds_read_b64_tr_b16 a[236:237], v2 offset:0
    ds_read_b64_tr_b16 a[238:239], v2 offset:20480
    s_add_u32 s44, s54, 96
    v_xad_u32 v3, s44, v18, v17
    ds_read_b64_tr_b16 v[84:85], v3 offset:0
    ds_read_b64_tr_b16 v[86:87], v3 offset:20480
    s_add_u32 s44, s54, 128
    v_xad_u32 v2, s44, v18, v17
    ds_read_b64_tr_b16 v[108:109], v2 offset:0
    ds_read_b64_tr_b16 v[110:111], v2 offset:20480
    s_add_u32 s44, s54, 160
    v_xad_u32 v3, s44, v18, v17
    ds_read_b64_tr_b16 v[132:133], v3 offset:0
    ds_read_b64_tr_b16 v[134:135], v3 offset:20480
    s_add_u32 s44, s54, 192
    v_xad_u32 v2, s44, v18, v17
    ds_read_b64_tr_b16 v[164:165], v2 offset:0
    ds_read_b64_tr_b16 v[166:167], v2 offset:20480
    s_add_u32 s44, s54, 224
    v_xad_u32 v3, s44, v18, v17
    ds_read_b64_tr_b16 v[188:189], v3 offset:0
    ds_read_b64_tr_b16 v[190:191], v3 offset:20480
    s_add_u32 s44, s54, 256
    v_xad_u32 v2, s44, v18, v17
    ds_read_b64_tr_b16 v[212:213], v2 offset:0
    ds_read_b64_tr_b16 v[214:215], v2 offset:20480
    s_add_u32 s44, s54, 288
    v_xad_u32 v3, s44, v18, v17
    ds_read_b64_tr_b16 v[236:237], v3 offset:0
    ds_read_b64_tr_b16 v[238:239], v3 offset:20480
    v_add_u32 v17, 49152, v17
    s_waitcnt lgkmcnt(0)
    s_barrier
    s_add_u32 m0, s53, 0
    s_add_u32 s44, s52, 163840
    buffer_load_dwordx4 v139, s[20:23], s44 offen  lds
    s_add_u32 m0, s53, 1024
    s_nop 0
    buffer_load_dwordx4 v140, s[20:23], s44 offen  lds
    s_add_u32 m0, s53, 2048
    s_nop 0
    buffer_load_dwordx4 v141, s[20:23], s44 offen  lds
    s_add_u32 m0, s53, 3072
    s_nop 0
    buffer_load_dwordx4 v142, s[20:23], s44 offen  lds
    s_add_u32 m0, s53, 4096
    s_nop 0
    buffer_load_dwordx4 v143, s[20:23], s44 offen  lds
    s_add_u32 m0, s53, 5120
    s_add_u32 s44, s52, 168960
    v_xor_b32 v2, 128, v139
    buffer_load_dwordx4 v2, s[20:23], s44 offen  lds
    s_add_u32 m0, s53, 6144
    v_xor_b32 v2, 128, v140
    buffer_load_dwordx4 v2, s[20:23], s44 offen  lds
    s_add_u32 m0, s53, 7168
    v_xor_b32 v2, 128, v141
    buffer_load_dwordx4 v2, s[20:23], s44 offen  lds
    s_add_u32 m0, s53, 8192
    v_xor_b32 v2, 128, v142
    buffer_load_dwordx4 v2, s[20:23], s44 offen  lds
    s_add_u32 m0, s53, 9216
    v_xor_b32 v2, 128, v143
    buffer_load_dwordx4 v2, s[20:23], s44 offen  lds
    s_waitcnt vmcnt(20)
    s_barrier
    s_add_u32 s44, s54, 0
    v_xad_u32 v2, s44, v18, v17
    ds_read_b64_tr_b16 a[192:193], v2 offset:0
    ds_read_b64_tr_b16 a[194:195], v2 offset:20480
    s_add_u32 s44, s54, 32
    v_xad_u32 v3, s44, v18, v17
    ds_read_b64_tr_b16 a[216:217], v3 offset:0
    ds_read_b64_tr_b16 a[218:219], v3 offset:20480
    s_add_u32 s44, s54, 64
    v_xad_u32 v2, s44, v18, v17
    ds_read_b64_tr_b16 a[240:241], v2 offset:0
    ds_read_b64_tr_b16 a[242:243], v2 offset:20480
    s_add_u32 s44, s54, 96
    v_xad_u32 v3, s44, v18, v17
    ds_read_b64_tr_b16 v[88:89], v3 offset:0
    ds_read_b64_tr_b16 v[90:91], v3 offset:20480
    s_add_u32 s44, s54, 128
    v_xad_u32 v2, s44, v18, v17
    ds_read_b64_tr_b16 v[112:113], v2 offset:0
    ds_read_b64_tr_b16 v[114:115], v2 offset:20480
    s_add_u32 s44, s54, 160
    v_xad_u32 v3, s44, v18, v17
    ds_read_b64_tr_b16 v[144:145], v3 offset:0
    ds_read_b64_tr_b16 v[146:147], v3 offset:20480
    s_add_u32 s44, s54, 192
    v_xad_u32 v2, s44, v18, v17
    ds_read_b64_tr_b16 v[168:169], v2 offset:0
    ds_read_b64_tr_b16 v[170:171], v2 offset:20480
    s_add_u32 s44, s54, 224
    v_xad_u32 v3, s44, v18, v17
    ds_read_b64_tr_b16 v[192:193], v3 offset:0
    ds_read_b64_tr_b16 v[194:195], v3 offset:20480
    s_add_u32 s44, s54, 256
    v_xad_u32 v2, s44, v18, v17
    ds_read_b64_tr_b16 v[216:217], v2 offset:0
    ds_read_b64_tr_b16 v[218:219], v2 offset:20480
    s_add_u32 s44, s54, 288
    v_xad_u32 v3, s44, v18, v17
    ds_read_b64_tr_b16 v[240:241], v3 offset:0
    ds_read_b64_tr_b16 v[242:243], v3 offset:20480
    v_add_u32 v17, 49152, v17
    s_waitcnt lgkmcnt(0)
    s_barrier
    s_add_u32 m0, s53, 49152
    s_add_u32 s44, s52, 204800
    buffer_load_dwordx4 v139, s[20:23], s44 offen  lds
    s_add_u32 m0, s53, 50176
    s_nop 0
    buffer_load_dwordx4 v140, s[20:23], s44 offen  lds
    s_add_u32 m0, s53, 51200
    s_nop 0
    buffer_load_dwordx4 v141, s[20:23], s44 offen  lds
    s_add_u32 m0, s53, 52224
    s_nop 0
    buffer_load_dwordx4 v142, s[20:23], s44 offen  lds
    s_add_u32 m0, s53, 53248
    s_nop 0
    buffer_load_dwordx4 v143, s[20:23], s44 offen  lds
    s_add_u32 m0, s53, 54272
    s_add_u32 s44, s52, 209920
    v_xor_b32 v2, 128, v139
    buffer_load_dwordx4 v2, s[20:23], s44 offen  lds
    s_add_u32 m0, s53, 55296
    v_xor_b32 v2, 128, v140
    buffer_load_dwordx4 v2, s[20:23], s44 offen  lds
    s_add_u32 m0, s53, 56320
    v_xor_b32 v2, 128, v141
    buffer_load_dwordx4 v2, s[20:23], s44 offen  lds
    s_add_u32 m0, s53, 57344
    v_xor_b32 v2, 128, v142
    buffer_load_dwordx4 v2, s[20:23], s44 offen  lds
    s_add_u32 m0, s53, 58368
    v_xor_b32 v2, 128, v143
    buffer_load_dwordx4 v2, s[20:23], s44 offen  lds
    s_waitcnt vmcnt(20)
    s_barrier
    s_add_u32 s44, s54, 0
    v_xad_u32 v2, s44, v18, v17
    ds_read_b64_tr_b16 a[196:197], v2 offset:0
    ds_read_b64_tr_b16 a[198:199], v2 offset:20480
    s_add_u32 s44, s54, 32
    v_xad_u32 v3, s44, v18, v17
    ds_read_b64_tr_b16 a[220:221], v3 offset:0
    ds_read_b64_tr_b16 a[222:223], v3 offset:20480
    s_add_u32 s44, s54, 64
    v_xad_u32 v2, s44, v18, v17
    ds_read_b64_tr_b16 a[244:245], v2 offset:0
    ds_read_b64_tr_b16 a[246:247], v2 offset:20480
    s_add_u32 s44, s54, 96
    v_xad_u32 v3, s44, v18, v17
    ds_read_b64_tr_b16 v[92:93], v3 offset:0
    ds_read_b64_tr_b16 v[94:95], v3 offset:20480
    s_add_u32 s44, s54, 128
    v_xad_u32 v2, s44, v18, v17
    ds_read_b64_tr_b16 v[116:117], v2 offset:0
    ds_read_b64_tr_b16 v[118:119], v2 offset:20480
    s_add_u32 s44, s54, 160
    v_xad_u32 v3, s44, v18, v17
    ds_read_b64_tr_b16 v[148:149], v3 offset:0
    ds_read_b64_tr_b16 v[150:151], v3 offset:20480
    s_add_u32 s44, s54, 192
    v_xad_u32 v2, s44, v18, v17
    ds_read_b64_tr_b16 v[172:173], v2 offset:0
    ds_read_b64_tr_b16 v[174:175], v2 offset:20480
    s_add_u32 s44, s54, 224
    v_xad_u32 v3, s44, v18, v17
    ds_read_b64_tr_b16 v[196:197], v3 offset:0
    ds_read_b64_tr_b16 v[198:199], v3 offset:20480
    s_add_u32 s44, s54, 256
    v_xad_u32 v2, s44, v18, v17
    ds_read_b64_tr_b16 v[220:221], v2 offset:0
    ds_read_b64_tr_b16 v[222:223], v2 offset:20480
    s_add_u32 s44, s54, 288
    v_xad_u32 v3, s44, v18, v17
    ds_read_b64_tr_b16 v[244:245], v3 offset:0
    ds_read_b64_tr_b16 v[246:247], v3 offset:20480
    v_add_u32 v17, -98304, v17
    s_waitcnt vmcnt(10)
    s_barrier
    s_add_u32 s44, s54, 0
    v_xad_u32 v2, s44, v18, v17
    ds_read_b64_tr_b16 a[200:201], v2 offset:0
    ds_read_b64_tr_b16 a[202:203], v2 offset:20480
    s_add_u32 s44, s54, 32
    v_xad_u32 v3, s44, v18, v17
    ds_read_b64_tr_b16 a[224:225], v3 offset:0
    ds_read_b64_tr_b16 a[226:227], v3 offset:20480
    s_add_u32 s44, s54, 64
    v_xad_u32 v2, s44, v18, v17
    ds_read_b64_tr_b16 a[248:249], v2 offset:0
    ds_read_b64_tr_b16 a[250:251], v2 offset:20480
    s_add_u32 s44, s54, 96
    v_xad_u32 v3, s44, v18, v17
    ds_read_b64_tr_b16 v[96:97], v3 offset:0
    ds_read_b64_tr_b16 v[98:99], v3 offset:20480
    s_add_u32 s44, s54, 128
    v_xad_u32 v2, s44, v18, v17
    ds_read_b64_tr_b16 v[120:121], v2 offset:0
    ds_read_b64_tr_b16 v[122:123], v2 offset:20480
    s_add_u32 s44, s54, 160
    v_xad_u32 v3, s44, v18, v17
    ds_read_b64_tr_b16 v[152:153], v3 offset:0
    ds_read_b64_tr_b16 v[154:155], v3 offset:20480
    s_add_u32 s44, s54, 192
    v_xad_u32 v2, s44, v18, v17
    ds_read_b64_tr_b16 v[176:177], v2 offset:0
    ds_read_b64_tr_b16 v[178:179], v2 offset:20480
    s_add_u32 s44, s54, 224
    v_xad_u32 v3, s44, v18, v17
    ds_read_b64_tr_b16 v[200:201], v3 offset:0
    ds_read_b64_tr_b16 v[202:203], v3 offset:20480
    s_add_u32 s44, s54, 256
    v_xad_u32 v2, s44, v18, v17
    ds_read_b64_tr_b16 v[224:225], v2 offset:0
    ds_read_b64_tr_b16 v[226:227], v2 offset:20480
    s_add_u32 s44, s54, 288
    v_xad_u32 v3, s44, v18, v17
    ds_read_b64_tr_b16 v[248:249], v3 offset:0
    ds_read_b64_tr_b16 v[250:251], v3 offset:20480
    v_add_u32 v17, 49152, v17
    s_waitcnt vmcnt(0)
    s_barrier
    s_add_u32 s44, s54, 0
    v_xad_u32 v2, s44, v18, v17
    ds_read_b64_tr_b16 a[204:205], v2 offset:0
    ds_read_b64_tr_b16 a[206:207], v2 offset:20480
    s_add_u32 s44, s54, 32
    v_xad_u32 v3, s44, v18, v17
    ds_read_b64_tr_b16 a[228:229], v3 offset:0
    ds_read_b64_tr_b16 a[230:231], v3 offset:20480
    s_add_u32 s44, s54, 64
    v_xad_u32 v2, s44, v18, v17
    ds_read_b64_tr_b16 a[252:253], v2 offset:0
    ds_read_b64_tr_b16 a[254:255], v2 offset:20480
    s_add_u32 s44, s54, 96
    v_xad_u32 v3, s44, v18, v17
    ds_read_b64_tr_b16 v[100:101], v3 offset:0
    ds_read_b64_tr_b16 v[102:103], v3 offset:20480
    s_add_u32 s44, s54, 128
    v_xad_u32 v2, s44, v18, v17
    ds_read_b64_tr_b16 v[124:125], v2 offset:0
    ds_read_b64_tr_b16 v[126:127], v2 offset:20480
    s_add_u32 s44, s54, 160
    v_xad_u32 v3, s44, v18, v17
    ds_read_b64_tr_b16 v[156:157], v3 offset:0
    ds_read_b64_tr_b16 v[158:159], v3 offset:20480
    s_add_u32 s44, s54, 192
    v_xad_u32 v2, s44, v18, v17
    ds_read_b64_tr_b16 v[180:181], v2 offset:0
    ds_read_b64_tr_b16 v[182:183], v2 offset:20480
    s_add_u32 s44, s54, 224
    v_xad_u32 v3, s44, v18, v17
    ds_read_b64_tr_b16 v[204:205], v3 offset:0
    ds_read_b64_tr_b16 v[206:207], v3 offset:20480
    s_add_u32 s44, s54, 256
    v_xad_u32 v2, s44, v18, v17
    ds_read_b64_tr_b16 v[228:229], v2 offset:0
    ds_read_b64_tr_b16 v[230:231], v2 offset:20480
    s_add_u32 s44, s54, 288
    v_xad_u32 v3, s44, v18, v17
    ds_read_b64_tr_b16 v[252:253], v3 offset:0
    ds_read_b64_tr_b16 v[254:255], v3 offset:20480
    v_add_u32 v17, 49152, v17
    s_waitcnt lgkmcnt(0)
    s_barrier
    s_mul_i32 s44, s40, 40960
    s_lshl_b32 s46, s34, 10
    s_add_u32 s46, s46, 114688
    s_add_u32 m0, s46, 0
    s_nop 0
    buffer_load_dwordx4 v11, s[24:27], s44 offen  lds
    s_add_u32 m0, s46, 4096
    s_add_u32 s44, s44, 128
    buffer_load_dwordx4 v11, s[24:27], s44 offen  lds
    s_add_u32 m0, s46, 8192
    s_add_u32 s44, s44, 128
    buffer_load_dwordx4 v11, s[24:27], s44 offen  lds
    s_add_u32 m0, s46, 12288
    s_add_u32 s44, s44, 128
    buffer_load_dwordx4 v11, s[24:27], s44 offen  lds
    s_add_u32 m0, s46, 16384
    s_add_u32 s44, s44, 128
    buffer_load_dwordx4 v11, s[24:27], s44 offen  lds
    s_add_u32 m0, s46, 20480
    s_add_u32 s44, s44, 128
    buffer_load_dwordx4 v11, s[24:27], s44 offen  lds
    s_add_u32 m0, s46, 24576
    s_add_u32 s44, s44, 128
    buffer_load_dwordx4 v11, s[24:27], s44 offen  lds
    s_add_u32 m0, s46, 28672
    s_add_u32 s44, s44, 128
    buffer_load_dwordx4 v11, s[24:27], s44 offen  lds
    s_add_u32 m0, s46, 32768
    s_add_u32 s44, s44, 128
    buffer_load_dwordx4 v11, s[24:27], s44 offen  lds
    s_add_u32 m0, s46, 36864
    s_add_u32 s44, s44, 128
    buffer_load_dwordx4 v11, s[24:27], s44 offen  lds
    ds_write_b128 v10, v[24:27] offset:0
    ds_write_b128 v10, v[28:31] offset:1024
    ds_write_b128 v10, v[32:35] offset:2048
    ds_write_b128 v10, v[36:39] offset:3072
    ds_write_b128 v10, v[40:43] offset:4096
    ds_write_b128 v10, v[44:47] offset:5120
    ds_write_b128 v10, v[48:51] offset:6144
    ds_write_b128 v10, v[52:55] offset:7168
    ds_write_b128 v10, v[56:59] offset:8192
    ds_write_b128 v10, v[60:63] offset:9216
    ds_write_b128 v10, v[64:67] offset:10240
    ds_write_b128 v10, v[68:71] offset:11264
    ds_write_b128 v10, v[72:75] offset:12288
    ds_write_b128 v10, v[76:79] offset:13312
    ds_write_b128 v10, v[80:83] offset:14336
    ds_write_b128 v10, v[84:87] offset:15360
    ds_write_b128 v10, v[88:91] offset:16384
    ds_write_b128 v10, v[92:95] offset:17408
    ds_write_b128 v10, v[96:99] offset:18432
    ds_write_b128 v10, v[100:103] offset:19456
    ds_write_b128 v10, v[104:107] offset:20480
    ds_write_b128 v10, v[108:111] offset:21504
    ds_write_b128 v10, v[112:115] offset:22528
    ds_write_b128 v10, v[116:119] offset:23552
    ds_write_b128 v10, v[120:123] offset:24576
    ds_write_b128 v10, v[124:127] offset:25600
    ds_write_b128 v10, v[128:131] offset:26624
    ds_write_b128 v10, v[132:135] offset:27648
    s_waitcnt vmcnt(10) lgkmcnt(0)
    v_and_b32 v2, 15, v1
    v_lshrrev_b32 v3, 4, v1
    v_lshrrev_b32 v4, 3, v2
    v_lshlrev_b32 v4, 4, v4
    v_bfe_u32 v5, v2, 1, 1
    v_add_u32 v4, v5, v4
    v_lshl_add_u32 v4, v3, 2, v4
    v_lshlrev_b32 v4, 4, v4
    v_bfe_u32 v5, v2, 2, 1
    v_lshl_add_u32 v4, v5, 3, v4
    v_and_b32 v5, 1, v2
    v_lshl_add_u32 v4, v5, 1, v4
    s_mul_i32 s44, s34, 3
    s_add_u32 s44, s44, 0
    s_lshr_b32 s45, s44, 1
    s_and_b32 s46, s44, 1
    s_lshl_b32 s47, s45, 9
    s_lshl_b32 s48, s46, 2
    s_add_u32 s47, s47, s48
    s_add_u32 s47, s47, 157696
    v_add_u32 v14, s47, v4
    s_lshl_b32 s47, s45, 10
    s_lshl_b32 s48, s46, 3
    s_add_u32 s47, s47, s48
    v_add_u32 v17, s47, v13
    s_mul_i32 s44, s34, 3
    s_add_u32 s44, s44, 1
    s_lshr_b32 s45, s44, 1
    s_and_b32 s46, s44, 1
    s_lshl_b32 s47, s45, 9
    s_lshl_b32 s48, s46, 2
    s_add_u32 s47, s47, s48
    s_add_u32 s47, s47, 157696
    v_add_u32 v15, s47, v4
    s_lshl_b32 s47, s45, 10
    s_lshl_b32 s48, s46, 3
    s_add_u32 s47, s47, s48
    v_add_u32 v18, s47, v13
    s_mul_i32 s44, s34, 3
    s_add_u32 s44, s44, 2
    s_lshr_b32 s45, s44, 1
    s_and_b32 s46, s44, 1
    s_lshl_b32 s47, s45, 9
    s_lshl_b32 s48, s46, 2
    s_add_u32 s47, s47, s48
    s_add_u32 s47, s47, 157696
    v_add_u32 v16, s47, v4
    s_lshl_b32 s47, s45, 10
    s_lshl_b32 s48, s46, 3
    s_add_u32 s47, s47, s48
    v_add_u32 v19, s47, v13
    s_mov_b32 s35, s40
    s_mov_b32 s57, s40
    s_mov_b32 s42, 0
    v_mov_b32 v3, 128
WST_104:
    buffer_load_dwordx2 v[4:5], v3, s[12:15], 0 offen sc1
    s_waitcnt vmcnt(0)
    v_readfirstlane_b32 s44, v4
    v_readfirstlane_b32 s39, v5
    s_cmp_lg_u32 s44, 0
    s_cbranch_scc1 WSO_105
    s_sleep 4
    s_add_u32 s42, s42, 1
    s_cmp_lt_u32 s42, s37
    s_cbranch_scc1 WST_104
    s_mov_b32 s37, 1
WSO_105:
    s_cmp_lg_u32 s100, 0
    s_cbranch_scc1 WSE_107
    s_cmp_eq_u32 s44, 2
    s_cbranch_scc1 L_fallback
WSE_107:
    s_mul_i32 s44, s40, 0x11111111
    s_xor_b32 s39, s39, s44
    s_xor_b32 s39, s39, 0x11111111
    s_lshl_b32 s62, s34, 14
    s_lshl_b32 s44, s41, 7
    s_add_u32 s62, s62, s44
    s_lshl_b32 s44, s33, 2
    s_add_u32 s62, s62, s44
    s_add_u32 s62, s62, 1835008
    s_lshr_b32 s43, s62, 19
    s_and_b32 s43, s43, 28
    s_lshr_b32 s43, s39, s43
    s_and_b32 s43, s43, 1
    s_lshl_b32 s43, s43, 13
    s_add_u32 s62, s62, s43
    s_sub_u32 s62, s62, 32
    s_cmp_eq_u32 s33, 8
    s_cselect_b32 s92, 0x3ff, 0
    s_mov_b32 s93, 0
    s_lshr_b32 s43, s35, 1
    s_add_u32 s43, s43, 3
    s_bfe_u32 s53, s43, 0x10001
    s_lshl_b32 s53, s53, 21
    s_and_b32 s43, s43, 1
    s_mul_i32 s43, s43, 655360
    s_add_u32 s53, s53, s43
    s_add_u32 s53, s53, s61
    s_lshr_b32 s43, s53, 19
    s_and_b32 s43, s43, 28
    s_lshr_b32 s43, s39, s43
    s_and_b32 s43, s43, 1
    s_lshl_b32 s43, s43, 13
    s_add_u32 s53, s53, s43
    v_and_b32 v3, 0x7fff, v8
    v_lshrrev_b32 v5, 15, v8
    v_lshl_add_u32 v3, v5, 3, v3
    v_and_b32 v1, 0xc000, v8
    v_add_u32 v1, v1, v8
    s_waitcnt vmcnt(0)
    s_barrier
L_V_loop:
    s_cmp_ge_u32 s57, 64
    s_cbranch_scc1 L_V_last
    s_barrier
    s_lshl_b32 s95, s85, 12
    v_add_u32 v4, s95, v0
    v_xor_b32 v5, 64, v4
    ds_read_b128 v[48:51], v4 offset:12288
    ds_read_b128 v[52:55], v4 offset:14336
    ds_read_b128 v[56:59], v5 offset:12288
    ds_read_b128 v[60:63], v5 offset:14336
    s_lshl_b32 s95, s86, 12
    v_add_u32 v4, s95, v0
    v_xor_b32 v5, 64, v4
    ds_read_b128 v[64:67], v4 offset:16384
    ds_read_b128 v[68:71], v4 offset:18432
    ds_read_b128 v[72:75], v5 offset:16384
    ds_read_b128 v[76:79], v5 offset:18432
    s_waitcnt lgkmcnt(6)
    v_mfma_f32_16x16x32_bf16 v[24:27], a[16:19], v[48:51], 0
    ds_read_b128 v[80:83], v4 offset:20480
    v_mfma_f32_16x16x32_bf16 v[28:31], a[16:19], v[52:55], 0
    ds_read_b128 v[84:87], v4 offset:22528
    v_mfma_f32_16x16x32_bf16 v[32:35], a[24:27], v[48:51], 0
    s_lshr_b32 s50, s57, 1
    v_mfma_f32_16x16x32_bf16 v[36:39], a[24:27], v[52:55], 0
    s_and_b32 s50, s50, 3
    ds_read_b128 v[88:91], v10 offset:0
    v_mfma_f32_16x16x32_bf16 v[40:43], a[32:35], v[48:51], 0
    s_mul_i32 s50, s50, 160
    v_mfma_f32_16x16x32_bf16 v[44:47], a[32:35], v[52:55], 0
    s_mul_i32 s44, s34, 40
    ds_read_b128 v[92:95], v10 offset:1024
    s_waitcnt lgkmcnt(8)
    v_mfma_f32_16x16x32_bf16 v[24:27], a[20:23], v[56:59], v[24:27]
    ds_read_b128 v[48:51], v5 offset:20480
    v_mfma_f32_16x16x32_bf16 v[28:31], a[20:23], v[60:63], v[28:31]
    ds_read_b128 v[52:55], v5 offset:22528
    v_mfma_f32_16x16x32_bf16 v[32:35], a[28:31], v[56:59], v[32:35]
    s_add_u32 s50, s50, s44
    v_mfma_f32_16x16x32_bf16 v[36:39], a[28:31], v[60:63], v[36:39]
    s_add_u32 s50, s50, s41
    ds_read_b128 v[96:99], v10 offset:2048
    v_mfma_f32_16x16x32_bf16 v[40:43], a[36:39], v[56:59], v[40:43]
    s_lshl_b32 s50, s50, 14
    v_mfma_f32_16x16x32_bf16 v[44:47], a[36:39], v[60:63], v[44:47]
    s_and_b32 s44, s33, 7
    ds_read_b128 v[100:103], v10 offset:3072
    s_waitcnt lgkmcnt(10)
    v_mfma_f32_16x16x32_bf16 v[24:27], a[40:43], v[64:67], v[24:27]
    ds_read_b128 v[56:59], v4 offset:24576
    v_mfma_f32_16x16x32_bf16 v[28:31], a[40:43], v[68:71], v[28:31]
    ds_read_b128 v[60:63], v4 offset:26624
    v_mfma_f32_16x16x32_bf16 v[32:35], a[48:51], v[64:67], v[32:35]
    s_lshl_b32 s44, s44, 10
    v_mfma_f32_16x16x32_bf16 v[36:39], a[48:51], v[68:71], v[36:39]
    s_add_u32 s50, s50, s44
    ds_read_b128 v[104:107], v10 offset:4096
    v_mfma_f32_16x16x32_bf16 v[40:43], a[56:59], v[64:67], v[40:43]
    s_add_u32 s50, s50, 4194304
    v_mfma_f32_16x16x32_bf16 v[44:47], a[56:59], v[68:71], v[44:47]
    s_add_u32 s63, s57, 2
    ds_read_b128 v[108:111], v10 offset:5120
    s_waitcnt lgkmcnt(12)
    v_mfma_f32_16x16x32_bf16 v[24:27], a[44:47], v[72:75], v[24:27]
    ds_read_b128 v[64:67], v5 offset:24576
    v_mfma_f32_16x16x32_bf16 v[28:31], a[44:47], v[76:79], v[28:31]
    ds_read_b128 v[68:71], v5 offset:26624
    v_mfma_f32_16x16x32_bf16 v[32:35], a[52:55], v[72:75], v[32:35]
    s_min_u32 s63, s63, 63
    v_mfma_f32_16x16x32_bf16 v[36:39], a[52:55], v[76:79], v[36:39]
    s_mul_i32 s58, s63, 40960
    ds_read_b128 v[112:115], v10 offset:6144
    v_mfma_f32_16x16x32_bf16 v[40:43], a[60:63], v[72:75], v[40:43]
    s_lshl_b32 s59, s34, 10
    v_mfma_f32_16x16x32_bf16 v[44:47], a[60:63], v[76:79], v[44:47]
    s_add_u32 s59, s59, 114688
    ds_read_b128 v[116:119], v10 offset:7168
    s_waitcnt lgkmcnt(14)
    v_mfma_f32_16x16x32_bf16 v[24:27], a[64:67], v[80:83], v[24:27]
    s_lshl_b32 s95, s87, 12
    v_add_u32 v4, s95, v0
    v_xor_b32 v5, 64, v4
    ds_read_b128 v[72:75], v4 offset:28672
    v_mfma_f32_16x16x32_bf16 v[28:31], a[64:67], v[84:87], v[28:31]
    ds_read_b128 v[76:79], v4 offset:30720
    v_mfma_f32_16x16x32_bf16 v[32:35], a[72:75], v[80:83], v[32:35]
    v_mov_b32 v20, -1
    v_mfma_f32_16x16x32_bf16 v[36:39], a[72:75], v[84:87], v[36:39]
    v_mov_b32 v21, -1
    ds_read_b128 v[120:123], v10 offset:8192
    v_mfma_f32_16x16x32_bf16 v[40:43], a[80:83], v[80:83], v[40:43]
    v_mov_b32 v22, -1
    v_mfma_f32_16x16x32_bf16 v[44:47], a[80:83], v[84:87], v[44:47]
    v_mov_b32 v23, -1
    ds_read_b128 v[124:127], v10 offset:9216
    s_waitcnt lgkmcnt(14)
    v_mfma_f32_16x16x32_bf16 v[24:27], a[68:71], v[48:51], v[24:27]
    ds_read_b128 v[80:83], v5 offset:28672
    v_mfma_f32_16x16x32_bf16 v[28:31], a[68:71], v[52:55], v[28:31]
    ds_read_b128 v[84:87], v5 offset:30720
    v_mfma_f32_16x16x32_bf16 v[32:35], a[76:79], v[48:51], v[32:35]
    v_mfma_f32_16x16x32_bf16 v[36:39], a[76:79], v[52:55], v[36:39]
    ds_read_b128 v[128:131], v10 offset:10240
    v_mfma_f32_16x16x32_bf16 v[40:43], a[84:87], v[48:51], v[40:43]
    v_mfma_f32_16x16x32_bf16 v[44:47], a[84:87], v[52:55], v[44:47]
    ds_read_b128 v[132:135], v10 offset:11264
    s_waitcnt lgkmcnt(14)
    v_mfma_f32_16x16x32_bf16 v[24:27], a[88:91], v[56:59], v[24:27]
    ds_read_b128 v[48:51], v4 offset:32768
    v_mfma_f32_16x16x32_bf16 v[28:31], a[88:91], v[60:63], v[28:31]
    ds_read_b128 v[52:55], v4 offset:34816
    v_mfma_f32_16x16x32_bf16 v[32:35], a[96:99], v[56:59], v[32:35]
    v_mfma_f32_16x16x32_bf16 v[36:39], a[96:99], v[60:63], v[36:39]
    ds_read_b128 v[136:139], v10 offset:12288
    v_mfma_f32_16x16x32_bf16 v[40:43], a[104:107], v[56:59], v[40:43]
    v_mfma_f32_16x16x32_bf16 v[44:47], a[104:107], v[60:63], v[44:47]
    ds_read_b128 v[140:143], v10 offset:13312
    s_waitcnt lgkmcnt(14)
    v_mfma_f32_16x16x32_bf16 v[24:27], a[92:95], v[64:67], v[24:27]
    ds_read_b128 v[56:59], v5 offset:32768
    v_mfma_f32_16x16x32_bf16 v[28:31], a[92:95], v[68:71], v[28:31]
    ds_read_b128 v[60:63], v5 offset:34816
    v_mfma_f32_16x16x32_bf16 v[32:35], a[100:103], v[64:67], v[32:35]
    v_mfma_f32_16x16x32_bf16 v[36:39], a[100:103], v[68:71], v[36:39]
    v_mfma_f32_16x16x32_bf16 v[40:43], a[108:111], v[64:67], v[40:43]
    v_mfma_f32_16x16x32_bf16 v[44:47], a[108:111], v[68:71], v[44:47]
    s_waitcnt lgkmcnt(12)
    v_mfma_f32_16x16x32_bf16 v[24:27], a[112:115], v[72:75], v[24:27]
    ds_read_b128 v[64:67], v4 offset:36864
    v_mfma_f32_16x16x32_bf16 v[28:31], a[112:115], v[76:79], v[28:31]
    ds_read_b128 v[68:71], v4 offset:38912
    v_mfma_f32_16x16x32_bf16 v[32:35], a[120:123], v[72:75], v[32:35]
    v_mfma_f32_16x16x32_bf16 v[36:39], a[120:123], v[76:79], v[36:39]
    v_mfma_f32_16x16x32_bf16 v[40:43], a[128:131], v[72:75], v[40:43]
    v_mfma_f32_16x16x32_bf16 v[44:47], a[128:131], v[76:79], v[44:47]
    s_waitcnt lgkmcnt(10)
    v_mfma_f32_16x16x32_bf16 v[24:27], a[116:119], v[80:83], v[24:27]
    ds_read_b128 v[72:75], v5 offset:36864
    v_mfma_f32_16x16x32_bf16 v[28:31], a[116:119], v[84:87], v[28:31]
    ds_read_b128 v[76:79], v5 offset:38912
    v_mfma_f32_16x16x32_bf16 v[32:35], a[124:127], v[80:83], v[32:35]
    v_mfma_f32_16x16x32_bf16 v[36:39], a[124:127], v[84:87], v[36:39]
    v_mfma_f32_16x16x32_bf16 v[40:43], a[132:135], v[80:83], v[40:43]
    v_mfma_f32_16x16x32_bf16 v[44:47], a[132:135], v[84:87], v[44:47]
    s_waitcnt lgkmcnt(8)
    v_mfma_f32_16x16x32_bf16 v[24:27], a[136:139], v[48:51], v[24:27]
    s_lshl_b32 s95, s84, 12
    v_add_u32 v4, s95, v0
    v_xor_b32 v5, 64, v4
    ds_read_b128 v[80:83], v4 offset:0
    v_mfma_f32_16x16x32_bf16 v[28:31], a[136:139], v[52:55], v[28:31]
    ds_read_b128 v[84:87], v4 offset:2048
    v_mfma_f32_16x16x32_bf16 v[32:35], a[144:147], v[48:51], v[32:35]
    v_mfma_f32_16x16x32_bf16 v[36:39], a[144:147], v[52:55], v[36:39]
    v_mfma_f32_16x16x32_bf16 v[40:43], a[152:155], v[48:51], v[40:43]
    v_mfma_f32_16x16x32_bf16 v[44:47], a[152:155], v[52:55], v[44:47]
    s_waitcnt lgkmcnt(6)
    v_mfma_f32_16x16x32_bf16 v[24:27], a[140:143], v[56:59], v[24:27]
    ds_read_b128 v[48:51], v5 offset:0
    v_mfma_f32_16x16x32_bf16 v[28:31], a[140:143], v[60:63], v[28:31]
    ds_read_b128 v[52:55], v5 offset:2048
    v_mfma_f32_16x16x32_bf16 v[32:35], a[148:151], v[56:59], v[32:35]
    v_mfma_f32_16x16x32_bf16 v[36:39], a[148:151], v[60:63], v[36:39]
    v_mfma_f32_16x16x32_bf16 v[40:43], a[156:159], v[56:59], v[40:43]
    v_mfma_f32_16x16x32_bf16 v[44:47], a[156:159], v[60:63], v[44:47]
    s_waitcnt lgkmcnt(6)
    v_mfma_f32_16x16x32_bf16 v[24:27], a[160:163], v[64:67], v[24:27]
    ds_read_b128 v[56:59], v4 offset:4096
    v_mfma_f32_16x16x32_bf16 v[28:31], a[160:163], v[68:71], v[28:31]
    ds_read_b128 v[60:63], v4 offset:6144
    v_mfma_f32_16x16x32_bf16 v[32:35], a[168:171], v[64:67], v[32:35]
    v_mfma_f32_16x16x32_bf16 v[36:39], a[168:171], v[68:71], v[36:39]
    v_mfma_f32_16x16x32_bf16 v[40:43], a[176:179], v[64:67], v[40:43]
    v_mfma_f32_16x16x32_bf16 v[44:47], a[176:179], v[68:71], v[44:47]
    s_waitcnt lgkmcnt(6)
    v_mfma_f32_16x16x32_bf16 v[24:27], a[164:167], v[72:75], v[24:27]
    ds_read_b128 v[64:67], v5 offset:4096
    v_mfma_f32_16x16x32_bf16 v[28:31], a[164:167], v[76:79], v[28:31]
    ds_read_b128 v[68:71], v5 offset:6144
    v_mfma_f32_16x16x32_bf16 v[32:35], a[172:175], v[72:75], v[32:35]
    v_mfma_f32_16x16x32_bf16 v[36:39], a[172:175], v[76:79], v[36:39]
    v_mfma_f32_16x16x32_bf16 v[40:43], a[180:183], v[72:75], v[40:43]
    v_mfma_f32_16x16x32_bf16 v[44:47], a[180:183], v[76:79], v[44:47]
    s_waitcnt lgkmcnt(6)
    v_mfma_f32_16x16x32_bf16 v[24:27], v[88:91], v[80:83], v[24:27]
    s_lshl_b32 s95, s85, 12
    v_add_u32 v4, s95, v0
    v_xor_b32 v5, 64, v4
    ds_read_b128 v[72:75], v4 offset:8192
    v_mfma_f32_16x16x32_bf16 v[28:31], v[88:91], v[84:87], v[28:31]
    ds_read_b128 v[76:79], v4 offset:10240
    v_mfma_f32_16x16x32_bf16 v[32:35], v[96:99], v[80:83], v[32:35]
    v_mfma_f32_16x16x32_bf16 v[36:39], v[96:99], v[84:87], v[36:39]
    v_mfma_f32_16x16x32_bf16 v[40:43], v[104:107], v[80:83], v[40:43]
    v_mfma_f32_16x16x32_bf16 v[44:47], v[104:107], v[84:87], v[44:47]
    s_waitcnt lgkmcnt(6)
    v_mfma_f32_16x16x32_bf16 v[24:27], v[92:95], v[48:51], v[24:27]
    ds_read_b128 v[80:83], v5 offset:8192
    v_mfma_f32_16x16x32_bf16 v[28:31], v[92:95], v[52:55], v[28:31]
    ds_read_b128 v[84:87], v5 offset:10240
    v_mfma_f32_16x16x32_bf16 v[32:35], v[100:103], v[48:51], v[32:35]
    v_mfma_f32_16x16x32_bf16 v[36:39], v[100:103], v[52:55], v[36:39]
    v_mfma_f32_16x16x32_bf16 v[40:43], v[108:111], v[48:51], v[40:43]
    v_mfma_f32_16x16x32_bf16 v[44:47], v[108:111], v[52:55], v[44:47]
    s_waitcnt lgkmcnt(6)
    v_mfma_f32_16x16x32_bf16 v[24:27], v[112:115], v[56:59], v[24:27]
    v_mfma_f32_16x16x32_bf16 v[28:31], v[112:115], v[60:63], v[28:31]
    v_mfma_f32_16x16x32_bf16 v[32:35], v[120:123], v[56:59], v[32:35]
    v_mfma_f32_16x16x32_bf16 v[36:39], v[120:123], v[60:63], v[36:39]
    v_mfma_f32_16x16x32_bf16 v[40:43], v[128:131], v[56:59], v[40:43]
    v_mfma_f32_16x16x32_bf16 v[44:47], v[128:131], v[60:63], v[44:47]
    s_waitcnt lgkmcnt(4)
    v_mfma_f32_16x16x32_bf16 v[24:27], v[116:119], v[64:67], v[24:27]
    v_mfma_f32_16x16x32_bf16 v[28:31], v[116:119], v[68:71], v[28:31]
    v_mfma_f32_16x16x32_bf16 v[32:35], v[124:127], v[64:67], v[32:35]
    v_mfma_f32_16x16x32_bf16 v[36:39], v[124:127], v[68:71], v[36:39]
    v_mfma_f32_16x16x32_bf16 v[40:43], v[132:135], v[64:67], v[40:43]
    v_mfma_f32_16x16x32_bf16 v[44:47], v[132:135], v[68:71], v[44:47]
    s_add_u32 s44, s53, 0
    buffer_store_dwordx4 v[20:23], v8, s[8:11], s44 offen sc1
    s_mov_b32 exec_hi, -1
    s_waitcnt lgkmcnt(2)
    v_mfma_f32_16x16x32_bf16 v[24:27], v[136:139], v[72:75], v[24:27]
    v_mfma_f32_16x16x32_bf16 v[28:31], v[136:139], v[76:79], v[28:31]
    v_mfma_f32_16x16x32_bf16 v[32:35], a[0:3], v[72:75], v[32:35]
    v_mfma_f32_16x16x32_bf16 v[36:39], a[0:3], v[76:79], v[36:39]
    v_mfma_f32_16x16x32_bf16 v[40:43], a[8:11], v[72:75], v[40:43]
    v_mfma_f32_16x16x32_bf16 v[44:47], a[8:11], v[76:79], v[44:47]
    s_add_u32 s44, s53, 65536
    buffer_store_dwordx4 v[20:23], v8, s[8:11], s44 offen sc1
    s_mov_b32 exec_hi, -1
    s_waitcnt lgkmcnt(0)
    v_mfma_f32_16x16x32_bf16 v[24:27], v[140:143], v[80:83], v[24:27]
    v_mfma_f32_16x16x32_bf16 v[28:31], v[140:143], v[84:87], v[28:31]
    v_mfma_f32_16x16x32_bf16 v[32:35], a[4:7], v[80:83], v[32:35]
    v_mfma_f32_16x16x32_bf16 v[36:39], a[4:7], v[84:87], v[36:39]
    v_mfma_f32_16x16x32_bf16 v[40:43], a[12:15], v[80:83], v[40:43]
    v_mfma_f32_16x16x32_bf16 v[44:47], a[12:15], v[84:87], v[44:47]
    s_mov_b32 exec_hi, 0
    s_add_u32 s44, s53, 131072
    buffer_store_dwordx4 v[20:23], v8, s[8:11], s44 offen sc1
    s_mov_b32 exec_hi, -1
    v_cvt_pk_bf16_f32 v72, v24, v25
    v_cvt_pk_bf16_f32 v73, v26, v27
    v_cvt_pk_bf16_f32 v74, v28, v29
    v_cvt_pk_bf16_f32 v75, v30, v31
    v_cvt_pk_bf16_f32 v76, v32, v33
    v_cvt_pk_bf16_f32 v77, v34, v35
    v_cvt_pk_bf16_f32 v78, v36, v37
    v_cvt_pk_bf16_f32 v79, v38, v39
    v_cvt_pk_bf16_f32 v80, v40, v41
    v_cvt_pk_bf16_f32 v81, v42, v43
    v_cvt_pk_bf16_f32 v82, v44, v45
    v_cvt_pk_bf16_f32 v83, v46, v47
    s_barrier
    ds_write_b64 v17, v[72:73] offset:0
    ds_write_b64 v17, v[74:75] offset:6144
    ds_write_b64 v18, v[76:77] offset:0
    ds_write_b64 v18, v[78:79] offset:6144
    ds_write_b64 v19, v[80:81] offset:0
    ds_write_b64 v19, v[82:83] offset:6144
    s_waitcnt lgkmcnt(0)
    s_barrier
    ds_read_b128 v[24:27], v13 offset:0
    ds_read_b128 v[48:51], v13 offset:6144
    ds_read_b128 v[28:31], v13 offset:1024
    ds_read_b128 v[52:55], v13 offset:7168
    ds_read_b128 v[32:35], v13 offset:2048
    ds_read_b128 v[56:59], v13 offset:8192
    ds_read_b128 v[36:39], v13 offset:3072
    ds_read_b128 v[60:63], v13 offset:9216
    ds_read_b128 v[40:43], v13 offset:4096
    ds_read_b128 v[64:67], v13 offset:10240
    ds_read_b128 v[44:47], v13 offset:5120
    ds_read_b128 v[68:71], v13 offset:11264
    s_waitcnt lgkmcnt(10)
    v_mfma_f32_16x16x32_bf16 v[72:75], v[24:27], a[184:187], 0
    s_add_u32 s49, s50, 0
    v_mfma_f32_16x16x32_bf16 v[76:79], v[48:51], a[184:187], 0
    s_lshr_b32 s94, s49, 19
    s_waitcnt lgkmcnt(8)
    v_mfma_f32_16x16x32_bf16 v[72:75], v[28:31], a[188:191], v[72:75]
    s_and_b32 s94, s94, 28
    v_mfma_f32_16x16x32_bf16 v[76:79], v[52:55], a[188:191], v[76:79]
    s_lshr_b32 s94, s39, s94
    s_waitcnt lgkmcnt(6)
    v_mfma_f32_16x16x32_bf16 v[72:75], v[32:35], a[192:195], v[72:75]
    s_and_b32 s94, s94, 1
    v_mfma_f32_16x16x32_bf16 v[76:79], v[56:59], a[192:195], v[76:79]
    s_lshl_b32 s94, s94, 13
    s_waitcnt lgkmcnt(4)
    v_mfma_f32_16x16x32_bf16 v[72:75], v[36:39], a[196:199], v[72:75]
    s_add_u32 s49, s49, s94
    v_mfma_f32_16x16x32_bf16 v[76:79], v[60:63], a[196:199], v[76:79]
    s_waitcnt lgkmcnt(2)
    v_mfma_f32_16x16x32_bf16 v[72:75], v[40:43], a[200:203], v[72:75]
    v_mfma_f32_16x16x32_bf16 v[76:79], v[64:67], a[200:203], v[76:79]
    s_waitcnt lgkmcnt(0)
    v_mfma_f32_16x16x32_bf16 v[72:75], v[44:47], a[204:207], v[72:75]
    v_mfma_f32_16x16x32_bf16 v[76:79], v[68:71], a[204:207], v[76:79]
    s_mov_b32 s51, s49
    s_barrier
    v_mfma_f32_16x16x32_bf16 v[80:83], v[24:27], a[208:211], 0
    s_add_u32 s49, s50, 65536
    s_add_u32 m0, s59, 0
    s_add_u32 s45, s58, 0
    buffer_load_dwordx4 v11, s[24:27], s45 offen lds
    v_mfma_f32_16x16x32_bf16 v[84:87], v[48:51], a[208:211], 0
    s_lshr_b32 s94, s49, 19
    ds_read_b128 v[88:91], v10 offset:14336
    ds_read_b128 v[92:95], v10 offset:15360
    v_mfma_f32_16x16x32_bf16 v[80:83], v[28:31], a[212:215], v[80:83]
    s_and_b32 s94, s94, 28
    v_mfma_f32_16x16x32_bf16 v[84:87], v[52:55], a[212:215], v[84:87]
    s_lshr_b32 s94, s39, s94
    ds_read_b128 v[96:99], v10 offset:16384
    ds_read_b128 v[100:103], v10 offset:17408
    v_mfma_f32_16x16x32_bf16 v[80:83], v[32:35], a[216:219], v[80:83]
    s_and_b32 s94, s94, 1
    s_add_u32 m0, s59, 4096
    s_add_u32 s45, s58, 128
    buffer_load_dwordx4 v11, s[24:27], s45 offen lds
    v_mfma_f32_16x16x32_bf16 v[84:87], v[56:59], a[216:219], v[84:87]
    s_lshl_b32 s94, s94, 13
    ds_read_b128 v[104:107], v10 offset:18432
    ds_read_b128 v[108:111], v10 offset:19456
    v_mfma_f32_16x16x32_bf16 v[80:83], v[36:39], a[220:223], v[80:83]
    s_add_u32 s49, s49, s94
    v_mfma_f32_16x16x32_bf16 v[84:87], v[60:63], a[220:223], v[84:87]
    ds_read_b128 v[112:115], v10 offset:20480
    ds_read_b128 v[116:119], v10 offset:21504
    v_mfma_f32_16x16x32_bf16 v[80:83], v[40:43], a[224:227], v[80:83]
    v_cvt_pk_bf16_f32 v20, v72, v73
    v_cvt_pk_bf16_f32 v21, v76, v77
    v_mfma_f32_16x16x32_bf16 v[84:87], v[64:67], a[224:227], v[84:87]
    v_cvt_pk_bf16_f32 v22, v74, v75
    v_cvt_pk_bf16_f32 v23, v78, v79
    ds_read_b128 v[120:123], v10 offset:22528
    ds_read_b128 v[124:127], v10 offset:23552
    v_mfma_f32_16x16x32_bf16 v[80:83], v[44:47], a[228:231], v[80:83]
    buffer_store_dwordx4 v[20:23], v12, s[8:11], s51 offen sc1
    v_mfma_f32_16x16x32_bf16 v[84:87], v[68:71], a[228:231], v[84:87]
    ds_read_b128 v[128:131], v10 offset:24576
    ds_read_b128 v[132:135], v10 offset:25600
    s_mov_b32 s51, s49
    v_mfma_f32_16x16x32_bf16 v[72:75], v[24:27], a[232:235], 0
    s_add_u32 s49, s50, 131072
    s_add_u32 m0, s59, 8192
    s_add_u32 s45, s58, 256
    buffer_load_dwordx4 v11, s[24:27], s45 offen lds
    v_mfma_f32_16x16x32_bf16 v[76:79], v[48:51], a[232:235], 0
    s_lshr_b32 s94, s49, 19
    ds_read_b128 v[136:139], v10 offset:26624
    ds_read_b128 v[140:143], v10 offset:27648
    v_mfma_f32_16x16x32_bf16 v[72:75], v[28:31], a[236:239], v[72:75]
    s_and_b32 s94, s94, 28
    v_mfma_f32_16x16x32_bf16 v[76:79], v[52:55], a[236:239], v[76:79]
    s_lshr_b32 s94, s39, s94
    v_mfma_f32_16x16x32_bf16 v[72:75], v[32:35], a[240:243], v[72:75]
    s_and_b32 s94, s94, 1
    s_add_u32 m0, s59, 12288
    s_add_u32 s45, s58, 384
    buffer_load_dwordx4 v11, s[24:27], s45 offen lds
    v_mfma_f32_16x16x32_bf16 v[76:79], v[56:59], a[240:243], v[76:79]
    s_lshl_b32 s94, s94, 13
    v_mfma_f32_16x16x32_bf16 v[72:75], v[36:39], a[244:247], v[72:75]
    s_add_u32 s49, s49, s94
    v_mfma_f32_16x16x32_bf16 v[76:79], v[60:63], a[244:247], v[76:79]
    v_mfma_f32_16x16x32_bf16 v[72:75], v[40:43], a[248:251], v[72:75]
    v_cvt_pk_bf16_f32 v4, v80, v81
    v_cvt_pk_bf16_f32 v5, v84, v85
    v_mfma_f32_16x16x32_bf16 v[76:79], v[64:67], a[248:251], v[76:79]
    v_cvt_pk_bf16_f32 v6, v82, v83
    v_cvt_pk_bf16_f32 v7, v86, v87
    v_mfma_f32_16x16x32_bf16 v[72:75], v[44:47], a[252:255], v[72:75]
    buffer_store_dwordx4 v[4:7], v12, s[8:11], s51 offen sc1
    v_mfma_f32_16x16x32_bf16 v[76:79], v[68:71], a[252:255], v[76:79]
    s_mov_b32 s51, s49
    s_waitcnt lgkmcnt(12)
    v_mfma_f32_16x16x32_bf16 v[80:83], v[24:27], v[88:91], 0
    s_add_u32 s49, s50, 196608
    s_add_u32 m0, s59, 16384
    s_add_u32 s45, s58, 512
    buffer_load_dwordx4 v11, s[24:27], s45 offen lds
    v_mfma_f32_16x16x32_bf16 v[84:87], v[48:51], v[88:91], 0
    s_lshr_b32 s94, s49, 19
    v_mfma_f32_16x16x32_bf16 v[80:83], v[28:31], v[92:95], v[80:83]
    s_and_b32 s94, s94, 28
    v_mfma_f32_16x16x32_bf16 v[84:87], v[52:55], v[92:95], v[84:87]
    s_lshr_b32 s94, s39, s94
    s_waitcnt lgkmcnt(10)
    v_mfma_f32_16x16x32_bf16 v[80:83], v[32:35], v[96:99], v[80:83]
    s_and_b32 s94, s94, 1
    s_add_u32 m0, s59, 20480
    s_add_u32 s45, s58, 640
    buffer_load_dwordx4 v11, s[24:27], s45 offen lds
    v_mfma_f32_16x16x32_bf16 v[84:87], v[56:59], v[96:99], v[84:87]
    s_lshl_b32 s94, s94, 13
    v_mfma_f32_16x16x32_bf16 v[80:83], v[36:39], v[100:103], v[80:83]
    s_add_u32 s49, s49, s94
    v_mfma_f32_16x16x32_bf16 v[84:87], v[60:63], v[100:103], v[84:87]
    s_waitcnt lgkmcnt(8)
    v_mfma_f32_16x16x32_bf16 v[80:83], v[40:43], v[104:107], v[80:83]
    v_cvt_pk_bf16_f32 v20, v72, v73
    v_cvt_pk_bf16_f32 v21, v76, v77
    v_mfma_f32_16x16x32_bf16 v[84:87], v[64:67], v[104:107], v[84:87]
    v_cvt_pk_bf16_f32 v22, v74, v75
    v_cvt_pk_bf16_f32 v23, v78, v79
    v_mfma_f32_16x16x32_bf16 v[80:83], v[44:47], v[108:111], v[80:83]
    buffer_store_dwordx4 v[20:23], v12, s[8:11], s51 offen sc1
    v_mfma_f32_16x16x32_bf16 v[84:87], v[68:71], v[108:111], v[84:87]
    s_mov_b32 s51, s49
    s_waitcnt lgkmcnt(6)
    v_mfma_f32_16x16x32_bf16 v[72:75], v[24:27], v[112:115], 0
    s_add_u32 s49, s50, 262144
    s_add_u32 m0, s59, 24576
    s_add_u32 s45, s58, 768
    buffer_load_dwordx4 v11, s[24:27], s45 offen lds
    v_mfma_f32_16x16x32_bf16 v[76:79], v[48:51], v[112:115], 0
    s_lshr_b32 s94, s49, 19
    v_mfma_f32_16x16x32_bf16 v[72:75], v[28:31], v[116:119], v[72:75]
    s_and_b32 s94, s94, 28
    v_mfma_f32_16x16x32_bf16 v[76:79], v[52:55], v[116:119], v[76:79]
    s_lshr_b32 s94, s39, s94
    s_waitcnt lgkmcnt(4)
    v_mfma_f32_16x16x32_bf16 v[72:75], v[32:35], v[120:123], v[72:75]
    s_and_b32 s94, s94, 1
    s_add_u32 m0, s59, 28672
    s_add_u32 s45, s58, 896
    buffer_load_dwordx4 v11, s[24:27], s45 offen lds
    v_mfma_f32_16x16x32_bf16 v[76:79], v[56:59], v[120:123], v[76:79]
    s_lshl_b32 s94, s94, 13
    v_mfma_f32_16x16x32_bf16 v[72:75], v[36:39], v[124:127], v[72:75]
    s_add_u32 s49, s49, s94
    v_mfma_f32_16x16x32_bf16 v[76:79], v[60:63], v[124:127], v[76:79]
    s_waitcnt lgkmcnt(2)
    v_mfma_f32_16x16x32_bf16 v[72:75], v[40:43], v[128:131], v[72:75]
    v_cvt_pk_bf16_f32 v4, v80, v81
    v_cvt_pk_bf16_f32 v5, v84, v85
    v_mfma_f32_16x16x32_bf16 v[76:79], v[64:67], v[128:131], v[76:79]
    v_cvt_pk_bf16_f32 v6, v82, v83
    v_cvt_pk_bf16_f32 v7, v86, v87
    v_mfma_f32_16x16x32_bf16 v[72:75], v[44:47], v[132:135], v[72:75]
    buffer_store_dwordx4 v[4:7], v12, s[8:11], s51 offen sc1
    v_mfma_f32_16x16x32_bf16 v[76:79], v[68:71], v[132:135], v[76:79]
    s_mov_b32 s51, s49
    s_waitcnt lgkmcnt(0)
    v_mfma_f32_16x16x32_bf16 v[80:83], v[24:27], v[136:139], 0
    s_add_u32 s49, s50, 327680
    buffer_load_dword v2, v11, s[24:27], s45 offen offset:128
    v_mfma_f32_16x16x32_bf16 v[84:87], v[48:51], v[136:139], 0
    s_lshr_b32 s94, s49, 19
    v_mfma_f32_16x16x32_bf16 v[80:83], v[28:31], v[140:143], v[80:83]
    s_and_b32 s94, s94, 28
    v_mfma_f32_16x16x32_bf16 v[84:87], v[52:55], v[140:143], v[84:87]
    s_lshr_b32 s94, s39, s94
    v_mfma_f32_16x16x32_bf16 v[80:83], v[32:35], v[144:147], v[80:83]
    s_and_b32 s94, s94, 1
    buffer_load_dword v2, v11, s[24:27], s45 offen offset:256
    v_mfma_f32_16x16x32_bf16 v[84:87], v[56:59], v[144:147], v[84:87]
    s_lshl_b32 s94, s94, 13
    v_mfma_f32_16x16x32_bf16 v[80:83], v[36:39], v[148:151], v[80:83]
    s_add_u32 s49, s49, s94
    v_mfma_f32_16x16x32_bf16 v[84:87], v[60:63], v[148:151], v[84:87]
    v_mfma_f32_16x16x32_bf16 v[80:83], v[40:43], v[152:155], v[80:83]
    v_cvt_pk_bf16_f32 v20, v72, v73
    v_cvt_pk_bf16_f32 v21, v76, v77
    v_mfma_f32_16x16x32_bf16 v[84:87], v[64:67], v[152:155], v[84:87]
    v_cvt_pk_bf16_f32 v22, v74, v75
    v_cvt_pk_bf16_f32 v23, v78, v79
    v_mfma_f32_16x16x32_bf16 v[80:83], v[44:47], v[156:159], v[80:83]
    buffer_store_dwordx4 v[20:23], v12, s[8:11], s51 offen sc1
    v_mfma_f32_16x16x32_bf16 v[84:87], v[68:71], v[156:159], v[84:87]
    s_mov_b32 s51, s49
    v_mfma_f32_16x16x32_bf16 v[72:75], v[24:27], v[160:163], 0
    s_add_u32 s49, s50, 393216
    s_lshr_b32 s43, s35, 1
    v_mfma_f32_16x16x32_bf16 v[76:79], v[48:51], v[160:163], 0
    s_lshr_b32 s94, s49, 19
    s_add_u32 s43, s43, 0
    ds_read_b128 v[88:91], v10 offset:0
    v_mfma_f32_16x16x32_bf16 v[72:75], v[28:31], v[164:167], v[72:75]
    s_and_b32 s94, s94, 28
    s_bfe_u32 s52, s43, 0x10001
    v_mfma_f32_16x16x32_bf16 v[76:79], v[52:55], v[164:167], v[76:79]
    s_lshr_b32 s94, s39, s94
    s_lshl_b32 s52, s52, 21
    ds_read_b128 v[92:95], v10 offset:1024
    v_mfma_f32_16x16x32_bf16 v[72:75], v[32:35], v[168:171], v[72:75]
    s_and_b32 s94, s94, 1
    s_and_b32 s43, s43, 1
    v_mfma_f32_16x16x32_bf16 v[76:79], v[56:59], v[168:171], v[76:79]
    s_lshl_b32 s94, s94, 13
    s_mul_i32 s43, s43, 655360
    ds_read_b128 v[96:99], v10 offset:2048
    v_mfma_f32_16x16x32_bf16 v[72:75], v[36:39], v[172:175], v[72:75]
    s_add_u32 s49, s49, s94
    s_add_u32 s52, s52, s43
    v_mfma_f32_16x16x32_bf16 v[76:79], v[60:63], v[172:175], v[76:79]
    s_add_u32 s52, s52, s61
    ds_read_b128 v[100:103], v10 offset:3072
    v_mfma_f32_16x16x32_bf16 v[72:75], v[40:43], v[176:179], v[72:75]
    s_lshr_b32 s43, s52, 19
    v_cvt_pk_bf16_f32 v4, v80, v81
    v_cvt_pk_bf16_f32 v5, v84, v85
    v_mfma_f32_16x16x32_bf16 v[76:79], v[64:67], v[176:179], v[76:79]
    s_and_b32 s43, s43, 28
    v_cvt_pk_bf16_f32 v6, v82, v83
    v_cvt_pk_bf16_f32 v7, v86, v87
    ds_read_b128 v[104:107], v10 offset:4096
    v_mfma_f32_16x16x32_bf16 v[72:75], v[44:47], v[180:183], v[72:75]
    s_lshr_b32 s43, s39, s43
    buffer_store_dwordx4 v[4:7], v12, s[8:11], s51 offen sc1
    v_mfma_f32_16x16x32_bf16 v[76:79], v[68:71], v[180:183], v[76:79]
    s_and_b32 s43, s43, 1
    ds_read_b128 v[108:111], v10 offset:5120
    s_mov_b32 s51, s49
    v_mfma_f32_16x16x32_bf16 v[80:83], v[24:27], v[184:187], 0
    s_add_u32 s49, s50, 458752
    s_lshl_b32 s43, s43, 13
    v_mfma_f32_16x16x32_bf16 v[84:87], v[48:51], v[184:187], 0
    s_lshr_b32 s94, s49, 19
    s_add_u32 s52, s52, s43
    ds_read_b128 v[112:115], v10 offset:6144
    v_mfma_f32_16x16x32_bf16 v[80:83], v[28:31], v[188:191], v[80:83]
    s_and_b32 s94, s94, 28
    s_add_u32 s54, s52, 16384
    v_mfma_f32_16x16x32_bf16 v[84:87], v[52:55], v[188:191], v[84:87]
    s_lshr_b32 s94, s39, s94
    s_add_u32 s55, s52, 131072
    ds_read_b128 v[116:119], v10 offset:7168
    v_mfma_f32_16x16x32_bf16 v[80:83], v[32:35], v[192:195], v[80:83]
    s_and_b32 s94, s94, 1
    s_lshr_b32 s44, s35, 1
    v_mfma_f32_16x16x32_bf16 v[84:87], v[56:59], v[192:195], v[84:87]
    s_lshl_b32 s94, s94, 13
    s_and_b32 s44, s44, 3
    ds_read_b128 v[120:123], v10 offset:8192
    v_mfma_f32_16x16x32_bf16 v[80:83], v[36:39], v[196:199], v[80:83]
    s_add_u32 s49, s49, s94
    s_mul_i32 s44, s44, 10240
    v_mfma_f32_16x16x32_bf16 v[84:87], v[60:63], v[196:199], v[84:87]
    s_mul_i32 s47, s32, 40960
    ds_read_b128 v[124:127], v10 offset:9216
    v_mfma_f32_16x16x32_bf16 v[80:83], v[40:43], v[200:203], v[80:83]
    s_add_u32 s47, s47, s44
    v_cvt_pk_bf16_f32 v20, v72, v73
    v_cvt_pk_bf16_f32 v21, v76, v77
    v_mfma_f32_16x16x32_bf16 v[84:87], v[64:67], v[200:203], v[84:87]
    s_add_u32 s47, s47, 14680064
    v_cvt_pk_bf16_f32 v22, v74, v75
    v_cvt_pk_bf16_f32 v23, v78, v79
    ds_read_b128 v[128:131], v10 offset:10240
    v_mfma_f32_16x16x32_bf16 v[80:83], v[44:47], v[204:207], v[80:83]
    s_lshl_b32 s44, s85, 10
    buffer_store_dwordx4 v[20:23], v12, s[8:11], s51 offen sc1
    v_mfma_f32_16x16x32_bf16 v[84:87], v[68:71], v[204:207], v[84:87]
    s_add_u32 s48, s47, s44
    ds_read_b128 v[132:135], v10 offset:11264
    s_mov_b32 s51, s49
    v_mfma_f32_16x16x32_bf16 v[72:75], v[24:27], v[208:211], 0
    s_add_u32 s49, s50, 524288
    s_lshl_b32 s44, s84, 10
    v_mfma_f32_16x16x32_bf16 v[76:79], v[48:51], v[208:211], 0
    s_lshr_b32 s94, s49, 19
    s_add_u32 s47, s47, s44
    ds_read_b128 v[136:139], v10 offset:12288
    v_mfma_f32_16x16x32_bf16 v[72:75], v[28:31], v[212:215], v[72:75]
    s_and_b32 s94, s94, 28
    v_mfma_f32_16x16x32_bf16 v[76:79], v[52:55], v[212:215], v[76:79]
    s_lshr_b32 s94, s39, s94
    ds_read_b128 v[140:143], v10 offset:13312
    v_mfma_f32_16x16x32_bf16 v[72:75], v[32:35], v[216:219], v[72:75]
    s_and_b32 s94, s94, 1
    v_mfma_f32_16x16x32_bf16 v[76:79], v[56:59], v[216:219], v[76:79]
    s_lshl_b32 s94, s94, 13
    v_mfma_f32_16x16x32_bf16 v[72:75], v[36:39], v[220:223], v[72:75]
    s_add_u32 s49, s49, s94
    v_mfma_f32_16x16x32_bf16 v[76:79], v[60:63], v[220:223], v[76:79]
    v_mfma_f32_16x16x32_bf16 v[72:75], v[40:43], v[224:227], v[72:75]
    v_cvt_pk_bf16_f32 v4, v80, v81
    v_cvt_pk_bf16_f32 v5, v84, v85
    v_mfma_f32_16x16x32_bf16 v[76:79], v[64:67], v[224:227], v[76:79]
    v_cvt_pk_bf16_f32 v6, v82, v83
    v_cvt_pk_bf16_f32 v7, v86, v87
    v_mfma_f32_16x16x32_bf16 v[72:75], v[44:47], v[228:231], v[72:75]
    buffer_store_dwordx4 v[4:7], v12, s[8:11], s51 offen sc1
    v_mfma_f32_16x16x32_bf16 v[76:79], v[68:71], v[228:231], v[76:79]
    s_mov_b32 s51, s49
    v_mfma_f32_16x16x32_bf16 v[80:83], v[24:27], v[232:235], 0
    s_add_u32 s49, s50, 589824
    v_mfma_f32_16x16x32_bf16 v[84:87], v[48:51], v[232:235], 0
    s_lshr_b32 s94, s49, 19
    v_mfma_f32_16x16x32_bf16 v[80:83], v[28:31], v[236:239], v[80:83]
    s_and_b32 s94, s94, 28
    v_mfma_f32_16x16x32_bf16 v[84:87], v[52:55], v[236:239], v[84:87]
    s_lshr_b32 s94, s39, s94
    v_mfma_f32_16x16x32_bf16 v[80:83], v[32:35], v[240:243], v[80:83]
    s_and_b32 s94, s94, 1
    v_mfma_f32_16x16x32_bf16 v[84:87], v[56:59], v[240:243], v[84:87]
    s_lshl_b32 s94, s94, 13
    v_mfma_f32_16x16x32_bf16 v[80:83], v[36:39], v[244:247], v[80:83]
    s_add_u32 s49, s49, s94
    v_mfma_f32_16x16x32_bf16 v[84:87], v[60:63], v[244:247], v[84:87]
    v_mfma_f32_16x16x32_bf16 v[80:83], v[40:43], v[248:251], v[80:83]
    v_cvt_pk_bf16_f32 v20, v72, v73
    v_cvt_pk_bf16_f32 v21, v76, v77
    v_mfma_f32_16x16x32_bf16 v[84:87], v[64:67], v[248:251], v[84:87]
    v_cvt_pk_bf16_f32 v22, v74, v75
    v_cvt_pk_bf16_f32 v23, v78, v79
    v_mfma_f32_16x16x32_bf16 v[80:83], v[44:47], v[252:255], v[80:83]
    buffer_store_dwordx4 v[20:23], v12, s[8:11], s51 offen sc1
    v_mfma_f32_16x16x32_bf16 v[84:87], v[68:71], v[252:255], v[84:87]
    s_mov_b32 s51, s49
    s_nop 4
    v_cvt_pk_bf16_f32 v4, v80, v81
    s_nop 0
    v_cvt_pk_bf16_f32 v5, v84, v85
    v_cvt_pk_bf16_f32 v6, v82, v83
    v_cvt_pk_bf16_f32 v7, v86, v87
    buffer_store_dwordx4 v[4:7], v12, s[8:11], s51 offen sc1
    s_add_u32 s57, s57, 2
    s_sub_u32 s44, s57, s40
    s_cmp_gt_u32 s44, 4
    s_cbranch_scc1 L_V_crit
    s_add_u32 s49, s57, s40
    s_cmp_lg_u32 s49, 4
    s_cbranch_scc1 L_V_fl
    s_mul_i32 s44, s63, 40960
    s_lshl_b32 s46, s34, 10
    s_add_u32 s46, s46, 114688
    s_add_u32 m0, s46, 32768
    s_add_u32 s44, s44, 1024
    buffer_load_dwordx4 v11, s[24:27], s44 offen  lds
    s_add_u32 m0, s46, 36864
    s_add_u32 s44, s44, 128
    buffer_load_dwordx4 v11, s[24:27], s44 offen  lds
L_V_fl:
    s_waitcnt vmcnt(0)
    s_barrier
    s_sub_u32 s45, s57, 2
    s_cmp_lg_u32 s34, 0
    s_cbranch_scc1 SF_108
    s_add_u32 s44, s45, 1
    v_mov_b32 v6, s44
    v_mov_b32 v7, 0
    s_mov_b64 exec, 1
    buffer_store_dword v6, v7, s[8:11], s60 offen sc1
    s_mov_b64 exec, -1
SF_108:
    s_cmp_lg_u32 s49, 4
    s_cbranch_scc1 L_V_crit
    s_branch L_V_loop
L_V_last:
    ds_read_b128 v[88:91], v10 offset:0
    ds_read_b128 v[92:95], v10 offset:1024
    ds_read_b128 v[96:99], v10 offset:2048
    ds_read_b128 v[100:103], v10 offset:3072
    ds_read_b128 v[104:107], v10 offset:4096
    ds_read_b128 v[108:111], v10 offset:5120
    ds_read_b128 v[112:115], v10 offset:6144
    ds_read_b128 v[116:119], v10 offset:7168
    ds_read_b128 v[120:123], v10 offset:8192
    ds_read_b128 v[124:127], v10 offset:9216
    ds_read_b128 v[128:131], v10 offset:10240
    ds_read_b128 v[132:135], v10 offset:11264
    ds_read_b128 v[136:139], v10 offset:12288
    ds_read_b128 v[140:143], v10 offset:13312
    s_lshr_b32 s43, s35, 1
    s_add_u32 s43, s43, 0
    s_bfe_u32 s52, s43, 0x10001
    s_lshl_b32 s52, s52, 21
    s_and_b32 s43, s43, 1
    s_mul_i32 s43, s43, 655360
    s_add_u32 s52, s52, s43
    s_add_u32 s52, s52, s61
    s_lshr_b32 s43, s52, 19
    s_and_b32 s43, s43, 28
    s_lshr_b32 s43, s39, s43
    s_and_b32 s43, s43, 1
    s_lshl_b32 s43, s43, 13
    s_add_u32 s52, s52, s43
    s_add_u32 s54, s52, 16384
    s_add_u32 s55, s52, 131072
    s_lshr_b32 s44, s35, 1
    s_and_b32 s44, s44, 3
    s_mul_i32 s44, s44, 10240
    s_mul_i32 s47, s32, 40960
    s_add_u32 s47, s47, s44
    s_add_u32 s47, s47, 14680064
    s_lshl_b32 s44, s85, 10
    s_add_u32 s48, s47, s44
    s_lshl_b32 s44, s84, 10
    s_add_u32 s47, s47, s44
L_V_crit:
    v_mov_b32 v64, 0
    v_mov_b32 v65, 0
    v_mov_b32 v66, 0
    v_mov_b32 v67, 0
    v_mov_b32 v68, 0
    v_mov_b32 v69, 0
    v_mov_b32 v70, 0
    v_mov_b32 v71, 0
    v_mov_b32 v72, 0
    v_mov_b32 v73, 0
    v_mov_b32 v74, 0
    v_mov_b32 v75, 0
    v_mov_b32 v76, 0
    v_mov_b32 v77, 0
    v_mov_b32 v78, 0
    v_mov_b32 v79, 0
    v_mov_b32 v80, 0
    v_mov_b32 v81, 0
    v_mov_b32 v82, 0
    v_mov_b32 v83, 0
    v_mov_b32 v84, 0
    v_mov_b32 v85, 0
    v_mov_b32 v86, 0
    v_mov_b32 v87, 0
    s_mul_i32 s58, s63, 40960
    s_add_u32 s58, s58, 1024
    s_add_u32 s59, s58, 128
    s_lshl_b32 s56, s34, 10
    s_add_u32 s56, s56, 147456
    s_waitcnt lgkmcnt(0)
    s_mov_b32 s42, 0
    s_lshl_b32 s44, s84, 10
    s_add_u32 s44, s44, 147456
    v_add_u32 v4, s44, v12
    s_lshl_b32 s44, s85, 10
    s_add_u32 s44, s44, 147456
    v_add_u32 v5, s44, v12
    s_lshl_b32 s44, s86, 10
    s_add_u32 s44, s44, 147456
    v_add_u32 v6, s44, v12
    s_lshl_b32 s44, s87, 10
    s_add_u32 s44, s44, 147456
    v_add_u32 v7, s44, v12
PM_109:
    buffer_load_dwordx4 v[24:27], v12, s[8:11], s47 offen offset:0 sc1
    buffer_load_dwordx4 v[28:31], v12, s[8:11], s47 offen offset:1024 sc1
    buffer_load_dwordx4 v[32:35], v12, s[8:11], s48 offen offset:2048 sc1
PM_109_e:
    s_add_u32 s42, s42, 1
    s_cmp_gt_u32 s42, s37
    s_cselect_b32 s37, 0, s37
    s_cselect_b32 s98, -1, -2
    s_waitcnt vmcnt(2)
    v_max3_u32 v2, v24, v25, v26
    v_max_u32 v2, v2, v27
    s_waitcnt vmcnt(1)
    v_max3_u32 v2, v2, v28, v29
    v_max3_u32 v2, v2, v30, v31
    s_waitcnt vmcnt(0)
    v_max3_u32 v2, v2, v32, v33
    v_max3_u32 v2, v2, v34, v35
    v_cmp_lt_u32 vcc, s98, v2
    s_cbranch_vccnz PM_109
PMO_110:
    v_smfmac_f32_16x16x64_bf16 v[64:67], v[24:27], v[88:95], v9
    ds_write_b128 v4, v[24:27] offset:0
    v_smfmac_f32_16x16x64_bf16 v[68:71], v[24:27], v[96:103], v9
    ds_write_b128 v4, v[28:31] offset:1024
    v_smfmac_f32_16x16x64_bf16 v[72:75], v[24:27], v[104:111], v9
    ds_write_b128 v5, v[32:35] offset:2048
    v_smfmac_f32_16x16x64_bf16 v[64:67], v[28:31], v[112:119], v9
    v_smfmac_f32_16x16x64_bf16 v[68:71], v[28:31], v[120:127], v9
    v_smfmac_f32_16x16x64_bf16 v[72:75], v[28:31], v[128:135], v9
    v_smfmac_f32_16x16x64_bf16 v[64:67], v[32:35], v[136:143], v9
    s_waitcnt lgkmcnt(0)
    s_barrier
    ds_read_b128 v[36:39], v5 offset:3072
    ds_read_b128 v[40:43], v6 offset:4096
    v_smfmac_f32_16x16x64_bf16 v[68:71], v[32:35], a[0:7], v9
    ds_read_b128 v[44:47], v6 offset:5120
    v_smfmac_f32_16x16x64_bf16 v[72:75], v[32:35], a[8:15], v9
    ds_read_b128 v[48:51], v6 offset:6144
    s_waitcnt lgkmcnt(3)
    v_smfmac_f32_16x16x64_bf16 v[64:67], v[36:39], a[16:23], v9
    ds_read_b128 v[52:55], v7 offset:7168
    v_smfmac_f32_16x16x64_bf16 v[68:71], v[36:39], a[24:31], v9
    ds_read_b128 v[56:59], v7 offset:8192
    v_mov_b32 v24, 0
    v_smfmac_f32_16x16x64_bf16 v[72:75], v[36:39], a[32:39], v9
    ds_read_b128 v[60:63], v7 offset:9216
    v_mov_b32 v25, 0
    s_waitcnt lgkmcnt(5)
    v_smfmac_f32_16x16x64_bf16 v[64:67], v[40:43], a[40:47], v9
    ds_read_b128 v[88:91], v10 offset:14336
    v_mov_b32 v26, 0
    v_smfmac_f32_16x16x64_bf16 v[68:71], v[40:43], a[48:55], v9
    ds_read_b128 v[92:95], v10 offset:15360
    v_mov_b32 v27, 0
    v_smfmac_f32_16x16x64_bf16 v[72:75], v[40:43], a[56:63], v9
    ds_read_b128 v[96:99], v10 offset:16384
    v_mov_b32 v28, 0
    s_waitcnt lgkmcnt(7)
    v_smfmac_f32_16x16x64_bf16 v[64:67], v[44:47], a[64:71], v9
    ds_read_b128 v[100:103], v10 offset:17408
    v_mov_b32 v29, 0
    v_smfmac_f32_16x16x64_bf16 v[68:71], v[44:47], a[72:79], v9
    ds_read_b128 v[104:107], v10 offset:18432
    v_mov_b32 v30, 0
    v_smfmac_f32_16x16x64_bf16 v[72:75], v[44:47], a[80:87], v9
    ds_read_b128 v[108:111], v10 offset:19456
    v_mov_b32 v31, 0
    s_waitcnt lgkmcnt(9)
    v_smfmac_f32_16x16x64_bf16 v[64:67], v[48:51], a[88:95], v9
    ds_read_b128 v[112:115], v10 offset:20480
    v_mov_b32 v32, 0
    v_smfmac_f32_16x16x64_bf16 v[68:71], v[48:51], a[96:103], v9
    ds_read_b128 v[116:119], v10 offset:21504
    v_mov_b32 v33, 0
    v_smfmac_f32_16x16x64_bf16 v[72:75], v[48:51], a[104:111], v9
    ds_read_b128 v[120:123], v10 offset:22528
    v_mov_b32 v34, 0
    s_waitcnt lgkmcnt(11)
    v_smfmac_f32_16x16x64_bf16 v[64:67], v[52:55], a[112:119], v9
    ds_read_b128 v[124:127], v10 offset:23552
    v_mov_b32 v35, 0
    s_waitcnt lgkmcnt(11)
    v_smfmac_f32_16x16x64_bf16 v[64:67], v[56:59], a[136:143], v9
    ds_read_b128 v[128:131], v10 offset:24576
    v_mov_b32 v36, 0
    s_waitcnt lgkmcnt(11)
    v_smfmac_f32_16x16x64_bf16 v[64:67], v[60:63], a[160:167], v9
    ds_read_b128 v[132:135], v10 offset:25600
    v_mov_b32 v37, 0
    v_smfmac_f32_16x16x64_bf16 v[68:71], v[52:55], a[120:127], v9
    ds_read_b128 v[136:139], v10 offset:26624
    v_mov_b32 v38, 0
    v_smfmac_f32_16x16x64_bf16 v[68:71], v[56:59], a[144:151], v9
    ds_read_b128 v[140:143], v10 offset:27648
    v_mov_b32 v39, 0
    v_smfmac_f32_16x16x64_bf16 v[68:71], v[60:63], a[168:175], v9
    v_mov_b32 v40, 0
    v_smfmac_f32_16x16x64_bf16 v[72:75], v[52:55], a[128:135], v9
    v_add_f32 v64, v64, v65
    v_smfmac_f32_16x16x64_bf16 v[72:75], v[56:59], a[152:159], v9
    v_add_f32 v66, v66, v67
    v_smfmac_f32_16x16x64_bf16 v[72:75], v[60:63], a[176:183], v9
    v_cvt_pk_bf16_f32 v64, v64, v66
    s_nop 0
    v_add_f32 v68, v68, v69
    ds_write_b16 v14, v64
    ds_write_b16_d16_hi v14, v64 offset:32
    v_add_f32 v70, v70, v71
    v_cvt_pk_bf16_f32 v68, v68, v70
    v_mov_b32 v41, 0
    v_add_f32 v72, v72, v73
    ds_write_b16 v15, v68
    ds_write_b16_d16_hi v15, v68 offset:32
    v_add_f32 v74, v74, v75
    v_cvt_pk_bf16_f32 v72, v72, v74
    v_mov_b32 v42, 0
    v_mov_b32 v43, 0
    ds_write_b16 v16, v72
    ds_write_b16_d16_hi v16, v72 offset:32
    v_mov_b32 v44, 0
    v_mov_b32 v45, 0
    v_mov_b32 v46, 0
    v_mov_b32 v47, 0
    v_mov_b32 v48, 0
    v_mov_b32 v49, 0
    v_mov_b32 v50, 0
    v_mov_b32 v51, 0
    s_waitcnt lgkmcnt(0)
    s_barrier
    ds_read_b128 v[52:55], v13 offset:43008
    ds_read_b128 v[56:59], v13 offset:44032
    ds_read_b128 v[60:63], v13 offset:45056
    s_mov_b32 m0, s56
    s_nop 0
    buffer_load_dwordx4 v11, s[24:27], s58 offen lds
    s_add_u32 m0, s56, 4096
    s_nop 0
    buffer_load_dwordx4 v11, s[24:27], s59 offen lds
    s_waitcnt lgkmcnt(2)
    v_smfmac_f32_16x16x64_bf16 v[76:79], v[52:55], a[184:191], v9
    s_add_u32 s44, s35, 1
    v_mov_b32 v2, s44
    s_waitcnt lgkmcnt(1)
    v_smfmac_f32_16x16x64_bf16 v[76:79], v[56:59], a[192:199], v9
    v_lshlrev_b32 v6, 5, v12
    s_waitcnt lgkmcnt(0)
    v_smfmac_f32_16x16x64_bf16 v[76:79], v[60:63], a[200:207], v9
    v_smfmac_f32_16x16x64_bf16 v[80:83], v[52:55], a[232:239], v9
    v_smfmac_f32_16x16x64_bf16 v[80:83], v[56:59], a[240:247], v9
    v_smfmac_f32_16x16x64_bf16 v[80:83], v[60:63], a[248:255], v9
    s_nop 4
    v_add_f32 v76, v76, v77
    v_smfmac_f32_16x16x64_bf16 v[84:87], v[52:55], v[112:119], v9
    v_add_f32 v78, v78, v79
    v_smfmac_f32_16x16x64_bf16 v[84:87], v[56:59], v[120:127], v9
    v_cvt_pk_bf16_f32 v20, v76, v78
    v_smfmac_f32_16x16x64_bf16 v[84:87], v[60:63], v[128:135], v9
    s_mov_b64 exec, s[92:93]
    buffer_store_dword v2, v6, s[8:11], s62 offen sc1
    s_mov_b64 exec, -1
    v_add_f32 v80, v80, v81
    v_smfmac_f32_16x16x64_bf16 v[24:27], v[52:55], v[160:167], v9
    v_add_f32 v82, v82, v83
    v_smfmac_f32_16x16x64_bf16 v[24:27], v[56:59], v[168:175], v9
    v_cvt_pk_bf16_f32 v21, v80, v82
    v_smfmac_f32_16x16x64_bf16 v[24:27], v[60:63], v[176:183], v9
    v_add_f32 v84, v84, v85
    v_permlane16_swap_b32 v20, v21
    v_smfmac_f32_16x16x64_bf16 v[28:31], v[52:55], v[208:215], v9
    v_add_f32 v86, v86, v87
    v_smfmac_f32_16x16x64_bf16 v[28:31], v[56:59], v[216:223], v9
    v_cvt_pk_bf16_f32 v22, v84, v86
    v_smfmac_f32_16x16x64_bf16 v[28:31], v[60:63], v[224:231], v9
    s_nop 0
    v_add_f32 v24, v24, v25
    v_add_f32 v26, v26, v27
    v_smfmac_f32_16x16x64_bf16 v[32:35], v[52:55], v[232:239], v9
    v_cvt_pk_bf16_f32 v23, v24, v26
    s_nop 1
    v_permlane16_swap_b32 v22, v23
    v_smfmac_f32_16x16x64_bf16 v[32:35], v[56:59], v[240:247], v9
    s_nop 0
    v_permlane32_swap_b32 v20, v22
    v_smfmac_f32_16x16x64_bf16 v[32:35], v[60:63], v[248:255], v9
    v_permlane32_swap_b32 v21, v23
    buffer_store_dwordx4 v[20:23], v1, s[8:11], s52 offen sc1
    v_add_f32 v28, v28, v29
    v_smfmac_f32_16x16x64_bf16 v[36:39], v[52:55], a[208:215], v9
    v_add_f32 v30, v30, v31
    v_smfmac_f32_16x16x64_bf16 v[36:39], v[56:59], a[216:223], v9
    v_cvt_pk_bf16_f32 v68, v28, v30
    v_smfmac_f32_16x16x64_bf16 v[36:39], v[60:63], a[224:231], v9
    v_add_f32 v32, v32, v33
    v_add_f32 v34, v34, v35
    v_smfmac_f32_16x16x64_bf16 v[40:43], v[52:55], v[88:95], v9
    v_cvt_pk_bf16_f32 v69, v32, v34
    v_smfmac_f32_16x16x64_bf16 v[40:43], v[56:59], v[96:103], v9
    s_nop 0
    v_permlane16_swap_b32 v68, v69
    buffer_store_dwordx2 v[68:69], v3, s[8:11], s55 offen sc1
    v_smfmac_f32_16x16x64_bf16 v[40:43], v[60:63], v[104:111], v9
    v_add_f32 v36, v36, v37
    v_smfmac_f32_16x16x64_bf16 v[44:47], v[52:55], v[136:143], v9
    v_add_f32 v38, v38, v39
    v_smfmac_f32_16x16x64_bf16 v[44:47], v[56:59], v[144:151], v9
    v_cvt_pk_bf16_f32 v64, v36, v38
    v_smfmac_f32_16x16x64_bf16 v[44:47], v[60:63], v[152:159], v9
    s_nop 1
    v_add_f32 v40, v40, v41
    v_smfmac_f32_16x16x64_bf16 v[48:51], v[52:55], v[184:191], v9
    v_add_f32 v42, v42, v43
    v_smfmac_f32_16x16x64_bf16 v[48:51], v[56:59], v[192:199], v9
    v_cvt_pk_bf16_f32 v65, v40, v42
    v_smfmac_f32_16x16x64_bf16 v[48:51], v[60:63], v[200:207], v9
    v_add_f32 v44, v44, v45
    v_permlane16_swap_b32 v64, v65
    v_add_f32 v46, v46, v47
    v_cvt_pk_bf16_f32 v66, v44, v46
    s_nop 3
    v_add_f32 v48, v48, v49
    v_add_f32 v50, v50, v51
    v_cvt_pk_bf16_f32 v67, v48, v50
    s_nop 1
    v_permlane16_swap_b32 v66, v67
    s_nop 1
    v_permlane32_swap_b32 v64, v66
    v_permlane32_swap_b32 v65, v67
    buffer_store_dwordx4 v[64:67], v1, s[8:11], s54 offen sc1
    s_lshr_b32 s43, s35, 1
    s_add_u32 s43, s43, 3
    s_bfe_u32 s53, s43, 0x10001
    s_lshl_b32 s53, s53, 21
    s_and_b32 s43, s43, 1
    s_mul_i32 s43, s43, 655360
    s_add_u32 s53, s53, s43
    s_add_u32 s53, s53, s61
    s_lshr_b32 s43, s53, 19
    s_and_b32 s43, s43, 28
    s_lshr_b32 s43, s39, s43
    s_and_b32 s43, s43, 1
    s_lshl_b32 s43, s43, 13
    s_add_u32 s53, s53, s43
    s_sub_u32 s45, s57, 2
    s_waitcnt vmcnt(4)
    s_cmp_lg_u32 s34, 0
    s_cbranch_scc1 SF_111
    s_add_u32 s44, s45, 1
    v_mov_b32 v6, s44
    v_mov_b32 v7, 0
    s_mov_b64 exec, 1
    buffer_store_dword v6, v7, s[8:11], s60 offen sc1
    s_mov_b64 exec, -1
SF_111:
    s_add_u32 s35, s35, 2
    s_cmp_lt_u32 s35, 64
    s_cbranch_scc1 L_V_loop
    s_endpgm
L_B:
    s_sub_u32 s36, s33, 26
    s_lshl_b32 s44, s36, 3
    s_add_u32 s44, s44, s32
    s_lshl_b32 s60, s44, 7
    s_add_u32 s60, s60, 15032320
    s_mov_b32 s42, 0
    v_mov_b32 v3, 128
WST_112:
    buffer_load_dwordx2 v[4:5], v3, s[12:15], 0 offen sc1
    s_waitcnt vmcnt(0)
    v_readfirstlane_b32 s44, v4
    v_readfirstlane_b32 s39, v5
    s_cmp_lg_u32 s44, 0
    s_cbranch_scc1 WSO_113
    s_sleep 4
    s_add_u32 s42, s42, 1
    s_cmp_lt_u32 s42, s37
    s_cbranch_scc1 WST_112
    s_mov_b32 s37, 1
WSO_113:
    s_cmp_lg_u32 s100, 0
    s_cbranch_scc1 WSE_115
    s_cmp_eq_u32 s44, 2
    s_cbranch_scc1 L_fallback
WSE_115:
    s_mov_b32 s24, s82
    s_mov_b32 s25, s83
    s_mov_b32 s26, 2621440
    s_mov_b32 s27, 0x20000
    s_mov_b32 s16, s84
    s_mov_b32 s17, s85
    s_mov_b32 s18, 2457600
    s_mov_b32 s19, 0x20000
    s_mov_b32 s20, s86
    s_mov_b32 s21, s87
    s_mov_b32 s22, 25600
    s_mov_b32 s23, 0x20000
    s_mov_b32 s28, s90
    s_mov_b32 s29, s91
    s_mov_b32 s30, 5242880
    s_mov_b32 s31, 0x20000
    v_lshrrev_b32 v2, 3, v1
    v_and_b32 v3, 7, v1
    v_xor_b32 v3, v3, v2
    s_lshl_b32 s44, s34, 3
    v_add_u32 v2, s44, v2
    v_mul_u32_u24 v11, 1280, v2
    v_lshl_add_u32 v11, v3, 4, v11
    v_and_b32 v2, 15, v1
    v_lshrrev_b32 v3, 4, v1
    v_and_b32 v4, 7, v1
    v_xor_b32 v3, v3, v4
    v_lshlrev_b32 v3, 4, v3
    v_lshl_add_u32 v0, v2, 7, v3
    v_xor_b32 v10, 64, v0
    v_add_u32 v0, 0, v0
    v_add_u32 v10, 0, v10
    v_lshlrev_b32 v12, 4, v1
    v_and_b32 v14, 15, v1
    v_lshrrev_b32 v15, 4, v1
    s_mov_b32 s62, 0x3fb8aa3b
    s_cmp_eq_u32 s34, 3
    s_cbranch_scc1 L_B_w3
    s_mul_i32 s50, s34, 1280
    s_mul_i32 s44, s32, 160
    s_add_u32 s50, s50, s44
    s_mul_i32 s51, s34, 36864
    v_add_u32 v2, 0, v1
    v_mul_u32_u24 v3, 6554, v2
    v_lshrrev_b32 v3, 16, v3
    v_mul_u32_u24 v4, 10, v3
    v_sub_u32 v4, v2, v4
    v_mul_u32_u24 v3, 3840, v3
    v_lshl_add_u32 v16, v4, 4, v3
    v_add_u32 v2, 64, v1
    v_mul_u32_u24 v3, 6554, v2
    v_lshrrev_b32 v3, 16, v3
    v_mul_u32_u24 v4, 10, v3
    v_sub_u32 v4, v2, v4
    v_mul_u32_u24 v3, 3840, v3
    v_lshl_add_u32 v17, v4, 4, v3
    v_add_u32 v2, 128, v1
    v_mul_u32_u24 v3, 6554, v2
    v_lshrrev_b32 v3, 16, v3
    v_mul_u32_u24 v4, 10, v3
    v_sub_u32 v4, v2, v4
    v_mul_u32_u24 v3, 3840, v3
    v_lshl_add_u32 v18, v4, 4, v3
    v_add_u32 v2, 192, v1
    v_mul_u32_u24 v3, 6554, v2
    v_lshrrev_b32 v3, 16, v3
    v_mul_u32_u24 v4, 10, v3
    v_sub_u32 v4, v2, v4
    v_mul_u32_u24 v3, 3840, v3
    v_lshl_add_u32 v19, v4, 4, v3
    v_add_u32 v2, 256, v1
    v_mul_u32_u24 v3, 6554, v2
    v_lshrrev_b32 v3, 16, v3
    v_mul_u32_u24 v4, 10, v3
    v_sub_u32 v4, v2, v4
    v_mul_u32_u24 v3, 3840, v3
    v_lshl_add_u32 v20, v4, 4, v3
    v_lshrrev_b32 v2, 4, v1
    v_bfe_u32 v3, v1, 2, 2
    v_lshl_add_u32 v2, v2, 3, v3
    v_mul_u32_u24 v2, 160, v2
    v_and_b32 v3, 3, v1
    v_mul_u32_u24 v3, 40, v3
    v_add3_u32 v21, v2, v3, s51
    s_add_u32 m0, s51, 0
    s_add_u32 s44, s50, 0
    buffer_load_dwordx4 v16, s[16:19], s44 offen lds
    s_add_u32 m0, s51, 1024
    s_nop 0
    buffer_load_dwordx4 v17, s[16:19], s44 offen lds
    s_add_u32 m0, s51, 2048
    s_nop 0
    buffer_load_dwordx4 v18, s[16:19], s44 offen lds
    s_add_u32 m0, s51, 3072
    s_nop 0
    buffer_load_dwordx4 v19, s[16:19], s44 offen lds
    s_add_u32 m0, s51, 4096
    s_nop 0
    buffer_load_dwordx4 v20, s[16:19], s44 offen lds
    s_add_u32 m0, s51, 5120
    s_add_u32 s44, s50, 122880
    buffer_load_dwordx4 v16, s[16:19], s44 offen lds
    s_add_u32 m0, s51, 6144
    s_nop 0
    buffer_load_dwordx4 v17, s[16:19], s44 offen lds
    s_add_u32 m0, s51, 7168
    s_nop 0
    buffer_load_dwordx4 v18, s[16:19], s44 offen lds
    s_add_u32 m0, s51, 8192
    s_nop 0
    buffer_load_dwordx4 v19, s[16:19], s44 offen lds
    s_add_u32 m0, s51, 9216
    s_nop 0
    buffer_load_dwordx4 v20, s[16:19], s44 offen lds
    s_add_u32 m0, s51, 12288
    s_add_u32 s44, s50, 245760
    buffer_load_dwordx4 v16, s[16:19], s44 offen lds
    s_add_u32 m0, s51, 13312
    s_nop 0
    buffer_load_dwordx4 v17, s[16:19], s44 offen lds
    s_add_u32 m0, s51, 14336
    s_nop 0
    buffer_load_dwordx4 v18, s[16:19], s44 offen lds
    s_add_u32 m0, s51, 15360
    s_nop 0
    buffer_load_dwordx4 v19, s[16:19], s44 offen lds
    s_add_u32 m0, s51, 16384
    s_nop 0
    buffer_load_dwordx4 v20, s[16:19], s44 offen lds
    s_add_u32 m0, s51, 17408
    s_add_u32 s44, s50, 368640
    buffer_load_dwordx4 v16, s[16:19], s44 offen lds
    s_add_u32 m0, s51, 18432
    s_nop 0
    buffer_load_dwordx4 v17, s[16:19], s44 offen lds
    s_add_u32 m0, s51, 19456
    s_nop 0
    buffer_load_dwordx4 v18, s[16:19], s44 offen lds
    s_add_u32 m0, s51, 20480
    s_nop 0
    buffer_load_dwordx4 v19, s[16:19], s44 offen lds
    s_add_u32 m0, s51, 21504
    s_nop 0
    buffer_load_dwordx4 v20, s[16:19], s44 offen lds
    s_add_u32 m0, s51, 24576
    s_add_u32 s44, s50, 491520
    buffer_load_dwordx4 v16, s[16:19], s44 offen lds
    s_add_u32 m0, s51, 25600
    s_nop 0
    buffer_load_dwordx4 v17, s[16:19], s44 offen lds
    s_add_u32 m0, s51, 26624
    s_nop 0
    buffer_load_dwordx4 v18, s[16:19], s44 offen lds
    s_add_u32 m0, s51, 27648
    s_nop 0
    buffer_load_dwordx4 v19, s[16:19], s44 offen lds
    s_add_u32 m0, s51, 28672
    s_nop 0
    buffer_load_dwordx4 v20, s[16:19], s44 offen lds
    s_add_u32 m0, s51, 29696
    s_add_u32 s44, s50, 614400
    buffer_load_dwordx4 v16, s[16:19], s44 offen lds
    s_add_u32 m0, s51, 30720
    s_nop 0
    buffer_load_dwordx4 v17, s[16:19], s44 offen lds
    s_add_u32 m0, s51, 31744
    s_nop 0
    buffer_load_dwordx4 v18, s[16:19], s44 offen lds
    s_add_u32 m0, s51, 32768
    s_nop 0
    buffer_load_dwordx4 v19, s[16:19], s44 offen lds
    s_add_u32 m0, s51, 33792
    s_nop 0
    buffer_load_dwordx4 v20, s[16:19], s44 offen lds
    s_waitcnt vmcnt(20)
    ds_read_b64_tr_b16 a[0:1], v21 offset:0
    ds_read_b64_tr_b16 a[2:3], v21 offset:640
    ds_read_b64_tr_b16 a[4:5], v21 offset:8
    ds_read_b64_tr_b16 a[6:7], v21 offset:648
    ds_read_b64_tr_b16 a[8:9], v21 offset:16
    ds_read_b64_tr_b16 a[10:11], v21 offset:656
    ds_read_b64_tr_b16 a[12:13], v21 offset:24
    ds_read_b64_tr_b16 a[14:15], v21 offset:664
    ds_read_b64_tr_b16 a[16:17], v21 offset:32
    ds_read_b64_tr_b16 a[18:19], v21 offset:672
    ds_read_b64_tr_b16 a[20:21], v21 offset:5120
    ds_read_b64_tr_b16 a[22:23], v21 offset:5760
    ds_read_b64_tr_b16 a[24:25], v21 offset:5128
    ds_read_b64_tr_b16 a[26:27], v21 offset:5768
    ds_read_b64_tr_b16 a[28:29], v21 offset:5136
    ds_read_b64_tr_b16 a[30:31], v21 offset:5776
    ds_read_b64_tr_b16 a[32:33], v21 offset:5144
    ds_read_b64_tr_b16 a[34:35], v21 offset:5784
    ds_read_b64_tr_b16 a[36:37], v21 offset:5152
    ds_read_b64_tr_b16 a[38:39], v21 offset:5792
    s_waitcnt lgkmcnt(0)
    s_add_u32 m0, s51, 0
    s_add_u32 s44, s50, 737280
    buffer_load_dwordx4 v16, s[16:19], s44 offen lds
    s_add_u32 m0, s51, 1024
    s_nop 0
    buffer_load_dwordx4 v17, s[16:19], s44 offen lds
    s_add_u32 m0, s51, 2048
    s_nop 0
    buffer_load_dwordx4 v18, s[16:19], s44 offen lds
    s_add_u32 m0, s51, 3072
    s_nop 0
    buffer_load_dwordx4 v19, s[16:19], s44 offen lds
    s_add_u32 m0, s51, 4096
    s_nop 0
    buffer_load_dwordx4 v20, s[16:19], s44 offen lds
    s_add_u32 m0, s51, 5120
    s_add_u32 s44, s50, 860160
    buffer_load_dwordx4 v16, s[16:19], s44 offen lds
    s_add_u32 m0, s51, 6144
    s_nop 0
    buffer_load_dwordx4 v17, s[16:19], s44 offen lds
    s_add_u32 m0, s51, 7168
    s_nop 0
    buffer_load_dwordx4 v18, s[16:19], s44 offen lds
    s_add_u32 m0, s51, 8192
    s_nop 0
    buffer_load_dwordx4 v19, s[16:19], s44 offen lds
    s_add_u32 m0, s51, 9216
    s_nop 0
    buffer_load_dwordx4 v20, s[16:19], s44 offen lds
    s_waitcnt vmcnt(20)
    ds_read_b64_tr_b16 a[40:41], v21 offset:12288
    ds_read_b64_tr_b16 a[42:43], v21 offset:12928
    ds_read_b64_tr_b16 a[44:45], v21 offset:12296
    ds_read_b64_tr_b16 a[46:47], v21 offset:12936
    ds_read_b64_tr_b16 a[48:49], v21 offset:12304
    ds_read_b64_tr_b16 a[50:51], v21 offset:12944
    ds_read_b64_tr_b16 a[52:53], v21 offset:12312
    ds_read_b64_tr_b16 a[54:55], v21 offset:12952
    ds_read_b64_tr_b16 a[56:57], v21 offset:12320
    ds_read_b64_tr_b16 a[58:59], v21 offset:12960
    ds_read_b64_tr_b16 a[60:61], v21 offset:17408
    ds_read_b64_tr_b16 a[62:63], v21 offset:18048
    ds_read_b64_tr_b16 a[64:65], v21 offset:17416
    ds_read_b64_tr_b16 a[66:67], v21 offset:18056
    ds_read_b64_tr_b16 a[68:69], v21 offset:17424
    ds_read_b64_tr_b16 a[70:71], v21 offset:18064
    ds_read_b64_tr_b16 a[72:73], v21 offset:17432
    ds_read_b64_tr_b16 a[74:75], v21 offset:18072
    ds_read_b64_tr_b16 a[76:77], v21 offset:17440
    ds_read_b64_tr_b16 a[78:79], v21 offset:18080
    s_waitcnt lgkmcnt(0)
    s_add_u32 m0, s51, 12288
    s_add_u32 s44, s50, 983040
    buffer_load_dwordx4 v16, s[16:19], s44 offen lds
    s_add_u32 m0, s51, 13312
    s_nop 0
    buffer_load_dwordx4 v17, s[16:19], s44 offen lds
    s_add_u32 m0, s51, 14336
    s_nop 0
    buffer_load_dwordx4 v18, s[16:19], s44 offen lds
    s_add_u32 m0, s51, 15360
    s_nop 0
    buffer_load_dwordx4 v19, s[16:19], s44 offen lds
    s_add_u32 m0, s51, 16384
    s_nop 0
    buffer_load_dwordx4 v20, s[16:19], s44 offen lds
    s_add_u32 m0, s51, 17408
    s_add_u32 s44, s50, 1105920
    buffer_load_dwordx4 v16, s[16:19], s44 offen lds
    s_add_u32 m0, s51, 18432
    s_nop 0
    buffer_load_dwordx4 v17, s[16:19], s44 offen lds
    s_add_u32 m0, s51, 19456
    s_nop 0
    buffer_load_dwordx4 v18, s[16:19], s44 offen lds
    s_add_u32 m0, s51, 20480
    s_nop 0
    buffer_load_dwordx4 v19, s[16:19], s44 offen lds
    s_add_u32 m0, s51, 21504
    s_nop 0
    buffer_load_dwordx4 v20, s[16:19], s44 offen lds
    s_waitcnt vmcnt(20)
    ds_read_b64_tr_b16 a[80:81], v21 offset:24576
    ds_read_b64_tr_b16 a[82:83], v21 offset:25216
    ds_read_b64_tr_b16 a[84:85], v21 offset:24584
    ds_read_b64_tr_b16 a[86:87], v21 offset:25224
    ds_read_b64_tr_b16 a[88:89], v21 offset:24592
    ds_read_b64_tr_b16 a[90:91], v21 offset:25232
    ds_read_b64_tr_b16 a[92:93], v21 offset:24600
    ds_read_b64_tr_b16 a[94:95], v21 offset:25240
    ds_read_b64_tr_b16 a[96:97], v21 offset:24608
    ds_read_b64_tr_b16 a[98:99], v21 offset:25248
    ds_read_b64_tr_b16 a[100:101], v21 offset:29696
    ds_read_b64_tr_b16 a[102:103], v21 offset:30336
    ds_read_b64_tr_b16 a[104:105], v21 offset:29704
    ds_read_b64_tr_b16 a[106:107], v21 offset:30344
    ds_read_b64_tr_b16 a[108:109], v21 offset:29712
    ds_read_b64_tr_b16 a[110:111], v21 offset:30352
    ds_read_b64_tr_b16 a[112:113], v21 offset:29720
    ds_read_b64_tr_b16 a[114:115], v21 offset:30360
    ds_read_b64_tr_b16 a[116:117], v21 offset:29728
    ds_read_b64_tr_b16 a[118:119], v21 offset:30368
    s_waitcnt lgkmcnt(0)
    s_add_u32 m0, s51, 24576
    s_add_u32 s44, s50, 1228800
    buffer_load_dwordx4 v16, s[16:19], s44 offen lds
    s_add_u32 m0, s51, 25600
    s_nop 0
    buffer_load_dwordx4 v17, s[16:19], s44 offen lds
    s_add_u32 m0, s51, 26624
    s_nop 0
    buffer_load_dwordx4 v18, s[16:19], s44 offen lds
    s_add_u32 m0, s51, 27648
    s_nop 0
    buffer_load_dwordx4 v19, s[16:19], s44 offen lds
    s_add_u32 m0, s51, 28672
    s_nop 0
    buffer_load_dwordx4 v20, s[16:19], s44 offen lds
    s_add_u32 m0, s51, 29696
    s_add_u32 s44, s50, 1351680
    buffer_load_dwordx4 v16, s[16:19], s44 offen lds
    s_add_u32 m0, s51, 30720
    s_nop 0
    buffer_load_dwordx4 v17, s[16:19], s44 offen lds
    s_add_u32 m0, s51, 31744
    s_nop 0
    buffer_load_dwordx4 v18, s[16:19], s44 offen lds
    s_add_u32 m0, s51, 32768
    s_nop 0
    buffer_load_dwordx4 v19, s[16:19], s44 offen lds
    s_add_u32 m0, s51, 33792
    s_nop 0
    buffer_load_dwordx4 v20, s[16:19], s44 offen lds
    s_waitcnt vmcnt(20)
    ds_read_b64_tr_b16 a[120:121], v21 offset:0
    ds_read_b64_tr_b16 a[122:123], v21 offset:640
    ds_read_b64_tr_b16 a[124:125], v21 offset:8
    ds_read_b64_tr_b16 a[126:127], v21 offset:648
    ds_read_b64_tr_b16 a[128:129], v21 offset:16
    ds_read_b64_tr_b16 a[130:131], v21 offset:656
    ds_read_b64_tr_b16 a[132:133], v21 offset:24
    ds_read_b64_tr_b16 a[134:135], v21 offset:664
    ds_read_b64_tr_b16 a[136:137], v21 offset:32
    ds_read_b64_tr_b16 a[138:139], v21 offset:672
    ds_read_b64_tr_b16 a[140:141], v21 offset:5120
    ds_read_b64_tr_b16 a[142:143], v21 offset:5760
    ds_read_b64_tr_b16 a[144:145], v21 offset:5128
    ds_read_b64_tr_b16 a[146:147], v21 offset:5768
    ds_read_b64_tr_b16 a[148:149], v21 offset:5136
    ds_read_b64_tr_b16 a[150:151], v21 offset:5776
    ds_read_b64_tr_b16 a[152:153], v21 offset:5144
    ds_read_b64_tr_b16 a[154:155], v21 offset:5784
    ds_read_b64_tr_b16 a[156:157], v21 offset:5152
    ds_read_b64_tr_b16 a[158:159], v21 offset:5792
    s_waitcnt lgkmcnt(0)
    s_add_u32 m0, s51, 0
    s_add_u32 s44, s50, 1474560
    buffer_load_dwordx4 v16, s[16:19], s44 offen lds
    s_add_u32 m0, s51, 1024
    s_nop 0
    buffer_load_dwordx4 v17, s[16:19], s44 offen lds
    s_add_u32 m0, s51, 2048
    s_nop 0
    buffer_load_dwordx4 v18, s[16:19], s44 offen lds
    s_add_u32 m0, s51, 3072
    s_nop 0
    buffer_load_dwordx4 v19, s[16:19], s44 offen lds
    s_add_u32 m0, s51, 4096
    s_nop 0
    buffer_load_dwordx4 v20, s[16:19], s44 offen lds
    s_add_u32 m0, s51, 5120
    s_add_u32 s44, s50, 1597440
    buffer_load_dwordx4 v16, s[16:19], s44 offen lds
    s_add_u32 m0, s51, 6144
    s_nop 0
    buffer_load_dwordx4 v17, s[16:19], s44 offen lds
    s_add_u32 m0, s51, 7168
    s_nop 0
    buffer_load_dwordx4 v18, s[16:19], s44 offen lds
    s_add_u32 m0, s51, 8192
    s_nop 0
    buffer_load_dwordx4 v19, s[16:19], s44 offen lds
    s_add_u32 m0, s51, 9216
    s_nop 0
    buffer_load_dwordx4 v20, s[16:19], s44 offen lds
    s_waitcnt vmcnt(20)
    ds_read_b64_tr_b16 a[160:161], v21 offset:12288
    ds_read_b64_tr_b16 a[162:163], v21 offset:12928
    ds_read_b64_tr_b16 a[164:165], v21 offset:12296
    ds_read_b64_tr_b16 a[166:167], v21 offset:12936
    ds_read_b64_tr_b16 a[168:169], v21 offset:12304
    ds_read_b64_tr_b16 a[170:171], v21 offset:12944
    ds_read_b64_tr_b16 a[172:173], v21 offset:12312
    ds_read_b64_tr_b16 a[174:175], v21 offset:12952
    ds_read_b64_tr_b16 a[176:177], v21 offset:12320
    ds_read_b64_tr_b16 a[178:179], v21 offset:12960
    ds_read_b64_tr_b16 a[180:181], v21 offset:17408
    ds_read_b64_tr_b16 a[182:183], v21 offset:18048
    ds_read_b64_tr_b16 a[184:185], v21 offset:17416
    ds_read_b64_tr_b16 a[186:187], v21 offset:18056
    ds_read_b64_tr_b16 a[188:189], v21 offset:17424
    ds_read_b64_tr_b16 a[190:191], v21 offset:18064
    ds_read_b64_tr_b16 a[192:193], v21 offset:17432
    ds_read_b64_tr_b16 a[194:195], v21 offset:18072
    ds_read_b64_tr_b16 a[196:197], v21 offset:17440
    ds_read_b64_tr_b16 a[198:199], v21 offset:18080
    s_waitcnt lgkmcnt(0)
    s_add_u32 m0, s51, 12288
    s_add_u32 s44, s50, 1720320
    buffer_load_dwordx4 v16, s[16:19], s44 offen lds
    s_add_u32 m0, s51, 13312
    s_nop 0
    buffer_load_dwordx4 v17, s[16:19], s44 offen lds
    s_add_u32 m0, s51, 14336
    s_nop 0
    buffer_load_dwordx4 v18, s[16:19], s44 offen lds
    s_add_u32 m0, s51, 15360
    s_nop 0
    buffer_load_dwordx4 v19, s[16:19], s44 offen lds
    s_add_u32 m0, s51, 16384
    s_nop 0
    buffer_load_dwordx4 v20, s[16:19], s44 offen lds
    s_add_u32 m0, s51, 17408
    s_add_u32 s44, s50, 1843200
    buffer_load_dwordx4 v16, s[16:19], s44 offen lds
    s_add_u32 m0, s51, 18432
    s_nop 0
    buffer_load_dwordx4 v17, s[16:19], s44 offen lds
    s_add_u32 m0, s51, 19456
    s_nop 0
    buffer_load_dwordx4 v18, s[16:19], s44 offen lds
    s_add_u32 m0, s51, 20480
    s_nop 0
    buffer_load_dwordx4 v19, s[16:19], s44 offen lds
    s_add_u32 m0, s51, 21504
    s_nop 0
    buffer_load_dwordx4 v20, s[16:19], s44 offen lds
    s_waitcnt vmcnt(20)
    ds_read_b64_tr_b16 a[200:201], v21 offset:24576
    ds_read_b64_tr_b16 a[202:203], v21 offset:25216
    ds_read_b64_tr_b16 a[204:205], v21 offset:24584
    ds_read_b64_tr_b16 a[206:207], v21 offset:25224
    ds_read_b64_tr_b16 a[208:209], v21 offset:24592
    ds_read_b64_tr_b16 a[210:211], v21 offset:25232
    ds_read_b64_tr_b16 a[212:213], v21 offset:24600
    ds_read_b64_tr_b16 a[214:215], v21 offset:25240
    ds_read_b64_tr_b16 a[216:217], v21 offset:24608
    ds_read_b64_tr_b16 a[218:219], v21 offset:25248
    ds_read_b64_tr_b16 a[220:221], v21 offset:29696
    ds_read_b64_tr_b16 a[222:223], v21 offset:30336
    ds_read_b64_tr_b16 a[224:225], v21 offset:29704
    ds_read_b64_tr_b16 a[226:227], v21 offset:30344
    ds_read_b64_tr_b16 a[228:229], v21 offset:29712
    ds_read_b64_tr_b16 a[230:231], v21 offset:30352
    ds_read_b64_tr_b16 a[232:233], v21 offset:29720
    ds_read_b64_tr_b16 a[234:235], v21 offset:30360
    ds_read_b64_tr_b16 a[236:237], v21 offset:29728
    ds_read_b64_tr_b16 a[238:239], v21 offset:30368
    s_waitcnt lgkmcnt(0)
    s_add_u32 m0, s51, 24576
    s_add_u32 s44, s50, 1966080
    buffer_load_dwordx4 v16, s[16:19], s44 offen lds
    s_add_u32 m0, s51, 25600
    s_nop 0
    buffer_load_dwordx4 v17, s[16:19], s44 offen lds
    s_add_u32 m0, s51, 26624
    s_nop 0
    buffer_load_dwordx4 v18, s[16:19], s44 offen lds
    s_add_u32 m0, s51, 27648
    s_nop 0
    buffer_load_dwordx4 v19, s[16:19], s44 offen lds
    s_add_u32 m0, s51, 28672
    s_nop 0
    buffer_load_dwordx4 v20, s[16:19], s44 offen lds
    s_add_u32 m0, s51, 29696
    s_add_u32 s44, s50, 2088960
    buffer_load_dwordx4 v16, s[16:19], s44 offen lds
    s_add_u32 m0, s51, 30720
    s_nop 0
    buffer_load_dwordx4 v17, s[16:19], s44 offen lds
    s_add_u32 m0, s51, 31744
    s_nop 0
    buffer_load_dwordx4 v18, s[16:19], s44 offen lds
    s_add_u32 m0, s51, 32768
    s_nop 0
    buffer_load_dwordx4 v19, s[16:19], s44 offen lds
    s_add_u32 m0, s51, 33792
    s_nop 0
    buffer_load_dwordx4 v20, s[16:19], s44 offen lds
    s_waitcnt vmcnt(20)
    ds_read_b64_tr_b16 a[240:241], v21 offset:0
    ds_read_b64_tr_b16 a[242:243], v21 offset:640
    ds_read_b64_tr_b16 a[244:245], v21 offset:8
    ds_read_b64_tr_b16 a[246:247], v21 offset:648
    ds_read_b64_tr_b16 a[248:249], v21 offset:16
    ds_read_b64_tr_b16 a[250:251], v21 offset:656
    ds_read_b64_tr_b16 a[252:253], v21 offset:24
    ds_read_b64_tr_b16 a[254:255], v21 offset:664
    ds_read_b64_tr_b16 v[112:113], v21 offset:32
    ds_read_b64_tr_b16 v[114:115], v21 offset:672
    ds_read_b64_tr_b16 v[116:117], v21 offset:5120
    ds_read_b64_tr_b16 v[118:119], v21 offset:5760
    ds_read_b64_tr_b16 v[120:121], v21 offset:5128
    ds_read_b64_tr_b16 v[122:123], v21 offset:5768
    ds_read_b64_tr_b16 v[124:125], v21 offset:5136
    ds_read_b64_tr_b16 v[126:127], v21 offset:5776
    ds_read_b64_tr_b16 v[128:129], v21 offset:5144
    ds_read_b64_tr_b16 v[130:131], v21 offset:5784
    ds_read_b64_tr_b16 v[132:133], v21 offset:5152
    ds_read_b64_tr_b16 v[134:135], v21 offset:5792
    s_waitcnt lgkmcnt(0)
    s_add_u32 m0, s51, 0
    s_add_u32 s44, s50, 2211840
    buffer_load_dwordx4 v16, s[16:19], s44 offen lds
    s_add_u32 m0, s51, 1024
    s_nop 0
    buffer_load_dwordx4 v17, s[16:19], s44 offen lds
    s_add_u32 m0, s51, 2048
    s_nop 0
    buffer_load_dwordx4 v18, s[16:19], s44 offen lds
    s_add_u32 m0, s51, 3072
    s_nop 0
    buffer_load_dwordx4 v19, s[16:19], s44 offen lds
    s_add_u32 m0, s51, 4096
    s_nop 0
    buffer_load_dwordx4 v20, s[16:19], s44 offen lds
    s_add_u32 m0, s51, 5120
    s_add_u32 s44, s50, 2334720
    buffer_load_dwordx4 v16, s[16:19], s44 offen lds
    s_add_u32 m0, s51, 6144
    s_nop 0
    buffer_load_dwordx4 v17, s[16:19], s44 offen lds
    s_add_u32 m0, s51, 7168
    s_nop 0
    buffer_load_dwordx4 v18, s[16:19], s44 offen lds
    s_add_u32 m0, s51, 8192
    s_nop 0
    buffer_load_dwordx4 v19, s[16:19], s44 offen lds
    s_add_u32 m0, s51, 9216
    s_nop 0
    buffer_load_dwordx4 v20, s[16:19], s44 offen lds
    s_waitcnt vmcnt(20)
    ds_read_b64_tr_b16 v[136:137], v21 offset:12288
    ds_read_b64_tr_b16 v[138:139], v21 offset:12928
    ds_read_b64_tr_b16 v[140:141], v21 offset:12296
    ds_read_b64_tr_b16 v[142:143], v21 offset:12936
    ds_read_b64_tr_b16 v[144:145], v21 offset:12304
    ds_read_b64_tr_b16 v[146:147], v21 offset:12944
    ds_read_b64_tr_b16 v[148:149], v21 offset:12312
    ds_read_b64_tr_b16 v[150:151], v21 offset:12952
    ds_read_b64_tr_b16 v[152:153], v21 offset:12320
    ds_read_b64_tr_b16 v[154:155], v21 offset:12960
    ds_read_b64_tr_b16 v[156:157], v21 offset:17408
    ds_read_b64_tr_b16 v[158:159], v21 offset:18048
    ds_read_b64_tr_b16 v[160:161], v21 offset:17416
    ds_read_b64_tr_b16 v[162:163], v21 offset:18056
    ds_read_b64_tr_b16 v[164:165], v21 offset:17424
    ds_read_b64_tr_b16 v[166:167], v21 offset:18064
    ds_read_b64_tr_b16 v[168:169], v21 offset:17432
    ds_read_b64_tr_b16 v[170:171], v21 offset:18072
    ds_read_b64_tr_b16 v[172:173], v21 offset:17440
    ds_read_b64_tr_b16 v[174:175], v21 offset:18080
    s_waitcnt vmcnt(10)
    ds_read_b64_tr_b16 v[176:177], v21 offset:24576
    ds_read_b64_tr_b16 v[178:179], v21 offset:25216
    ds_read_b64_tr_b16 v[180:181], v21 offset:24584
    ds_read_b64_tr_b16 v[182:183], v21 offset:25224
    ds_read_b64_tr_b16 v[184:185], v21 offset:24592
    ds_read_b64_tr_b16 v[186:187], v21 offset:25232
    ds_read_b64_tr_b16 v[188:189], v21 offset:24600
    ds_read_b64_tr_b16 v[190:191], v21 offset:25240
    ds_read_b64_tr_b16 v[192:193], v21 offset:24608
    ds_read_b64_tr_b16 v[194:195], v21 offset:25248
    ds_read_b64_tr_b16 v[196:197], v21 offset:29696
    ds_read_b64_tr_b16 v[198:199], v21 offset:30336
    ds_read_b64_tr_b16 v[200:201], v21 offset:29704
    ds_read_b64_tr_b16 v[202:203], v21 offset:30344
    ds_read_b64_tr_b16 v[204:205], v21 offset:29712
    ds_read_b64_tr_b16 v[206:207], v21 offset:30352
    ds_read_b64_tr_b16 v[208:209], v21 offset:29720
    ds_read_b64_tr_b16 v[210:211], v21 offset:30360
    ds_read_b64_tr_b16 v[212:213], v21 offset:29728
    ds_read_b64_tr_b16 v[214:215], v21 offset:30368
    s_waitcnt vmcnt(0)
    ds_read_b64_tr_b16 v[216:217], v21 offset:0
    ds_read_b64_tr_b16 v[218:219], v21 offset:640
    ds_read_b64_tr_b16 v[220:221], v21 offset:8
    ds_read_b64_tr_b16 v[222:223], v21 offset:648
    ds_read_b64_tr_b16 v[224:225], v21 offset:16
    ds_read_b64_tr_b16 v[226:227], v21 offset:656
    ds_read_b64_tr_b16 v[228:229], v21 offset:24
    ds_read_b64_tr_b16 v[230:231], v21 offset:664
    ds_read_b64_tr_b16 v[232:233], v21 offset:32
    ds_read_b64_tr_b16 v[234:235], v21 offset:672
    ds_read_b64_tr_b16 v[236:237], v21 offset:5120
    ds_read_b64_tr_b16 v[238:239], v21 offset:5760
    ds_read_b64_tr_b16 v[240:241], v21 offset:5128
    ds_read_b64_tr_b16 v[242:243], v21 offset:5768
    ds_read_b64_tr_b16 v[244:245], v21 offset:5136
    ds_read_b64_tr_b16 v[246:247], v21 offset:5776
    ds_read_b64_tr_b16 v[248:249], v21 offset:5144
    ds_read_b64_tr_b16 v[250:251], v21 offset:5784
    ds_read_b64_tr_b16 v[252:253], v21 offset:5152
    ds_read_b64_tr_b16 v[254:255], v21 offset:5792
    s_waitcnt lgkmcnt(0)
    s_barrier
    s_branch L_B_go
L_B_w3:
    v_mov_b32 v24, 0
    v_mov_b32 v25, 0
    v_mov_b32 v26, 0
    v_mov_b32 v27, 0
    v_mov_b32 v28, 0
    v_mov_b32 v29, 0
    v_mov_b32 v30, 0
    v_mov_b32 v31, 0
    v_mov_b32 v32, 0
    v_mov_b32 v33, 0
    v_mov_b32 v34, 0
    v_mov_b32 v35, 0
    v_mov_b32 v36, 0
    v_mov_b32 v37, 0
    v_mov_b32 v38, 0
    v_mov_b32 v39, 0
    v_mov_b32 v40, 0
    v_mov_b32 v41, 0
    v_mov_b32 v42, 0
    v_mov_b32 v43, 0
    v_mov_b32 v44, 0
    v_mov_b32 v45, 0
    v_mov_b32 v46, 0
    v_mov_b32 v47, 0
    v_mov_b32 v48, 0
    v_mov_b32 v49, 0
    v_mov_b32 v50, 0
    v_mov_b32 v51, 0
    v_mov_b32 v52, 0
    v_mov_b32 v53, 0
    v_mov_b32 v54, 0
    v_mov_b32 v55, 0
    v_mov_b32 v56, 0
    v_mov_b32 v57, 0
    v_mov_b32 v58, 0
    v_mov_b32 v59, 0
    v_mov_b32 v60, 0
    v_mov_b32 v61, 0
    v_mov_b32 v62, 0
    v_mov_b32 v63, 0
    v_mov_b32 v64, 0
    v_mov_b32 v65, 0
    v_mov_b32 v66, 0
    v_mov_b32 v67, 0
    v_mov_b32 v68, 0
    v_mov_b32 v69, 0
    v_mov_b32 v70, 0
    v_mov_b32 v71, 0
    v_mov_b32 v72, 0
    v_mov_b32 v73, 0
    v_mov_b32 v74, 0
    v_mov_b32 v75, 0
    v_mov_b32 v76, 0
    v_mov_b32 v77, 0
    v_mov_b32 v78, 0
    v_mov_b32 v79, 0
    v_mov_b32 v80, 0
    v_mov_b32 v81, 0
    v_mov_b32 v82, 0
    v_mov_b32 v83, 0
    v_lshrrev_b32 v2, 2, v14
    v_cmp_eq_u32 vcc, v2, v15
    v_mul_u32_u24 v3, 800, v15
    v_and_b32 v4, 3, v1
    v_lshl_add_u32 v3, v4, 1, v3
    s_mul_i32 s44, s32, 3200
    s_mov_b64 exec, vcc
    buffer_load_ushort v112, v3, s[20:23], s44 offen offset:0
    buffer_load_ushort v113, v3, s[20:23], s44 offen offset:40
    buffer_load_ushort v114, v3, s[20:23], s44 offen offset:80
    buffer_load_ushort v115, v3, s[20:23], s44 offen offset:120
    buffer_load_ushort v116, v3, s[20:23], s44 offen offset:160
    buffer_load_ushort v117, v3, s[20:23], s44 offen offset:200
    buffer_load_ushort v118, v3, s[20:23], s44 offen offset:240
    buffer_load_ushort v119, v3, s[20:23], s44 offen offset:280
    buffer_load_ushort v120, v3, s[20:23], s44 offen offset:320
    buffer_load_ushort v121, v3, s[20:23], s44 offen offset:360
    buffer_load_ushort v122, v3, s[20:23], s44 offen offset:400
    buffer_load_ushort v123, v3, s[20:23], s44 offen offset:440
    buffer_load_ushort v124, v3, s[20:23], s44 offen offset:480
    buffer_load_ushort v125, v3, s[20:23], s44 offen offset:520
    buffer_load_ushort v126, v3, s[20:23], s44 offen offset:560
    buffer_load_ushort v127, v3, s[20:23], s44 offen offset:600
    buffer_load_ushort v128, v3, s[20:23], s44 offen offset:640
    buffer_load_ushort v129, v3, s[20:23], s44 offen offset:680
    buffer_load_ushort v130, v3, s[20:23], s44 offen offset:720
    buffer_load_ushort v131, v3, s[20:23], s44 offen offset:760
    buffer_load_ushort v132, v3, s[20:23], s44 offen offset:8
    buffer_load_ushort v133, v3, s[20:23], s44 offen offset:48
    buffer_load_ushort v134, v3, s[20:23], s44 offen offset:88
    buffer_load_ushort v135, v3, s[20:23], s44 offen offset:128
    buffer_load_ushort v136, v3, s[20:23], s44 offen offset:168
    buffer_load_ushort v137, v3, s[20:23], s44 offen offset:208
    buffer_load_ushort v138, v3, s[20:23], s44 offen offset:248
    buffer_load_ushort v139, v3, s[20:23], s44 offen offset:288
    buffer_load_ushort v140, v3, s[20:23], s44 offen offset:328
    buffer_load_ushort v141, v3, s[20:23], s44 offen offset:368
    buffer_load_ushort v142, v3, s[20:23], s44 offen offset:408
    buffer_load_ushort v143, v3, s[20:23], s44 offen offset:448
    buffer_load_ushort v144, v3, s[20:23], s44 offen offset:488
    buffer_load_ushort v145, v3, s[20:23], s44 offen offset:528
    buffer_load_ushort v146, v3, s[20:23], s44 offen offset:568
    buffer_load_ushort v147, v3, s[20:23], s44 offen offset:608
    buffer_load_ushort v148, v3, s[20:23], s44 offen offset:648
    buffer_load_ushort v149, v3, s[20:23], s44 offen offset:688
    buffer_load_ushort v150, v3, s[20:23], s44 offen offset:728
    buffer_load_ushort v151, v3, s[20:23], s44 offen offset:768
    buffer_load_ushort v152, v3, s[20:23], s44 offen offset:16
    buffer_load_ushort v153, v3, s[20:23], s44 offen offset:56
    buffer_load_ushort v154, v3, s[20:23], s44 offen offset:96
    buffer_load_ushort v155, v3, s[20:23], s44 offen offset:136
    buffer_load_ushort v156, v3, s[20:23], s44 offen offset:176
    buffer_load_ushort v157, v3, s[20:23], s44 offen offset:216
    buffer_load_ushort v158, v3, s[20:23], s44 offen offset:256
    buffer_load_ushort v159, v3, s[20:23], s44 offen offset:296
    buffer_load_ushort v160, v3, s[20:23], s44 offen offset:336
    buffer_load_ushort v161, v3, s[20:23], s44 offen offset:376
    buffer_load_ushort v162, v3, s[20:23], s44 offen offset:416
    buffer_load_ushort v163, v3, s[20:23], s44 offen offset:456
    buffer_load_ushort v164, v3, s[20:23], s44 offen offset:496
    buffer_load_ushort v165, v3, s[20:23], s44 offen offset:536
    buffer_load_ushort v166, v3, s[20:23], s44 offen offset:576
    buffer_load_ushort v167, v3, s[20:23], s44 offen offset:616
    buffer_load_ushort v168, v3, s[20:23], s44 offen offset:656
    buffer_load_ushort v169, v3, s[20:23], s44 offen offset:696
    buffer_load_ushort v170, v3, s[20:23], s44 offen offset:736
    buffer_load_ushort v171, v3, s[20:23], s44 offen offset:776
    buffer_load_ushort v172, v3, s[20:23], s44 offen offset:24
    buffer_load_ushort v173, v3, s[20:23], s44 offen offset:64
    buffer_load_ushort v174, v3, s[20:23], s44 offen offset:104
    buffer_load_ushort v175, v3, s[20:23], s44 offen offset:144
    buffer_load_ushort v176, v3, s[20:23], s44 offen offset:184
    buffer_load_ushort v177, v3, s[20:23], s44 offen offset:224
    buffer_load_ushort v178, v3, s[20:23], s44 offen offset:264
    buffer_load_ushort v179, v3, s[20:23], s44 offen offset:304
    buffer_load_ushort v180, v3, s[20:23], s44 offen offset:344
    buffer_load_ushort v181, v3, s[20:23], s44 offen offset:384
    buffer_load_ushort v182, v3, s[20:23], s44 offen offset:424
    buffer_load_ushort v183, v3, s[20:23], s44 offen offset:464
    buffer_load_ushort v184, v3, s[20:23], s44 offen offset:504
    buffer_load_ushort v185, v3, s[20:23], s44 offen offset:544
    buffer_load_ushort v186, v3, s[20:23], s44 offen offset:584
    buffer_load_ushort v187, v3, s[20:23], s44 offen offset:624
    buffer_load_ushort v188, v3, s[20:23], s44 offen offset:664
    buffer_load_ushort v189, v3, s[20:23], s44 offen offset:704
    buffer_load_ushort v190, v3, s[20:23], s44 offen offset:744
    buffer_load_ushort v191, v3, s[20:23], s44 offen offset:784
    buffer_load_ushort v192, v3, s[20:23], s44 offen offset:32
    buffer_load_ushort v193, v3, s[20:23], s44 offen offset:72
    buffer_load_ushort v194, v3, s[20:23], s44 offen offset:112
    buffer_load_ushort v195, v3, s[20:23], s44 offen offset:152
    buffer_load_ushort v196, v3, s[20:23], s44 offen offset:192
    buffer_load_ushort v197, v3, s[20:23], s44 offen offset:232
    buffer_load_ushort v198, v3, s[20:23], s44 offen offset:272
    buffer_load_ushort v199, v3, s[20:23], s44 offen offset:312
    buffer_load_ushort v200, v3, s[20:23], s44 offen offset:352
    buffer_load_ushort v201, v3, s[20:23], s44 offen offset:392
    buffer_load_ushort v202, v3, s[20:23], s44 offen offset:432
    buffer_load_ushort v203, v3, s[20:23], s44 offen offset:472
    buffer_load_ushort v204, v3, s[20:23], s44 offen offset:512
    buffer_load_ushort v205, v3, s[20:23], s44 offen offset:552
    buffer_load_ushort v206, v3, s[20:23], s44 offen offset:592
    buffer_load_ushort v207, v3, s[20:23], s44 offen offset:632
    buffer_load_ushort v208, v3, s[20:23], s44 offen offset:672
    buffer_load_ushort v209, v3, s[20:23], s44 offen offset:712
    buffer_load_ushort v210, v3, s[20:23], s44 offen offset:752
    buffer_load_ushort v211, v3, s[20:23], s44 offen offset:792
    s_waitcnt vmcnt(0)
    v_lshl_or_b32 v24, v113, 16, v112
    v_lshl_or_b32 v25, v115, 16, v114
    v_lshl_or_b32 v26, v117, 16, v116
    v_lshl_or_b32 v27, v119, 16, v118
    v_lshl_or_b32 v28, v121, 16, v120
    v_lshl_or_b32 v29, v123, 16, v122
    v_lshl_or_b32 v30, v125, 16, v124
    v_lshl_or_b32 v31, v127, 16, v126
    v_lshl_or_b32 v32, v129, 16, v128
    v_lshl_or_b32 v33, v131, 16, v130
    v_lshl_or_b32 v36, v133, 16, v132
    v_lshl_or_b32 v37, v135, 16, v134
    v_lshl_or_b32 v38, v137, 16, v136
    v_lshl_or_b32 v39, v139, 16, v138
    v_lshl_or_b32 v40, v141, 16, v140
    v_lshl_or_b32 v41, v143, 16, v142
    v_lshl_or_b32 v42, v145, 16, v144
    v_lshl_or_b32 v43, v147, 16, v146
    v_lshl_or_b32 v44, v149, 16, v148
    v_lshl_or_b32 v45, v151, 16, v150
    v_lshl_or_b32 v48, v153, 16, v152
    v_lshl_or_b32 v49, v155, 16, v154
    v_lshl_or_b32 v50, v157, 16, v156
    v_lshl_or_b32 v51, v159, 16, v158
    v_lshl_or_b32 v52, v161, 16, v160
    v_lshl_or_b32 v53, v163, 16, v162
    v_lshl_or_b32 v54, v165, 16, v164
    v_lshl_or_b32 v55, v167, 16, v166
    v_lshl_or_b32 v56, v169, 16, v168
    v_lshl_or_b32 v57, v171, 16, v170
    v_lshl_or_b32 v60, v173, 16, v172
    v_lshl_or_b32 v61, v175, 16, v174
    v_lshl_or_b32 v62, v177, 16, v176
    v_lshl_or_b32 v63, v179, 16, v178
    v_lshl_or_b32 v64, v181, 16, v180
    v_lshl_or_b32 v65, v183, 16, v182
    v_lshl_or_b32 v66, v185, 16, v184
    v_lshl_or_b32 v67, v187, 16, v186
    v_lshl_or_b32 v68, v189, 16, v188
    v_lshl_or_b32 v69, v191, 16, v190
    v_lshl_or_b32 v72, v193, 16, v192
    v_lshl_or_b32 v73, v195, 16, v194
    v_lshl_or_b32 v74, v197, 16, v196
    v_lshl_or_b32 v75, v199, 16, v198
    v_lshl_or_b32 v76, v201, 16, v200
    v_lshl_or_b32 v77, v203, 16, v202
    v_lshl_or_b32 v78, v205, 16, v204
    v_lshl_or_b32 v79, v207, 16, v206
    v_lshl_or_b32 v80, v209, 16, v208
    v_lshl_or_b32 v81, v211, 16, v210
    s_mov_b64 exec, -1
    s_waitcnt vmcnt(0)
    s_barrier
    v_add_u32 v2, 81920, v12
    ds_write_b128 v2, v[24:27]
    v_add_u32 v2, 82944, v12
    ds_write_b128 v2, v[28:31]
    v_add_u32 v2, 83968, v12
    ds_write_b128 v2, v[32:35]
    v_add_u32 v2, 84992, v12
    ds_write_b128 v2, v[36:39]
    v_add_u32 v2, 86016, v12
    ds_write_b128 v2, v[40:43]
    v_add_u32 v2, 87040, v12
    ds_write_b128 v2, v[44:47]
    v_add_u32 v2, 88064, v12
    ds_write_b128 v2, v[48:51]
    v_add_u32 v2, 89088, v12
    ds_write_b128 v2, v[52:55]
    v_add_u32 v2, 90112, v12
    ds_write_b128 v2, v[56:59]
    v_add_u32 v2, 91136, v12
    ds_write_b128 v2, v[60:63]
    v_add_u32 v2, 92160, v12
    ds_write_b128 v2, v[64:67]
    v_add_u32 v2, 93184, v12
    ds_write_b128 v2, v[68:71]
    v_add_u32 v2, 94208, v12
    ds_write_b128 v2, v[72:75]
    v_add_u32 v2, 95232, v12
    ds_write_b128 v2, v[76:79]
    v_add_u32 v2, 96256, v12
    ds_write_b128 v2, v[80:83]
    v_mov_b32 v4, 0x3f80
    v_mov_b32 v5, 0
    v_mul_u32_u24 v2, 192, v1
    v_add_u32 v2, 118312, v2
    ds_write_b64 v2, v[4:5] offset:0
    ds_write_b64 v2, v[4:5] offset:48
    ds_write_b64 v2, v[4:5] offset:96
    ds_write_b64 v2, v[4:5] offset:144
    v_mov_b32 v112, 0
    v_mov_b32 v113, 0
    v_mov_b32 v114, 0
    v_mov_b32 v115, 0
    v_mov_b32 v116, 0
    v_mov_b32 v117, 0
    v_mov_b32 v118, 0
    v_mov_b32 v119, 0
    v_mov_b32 v120, 0
    v_mov_b32 v121, 0
    v_mov_b32 v122, 0
    v_mov_b32 v123, 0
    v_mov_b32 v124, 0
    v_mov_b32 v125, 0
    v_mov_b32 v126, 0
    v_mov_b32 v127, 0
    v_mov_b32 v128, 0
    v_mov_b32 v129, 0
    v_mov_b32 v130, 0
    v_mov_b32 v131, 0
    v_mov_b32 v132, 0
    v_mov_b32 v133, 0
    v_mov_b32 v134, 0
    v_mov_b32 v135, 0
    v_mov_b32 v136, 0
    v_mov_b32 v137, 0
    v_mov_b32 v138, 0
    v_mov_b32 v139, 0
    v_mov_b32 v140, 0
    v_mov_b32 v141, 0
    v_mov_b32 v142, 0
    v_mov_b32 v143, 0
    v_mov_b32 v144, 0
    v_mov_b32 v145, 0
    v_mov_b32 v146, 0
    v_mov_b32 v147, 0
    v_mov_b32 v148, 0
    v_mov_b32 v149, 0
    v_mov_b32 v150, 0
    v_mov_b32 v151, 0
    v_mov_b32 v152, 0
    v_mov_b32 v153, 0
    v_mov_b32 v154, 0
    v_mov_b32 v155, 0
    v_mov_b32 v156, 0
    v_mov_b32 v157, 0
    v_mov_b32 v158, 0
    v_mov_b32 v159, 0
    v_mov_b32 v160, 0
    v_mov_b32 v161, 0
    v_mov_b32 v162, 0
    v_mov_b32 v163, 0
    v_mov_b32 v164, 0
    v_mov_b32 v165, 0
    v_mov_b32 v166, 0
    v_mov_b32 v167, 0
    v_mov_b32 v168, 0
    v_mov_b32 v169, 0
    v_mov_b32 v170, 0
    v_mov_b32 v171, 0
    v_mov_b32 v172, 0
    v_mov_b32 v173, 0
    v_mov_b32 v174, 0
    v_mov_b32 v175, 0
    v_mov_b32 v176, 0
    v_mov_b32 v177, 0
    v_mov_b32 v178, 0
    v_mov_b32 v179, 0
    v_mov_b32 v180, 0
    v_mov_b32 v181, 0
    v_mov_b32 v182, 0
    v_mov_b32 v183, 0
    v_mov_b32 v184, 0
    v_mov_b32 v185, 0
    v_mov_b32 v186, 0
    v_mov_b32 v187, 0
    v_mov_b32 v188, 0
    v_mov_b32 v189, 0
    v_mov_b32 v190, 0
    v_mov_b32 v191, 0
    v_mov_b32 v192, 0
    v_mov_b32 v193, 0
    v_mov_b32 v194, 0
    v_mov_b32 v195, 0
    v_mov_b32 v196, 0
    v_mov_b32 v197, 0
    v_mov_b32 v198, 0
    v_mov_b32 v199, 0
    v_mov_b32 v200, 0
    v_mov_b32 v201, 0
    v_mov_b32 v202, 0
    v_mov_b32 v203, 0
    v_mov_b32 v204, 0
    v_mov_b32 v205, 0
    v_mov_b32 v206, 0
    v_mov_b32 v207, 0
L_B_go:
    s_mul_i32 s52, s36, 655360
    s_mov_b32 s53, 0
    s_mov_b32 s35, 0
    s_mov_b32 s44, s52
    s_lshl_b32 s46, s34, 10
    s_add_u32 s46, s46, s53
    s_add_u32 m0, s46, 0
    s_nop 0
    buffer_load_dwordx4 v11, s[24:27], s44 offen  lds
    s_add_u32 m0, s46, 4096
    s_add_u32 s44, s44, 128
    buffer_load_dwordx4 v11, s[24:27], s44 offen  lds
    s_add_u32 m0, s46, 8192
    s_add_u32 s44, s44, 128
    buffer_load_dwordx4 v11, s[24:27], s44 offen  lds
    s_add_u32 m0, s46, 12288
    s_add_u32 s44, s44, 128
    buffer_load_dwordx4 v11, s[24:27], s44 offen  lds
    s_add_u32 m0, s46, 16384
    s_add_u32 s44, s44, 128
    buffer_load_dwordx4 v11, s[24:27], s44 offen  lds
    s_add_u32 m0, s46, 20480
    s_add_u32 s44, s44, 128
    buffer_load_dwordx4 v11, s[24:27], s44 offen  lds
    s_add_u32 m0, s46, 24576
    s_add_u32 s44, s44, 128
    buffer_load_dwordx4 v11, s[24:27], s44 offen  lds
    s_add_u32 m0, s46, 28672
    s_add_u32 s44, s44, 128
    buffer_load_dwordx4 v11, s[24:27], s44 offen  lds
    s_add_u32 m0, s46, 32768
    s_add_u32 s44, s44, 128
    buffer_load_dwordx4 v11, s[24:27], s44 offen  lds
    s_add_u32 m0, s46, 36864
    s_add_u32 s44, s44, 128
    buffer_load_dwordx4 v11, s[24:27], s44 offen  lds
    v_mul_u32_u24 v2, 320, v14
    v_mul_u32_u24 v3, 80, v15
    v_add3_u32 v16, v2, v3, 0
    v_add_u32 v16, 97280, v16
    v_mul_u32_u24 v2, 192, v14
    v_mul_u32_u24 v3, 48, v15
    v_add_u32 v17, v2, v3
    v_add_u32 v17, 118272, v17
    v_mul_u32_u24 v2, 1280, v15
    v_lshl_add_u32 v18, v14, 4, v2
    v_lshrrev_b32 v2, 2, v14
    v_lshl_add_u32 v2, v15, 3, v2
    v_and_b32 v3, 3, v1
    v_mul_u32_u24 v4, 320, v2
    v_lshl_add_u32 v19, v3, 3, v4
    v_add_u32 v19, 97280, v19
    v_mul_u32_u24 v4, 192, v2
    v_lshl_add_u32 v20, v3, 3, v4
    v_add_u32 v20, 118272, v20
    v_min_u32 v3, 1, v3
    v_lshl_add_u32 v21, v3, 3, v4
    v_add_u32 v21, 118304, v21
    v_add_u32 v22, 81920, v12
L_B1:
    s_waitcnt vmcnt(0) lgkmcnt(0)
    s_barrier
    v_add_u32 v13, s53, v0
    s_xor_b32 s53, s53, 40960
    s_add_u32 s52, s52, 40960
    s_cmp_ge_u32 s35, 15
    s_cbranch_scc1 L_B1_nox
    s_mov_b32 s44, s52
    s_lshl_b32 s46, s34, 10
    s_add_u32 s46, s46, s53
    s_add_u32 m0, s46, 0
    s_nop 0
    buffer_load_dwordx4 v11, s[24:27], s44 offen  lds
    s_add_u32 m0, s46, 4096
    s_add_u32 s44, s44, 128
    buffer_load_dwordx4 v11, s[24:27], s44 offen  lds
    s_add_u32 m0, s46, 8192
    s_add_u32 s44, s44, 128
    buffer_load_dwordx4 v11, s[24:27], s44 offen  lds
    s_add_u32 m0, s46, 12288
    s_add_u32 s44, s44, 128
    buffer_load_dwordx4 v11, s[24:27], s44 offen  lds
    s_add_u32 m0, s46, 16384
    s_add_u32 s44, s44, 128
    buffer_load_dwordx4 v11, s[24:27], s44 offen  lds
    s_add_u32 m0, s46, 20480
    s_add_u32 s44, s44, 128
    buffer_load_dwordx4 v11, s[24:27], s44 offen  lds
    s_add_u32 m0, s46, 24576
    s_add_u32 s44, s44, 128
    buffer_load_dwordx4 v11, s[24:27], s44 offen  lds
    s_add_u32 m0, s46, 28672
    s_add_u32 s44, s44, 128
    buffer_load_dwordx4 v11, s[24:27], s44 offen  lds
    s_add_u32 m0, s46, 32768
    s_add_u32 s44, s44, 128
    buffer_load_dwordx4 v11, s[24:27], s44 offen  lds
    s_add_u32 m0, s46, 36864
    s_add_u32 s44, s44, 128
    buffer_load_dwordx4 v11, s[24:27], s44 offen  lds
L_B1_nox:
    s_and_b32 s54, s35, 1
    s_cmp_eq_u32 s34, 3
    s_cbranch_scc1 L_B1_kv
    s_cmp_ge_u32 s35, 16
    s_cbranch_scc1 L_B1_next
    v_xor_b32 v10, 64, v13
    ds_read_b128 v[64:67], v13 offset:0
    ds_read_b128 v[68:71], v13 offset:2048
    ds_read_b128 v[72:75], v10 offset:0
    ds_read_b128 v[76:79], v10 offset:2048
    s_waitcnt lgkmcnt(2)
    v_mfma_f32_16x16x32_bf16 v[24:27], a[0:3], v[64:67], 0
    v_mfma_f32_16x16x32_bf16 v[44:47], a[0:3], v[68:71], 0
    v_mfma_f32_16x16x32_bf16 v[28:31], a[4:7], v[64:67], 0
    v_mfma_f32_16x16x32_bf16 v[48:51], a[4:7], v[68:71], 0
    v_mfma_f32_16x16x32_bf16 v[32:35], a[8:11], v[64:67], 0
    v_mfma_f32_16x16x32_bf16 v[52:55], a[8:11], v[68:71], 0
    v_mfma_f32_16x16x32_bf16 v[36:39], a[12:15], v[64:67], 0
    v_mfma_f32_16x16x32_bf16 v[56:59], a[12:15], v[68:71], 0
    v_mfma_f32_16x16x32_bf16 v[40:43], a[16:19], v[64:67], 0
    v_mfma_f32_16x16x32_bf16 v[60:63], a[16:19], v[68:71], 0
    ds_read_b128 v[64:67], v13 offset:4096
    ds_read_b128 v[68:71], v13 offset:6144
    s_waitcnt lgkmcnt(2)
    v_mfma_f32_16x16x32_bf16 v[24:27], a[20:23], v[72:75], v[24:27]
    v_mfma_f32_16x16x32_bf16 v[44:47], a[20:23], v[76:79], v[44:47]
    v_mfma_f32_16x16x32_bf16 v[28:31], a[24:27], v[72:75], v[28:31]
    v_mfma_f32_16x16x32_bf16 v[48:51], a[24:27], v[76:79], v[48:51]
    v_mfma_f32_16x16x32_bf16 v[32:35], a[28:31], v[72:75], v[32:35]
    v_mfma_f32_16x16x32_bf16 v[52:55], a[28:31], v[76:79], v[52:55]
    v_mfma_f32_16x16x32_bf16 v[36:39], a[32:35], v[72:75], v[36:39]
    v_mfma_f32_16x16x32_bf16 v[56:59], a[32:35], v[76:79], v[56:59]
    v_mfma_f32_16x16x32_bf16 v[40:43], a[36:39], v[72:75], v[40:43]
    v_mfma_f32_16x16x32_bf16 v[60:63], a[36:39], v[76:79], v[60:63]
    ds_read_b128 v[72:75], v10 offset:4096
    ds_read_b128 v[76:79], v10 offset:6144
    s_waitcnt lgkmcnt(2)
    v_mfma_f32_16x16x32_bf16 v[24:27], a[40:43], v[64:67], v[24:27]
    v_mfma_f32_16x16x32_bf16 v[44:47], a[40:43], v[68:71], v[44:47]
    v_mfma_f32_16x16x32_bf16 v[28:31], a[44:47], v[64:67], v[28:31]
    v_mfma_f32_16x16x32_bf16 v[48:51], a[44:47], v[68:71], v[48:51]
    v_mfma_f32_16x16x32_bf16 v[32:35], a[48:51], v[64:67], v[32:35]
    v_mfma_f32_16x16x32_bf16 v[52:55], a[48:51], v[68:71], v[52:55]
    v_mfma_f32_16x16x32_bf16 v[36:39], a[52:55], v[64:67], v[36:39]
    v_mfma_f32_16x16x32_bf16 v[56:59], a[52:55], v[68:71], v[56:59]
    v_mfma_f32_16x16x32_bf16 v[40:43], a[56:59], v[64:67], v[40:43]
    v_mfma_f32_16x16x32_bf16 v[60:63], a[56:59], v[68:71], v[60:63]
    ds_read_b128 v[64:67], v13 offset:8192
    ds_read_b128 v[68:71], v13 offset:10240
    s_waitcnt lgkmcnt(2)
    v_mfma_f32_16x16x32_bf16 v[24:27], a[60:63], v[72:75], v[24:27]
    v_mfma_f32_16x16x32_bf16 v[44:47], a[60:63], v[76:79], v[44:47]
    v_mfma_f32_16x16x32_bf16 v[28:31], a[64:67], v[72:75], v[28:31]
    v_mfma_f32_16x16x32_bf16 v[48:51], a[64:67], v[76:79], v[48:51]
    v_mfma_f32_16x16x32_bf16 v[32:35], a[68:71], v[72:75], v[32:35]
    v_mfma_f32_16x16x32_bf16 v[52:55], a[68:71], v[76:79], v[52:55]
    v_mfma_f32_16x16x32_bf16 v[36:39], a[72:75], v[72:75], v[36:39]
    v_mfma_f32_16x16x32_bf16 v[56:59], a[72:75], v[76:79], v[56:59]
    v_mfma_f32_16x16x32_bf16 v[40:43], a[76:79], v[72:75], v[40:43]
    v_mfma_f32_16x16x32_bf16 v[60:63], a[76:79], v[76:79], v[60:63]
    ds_read_b128 v[72:75], v10 offset:8192
    ds_read_b128 v[76:79], v10 offset:10240
    s_waitcnt lgkmcnt(2)
    v_mfma_f32_16x16x32_bf16 v[24:27], a[80:83], v[64:67], v[24:27]
    v_mfma_f32_16x16x32_bf16 v[44:47], a[80:83], v[68:71], v[44:47]
    v_mfma_f32_16x16x32_bf16 v[28:31], a[84:87], v[64:67], v[28:31]
    v_mfma_f32_16x16x32_bf16 v[48:51], a[84:87], v[68:71], v[48:51]
    v_mfma_f32_16x16x32_bf16 v[32:35], a[88:91], v[64:67], v[32:35]
    v_mfma_f32_16x16x32_bf16 v[52:55], a[88:91], v[68:71], v[52:55]
    v_mfma_f32_16x16x32_bf16 v[36:39], a[92:95], v[64:67], v[36:39]
    v_mfma_f32_16x16x32_bf16 v[56:59], a[92:95], v[68:71], v[56:59]
    v_mfma_f32_16x16x32_bf16 v[40:43], a[96:99], v[64:67], v[40:43]
    v_mfma_f32_16x16x32_bf16 v[60:63], a[96:99], v[68:71], v[60:63]
    ds_read_b128 v[64:67], v13 offset:12288
    ds_read_b128 v[68:71], v13 offset:14336
    s_waitcnt lgkmcnt(2)
    v_mfma_f32_16x16x32_bf16 v[24:27], a[100:103], v[72:75], v[24:27]
    v_mfma_f32_16x16x32_bf16 v[44:47], a[100:103], v[76:79], v[44:47]
    v_mfma_f32_16x16x32_bf16 v[28:31], a[104:107], v[72:75], v[28:31]
    v_mfma_f32_16x16x32_bf16 v[48:51], a[104:107], v[76:79], v[48:51]
    v_mfma_f32_16x16x32_bf16 v[32:35], a[108:111], v[72:75], v[32:35]
    v_mfma_f32_16x16x32_bf16 v[52:55], a[108:111], v[76:79], v[52:55]
    v_mfma_f32_16x16x32_bf16 v[36:39], a[112:115], v[72:75], v[36:39]
    v_mfma_f32_16x16x32_bf16 v[56:59], a[112:115], v[76:79], v[56:59]
    v_mfma_f32_16x16x32_bf16 v[40:43], a[116:119], v[72:75], v[40:43]
    v_mfma_f32_16x16x32_bf16 v[60:63], a[116:119], v[76:79], v[60:63]
    ds_read_b128 v[72:75], v10 offset:12288
    ds_read_b128 v[76:79], v10 offset:14336
    s_waitcnt lgkmcnt(2)
    v_mfma_f32_16x16x32_bf16 v[24:27], a[120:123], v[64:67], v[24:27]
    v_mfma_f32_16x16x32_bf16 v[44:47], a[120:123], v[68:71], v[44:47]
    v_mfma_f32_16x16x32_bf16 v[28:31], a[124:127], v[64:67], v[28:31]
    v_mfma_f32_16x16x32_bf16 v[48:51], a[124:127], v[68:71], v[48:51]
    v_mfma_f32_16x16x32_bf16 v[32:35], a[128:131], v[64:67], v[32:35]
    v_mfma_f32_16x16x32_bf16 v[52:55], a[128:131], v[68:71], v[52:55]
    v_mfma_f32_16x16x32_bf16 v[36:39], a[132:135], v[64:67], v[36:39]
    v_mfma_f32_16x16x32_bf16 v[56:59], a[132:135], v[68:71], v[56:59]
    v_mfma_f32_16x16x32_bf16 v[40:43], a[136:139], v[64:67], v[40:43]
    v_mfma_f32_16x16x32_bf16 v[60:63], a[136:139], v[68:71], v[60:63]
    ds_read_b128 v[64:67], v13 offset:16384
    ds_read_b128 v[68:71], v13 offset:18432
    s_waitcnt lgkmcnt(2)
    v_mfma_f32_16x16x32_bf16 v[24:27], a[140:143], v[72:75], v[24:27]
    v_mfma_f32_16x16x32_bf16 v[44:47], a[140:143], v[76:79], v[44:47]
    v_mfma_f32_16x16x32_bf16 v[28:31], a[144:147], v[72:75], v[28:31]
    v_mfma_f32_16x16x32_bf16 v[48:51], a[144:147], v[76:79], v[48:51]
    v_mfma_f32_16x16x32_bf16 v[32:35], a[148:151], v[72:75], v[32:35]
    v_mfma_f32_16x16x32_bf16 v[52:55], a[148:151], v[76:79], v[52:55]
    v_mfma_f32_16x16x32_bf16 v[36:39], a[152:155], v[72:75], v[36:39]
    v_mfma_f32_16x16x32_bf16 v[56:59], a[152:155], v[76:79], v[56:59]
    v_mfma_f32_16x16x32_bf16 v[40:43], a[156:159], v[72:75], v[40:43]
    v_mfma_f32_16x16x32_bf16 v[60:63], a[156:159], v[76:79], v[60:63]
    ds_read_b128 v[72:75], v10 offset:16384
    ds_read_b128 v[76:79], v10 offset:18432
    s_waitcnt lgkmcnt(2)
    v_mfma_f32_16x16x32_bf16 v[24:27], a[160:163], v[64:67], v[24:27]
    v_mfma_f32_16x16x32_bf16 v[44:47], a[160:163], v[68:71], v[44:47]
    v_mfma_f32_16x16x32_bf16 v[28:31], a[164:167], v[64:67], v[28:31]
    v_mfma_f32_16x16x32_bf16 v[48:51], a[164:167], v[68:71], v[48:51]
    v_mfma_f32_16x16x32_bf16 v[32:35], a[168:171], v[64:67], v[32:35]
    v_mfma_f32_16x16x32_bf16 v[52:55], a[168:171], v[68:71], v[52:55]
    v_mfma_f32_16x16x32_bf16 v[36:39], a[172:175], v[64:67], v[36:39]
    v_mfma_f32_16x16x32_bf16 v[56:59], a[172:175], v[68:71], v[56:59]
    v_mfma_f32_16x16x32_bf16 v[40:43], a[176:179], v[64:67], v[40:43]
    v_mfma_f32_16x16x32_bf16 v[60:63], a[176:179], v[68:71], v[60:63]
    ds_read_b128 v[64:67], v13 offset:20480
    ds_read_b128 v[68:71], v13 offset:22528
    s_waitcnt lgkmcnt(2)
    v_mfma_f32_16x16x32_bf16 v[24:27], a[180:183], v[72:75], v[24:27]
    v_mfma_f32_16x16x32_bf16 v[44:47], a[180:183], v[76:79], v[44:47]
    v_mfma_f32_16x16x32_bf16 v[28:31], a[184:187], v[72:75], v[28:31]
    v_mfma_f32_16x16x32_bf16 v[48:51], a[184:187], v[76:79], v[48:51]
    v_mfma_f32_16x16x32_bf16 v[32:35], a[188:191], v[72:75], v[32:35]
    v_mfma_f32_16x16x32_bf16 v[52:55], a[188:191], v[76:79], v[52:55]
    v_mfma_f32_16x16x32_bf16 v[36:39], a[192:195], v[72:75], v[36:39]
    v_mfma_f32_16x16x32_bf16 v[56:59], a[192:195], v[76:79], v[56:59]
    v_mfma_f32_16x16x32_bf16 v[40:43], a[196:199], v[72:75], v[40:43]
    v_mfma_f32_16x16x32_bf16 v[60:63], a[196:199], v[76:79], v[60:63]
    ds_read_b128 v[72:75], v10 offset:20480
    ds_read_b128 v[76:79], v10 offset:22528
    s_waitcnt lgkmcnt(2)
    v_mfma_f32_16x16x32_bf16 v[24:27], a[200:203], v[64:67], v[24:27]
    v_mfma_f32_16x16x32_bf16 v[44:47], a[200:203], v[68:71], v[44:47]
    v_mfma_f32_16x16x32_bf16 v[28:31], a[204:207], v[64:67], v[28:31]
    v_mfma_f32_16x16x32_bf16 v[48:51], a[204:207], v[68:71], v[48:51]
    v_mfma_f32_16x16x32_bf16 v[32:35], a[208:211], v[64:67], v[32:35]
    v_mfma_f32_16x16x32_bf16 v[52:55], a[208:211], v[68:71], v[52:55]
    v_mfma_f32_16x16x32_bf16 v[36:39], a[212:215], v[64:67], v[36:39]
    v_mfma_f32_16x16x32_bf16 v[56:59], a[212:215], v[68:71], v[56:59]
    v_mfma_f32_16x16x32_bf16 v[40:43], a[216:219], v[64:67], v[40:43]
    v_mfma_f32_16x16x32_bf16 v[60:63], a[216:219], v[68:71], v[60:63]
    ds_read_b128 v[64:67], v13 offset:24576
    ds_read_b128 v[68:71], v13 offset:26624
    s_waitcnt lgkmcnt(2)
    v_mfma_f32_16x16x32_bf16 v[24:27], a[220:223], v[72:75], v[24:27]
    v_mfma_f32_16x16x32_bf16 v[44:47], a[220:223], v[76:79], v[44:47]
    v_mfma_f32_16x16x32_bf16 v[28:31], a[224:227], v[72:75], v[28:31]
    v_mfma_f32_16x16x32_bf16 v[48:51], a[224:227], v[76:79], v[48:51]
    v_mfma_f32_16x16x32_bf16 v[32:35], a[228:231], v[72:75], v[32:35]
    v_mfma_f32_16x16x32_bf16 v[52:55], a[228:231], v[76:79], v[52:55]
    v_mfma_f32_16x16x32_bf16 v[36:39], a[232:235], v[72:75], v[36:39]
    v_mfma_f32_16x16x32_bf16 v[56:59], a[232:235], v[76:79], v[56:59]
    v_mfma_f32_16x16x32_bf16 v[40:43], a[236:239], v[72:75], v[40:43]
    v_mfma_f32_16x16x32_bf16 v[60:63], a[236:239], v[76:79], v[60:63]
    ds_read_b128 v[72:75], v10 offset:24576
    ds_read_b128 v[76:79], v10 offset:26624
    s_waitcnt lgkmcnt(2)
    v_mfma_f32_16x16x32_bf16 v[24:27], a[240:243], v[64:67], v[24:27]
    v_mfma_f32_16x16x32_bf16 v[44:47], a[240:243], v[68:71], v[44:47]
    v_mfma_f32_16x16x32_bf16 v[28:31], a[244:247], v[64:67], v[28:31]
    v_mfma_f32_16x16x32_bf16 v[48:51], a[244:247], v[68:71], v[48:51]
    v_mfma_f32_16x16x32_bf16 v[32:35], a[248:251], v[64:67], v[32:35]
    v_mfma_f32_16x16x32_bf16 v[52:55], a[248:251], v[68:71], v[52:55]
    v_mfma_f32_16x16x32_bf16 v[36:39], a[252:255], v[64:67], v[36:39]
    v_mfma_f32_16x16x32_bf16 v[56:59], a[252:255], v[68:71], v[56:59]
    v_mfma_f32_16x16x32_bf16 v[40:43], v[112:115], v[64:67], v[40:43]
    v_mfma_f32_16x16x32_bf16 v[60:63], v[112:115], v[68:71], v[60:63]
    ds_read_b128 v[64:67], v13 offset:28672
    ds_read_b128 v[68:71], v13 offset:30720
    s_waitcnt lgkmcnt(2)
    v_mfma_f32_16x16x32_bf16 v[24:27], v[116:119], v[72:75], v[24:27]
    v_mfma_f32_16x16x32_bf16 v[44:47], v[116:119], v[76:79], v[44:47]
    v_mfma_f32_16x16x32_bf16 v[28:31], v[120:123], v[72:75], v[28:31]
    v_mfma_f32_16x16x32_bf16 v[48:51], v[120:123], v[76:79], v[48:51]
    v_mfma_f32_16x16x32_bf16 v[32:35], v[124:127], v[72:75], v[32:35]
    v_mfma_f32_16x16x32_bf16 v[52:55], v[124:127], v[76:79], v[52:55]
    v_mfma_f32_16x16x32_bf16 v[36:39], v[128:131], v[72:75], v[36:39]
    v_mfma_f32_16x16x32_bf16 v[56:59], v[128:131], v[76:79], v[56:59]
    v_mfma_f32_16x16x32_bf16 v[40:43], v[132:135], v[72:75], v[40:43]
    v_mfma_f32_16x16x32_bf16 v[60:63], v[132:135], v[76:79], v[60:63]
    ds_read_b128 v[72:75], v10 offset:28672
    ds_read_b128 v[76:79], v10 offset:30720
    s_waitcnt lgkmcnt(2)
    v_mfma_f32_16x16x32_bf16 v[24:27], v[136:139], v[64:67], v[24:27]
    v_mfma_f32_16x16x32_bf16 v[44:47], v[136:139], v[68:71], v[44:47]
    v_mfma_f32_16x16x32_bf16 v[28:31], v[140:143], v[64:67], v[28:31]
    v_mfma_f32_16x16x32_bf16 v[48:51], v[140:143], v[68:71], v[48:51]
    v_mfma_f32_16x16x32_bf16 v[32:35], v[144:147], v[64:67], v[32:35]
    v_mfma_f32_16x16x32_bf16 v[52:55], v[144:147], v[68:71], v[52:55]
    v_mfma_f32_16x16x32_bf16 v[36:39], v[148:151], v[64:67], v[36:39]
    v_mfma_f32_16x16x32_bf16 v[56:59], v[148:151], v[68:71], v[56:59]
    v_mfma_f32_16x16x32_bf16 v[40:43], v[152:155], v[64:67], v[40:43]
    v_mfma_f32_16x16x32_bf16 v[60:63], v[152:155], v[68:71], v[60:63]
    ds_read_b128 v[64:67], v13 offset:32768
    ds_read_b128 v[68:71], v13 offset:34816
    s_waitcnt lgkmcnt(2)
    v_mfma_f32_16x16x32_bf16 v[24:27], v[156:159], v[72:75], v[24:27]
    v_mfma_f32_16x16x32_bf16 v[44:47], v[156:159], v[76:79], v[44:47]
    v_mfma_f32_16x16x32_bf16 v[28:31], v[160:163], v[72:75], v[28:31]
    v_mfma_f32_16x16x32_bf16 v[48:51], v[160:163], v[76:79], v[48:51]
    v_mfma_f32_16x16x32_bf16 v[32:35], v[164:167], v[72:75], v[32:35]
    v_mfma_f32_16x16x32_bf16 v[52:55], v[164:167], v[76:79], v[52:55]
    v_mfma_f32_16x16x32_bf16 v[36:39], v[168:171], v[72:75], v[36:39]
    v_mfma_f32_16x16x32_bf16 v[56:59], v[168:171], v[76:79], v[56:59]
    v_mfma_f32_16x16x32_bf16 v[40:43], v[172:175], v[72:75], v[40:43]
    v_mfma_f32_16x16x32_bf16 v[60:63], v[172:175], v[76:79], v[60:63]
    ds_read_b128 v[72:75], v10 offset:32768
    ds_read_b128 v[76:79], v10 offset:34816
    s_waitcnt lgkmcnt(2)
    v_mfma_f32_16x16x32_bf16 v[24:27], v[176:179], v[64:67], v[24:27]
    v_mfma_f32_16x16x32_bf16 v[44:47], v[176:179], v[68:71], v[44:47]
    v_mfma_f32_16x16x32_bf16 v[28:31], v[180:183], v[64:67], v[28:31]
    v_mfma_f32_16x16x32_bf16 v[48:51], v[180:183], v[68:71], v[48:51]
    v_mfma_f32_16x16x32_bf16 v[32:35], v[184:187], v[64:67], v[32:35]
    v_mfma_f32_16x16x32_bf16 v[52:55], v[184:187], v[68:71], v[52:55]
    v_mfma_f32_16x16x32_bf16 v[36:39], v[188:191], v[64:67], v[36:39]
    v_mfma_f32_16x16x32_bf16 v[56:59], v[188:191], v[68:71], v[56:59]
    v_mfma_f32_16x16x32_bf16 v[40:43], v[192:195], v[64:67], v[40:43]
    v_mfma_f32_16x16x32_bf16 v[60:63], v[192:195], v[68:71], v[60:63]
    ds_read_b128 v[64:67], v13 offset:36864
    ds_read_b128 v[68:71], v13 offset:38912
    s_waitcnt lgkmcnt(2)
    v_mfma_f32_16x16x32_bf16 v[24:27], v[196:199], v[72:75], v[24:27]
    v_mfma_f32_16x16x32_bf16 v[44:47], v[196:199], v[76:79], v[44:47]
    v_mfma_f32_16x16x32_bf16 v[28:31], v[200:203], v[72:75], v[28:31]
    v_mfma_f32_16x16x32_bf16 v[48:51], v[200:203], v[76:79], v[48:51]
    v_mfma_f32_16x16x32_bf16 v[32:35], v[204:207], v[72:75], v[32:35]
    v_mfma_f32_16x16x32_bf16 v[52:55], v[204:207], v[76:79], v[52:55]
    v_mfma_f32_16x16x32_bf16 v[36:39], v[208:211], v[72:75], v[36:39]
    v_mfma_f32_16x16x32_bf16 v[56:59], v[208:211], v[76:79], v[56:59]
    v_mfma_f32_16x16x32_bf16 v[40:43], v[212:215], v[72:75], v[40:43]
    v_mfma_f32_16x16x32_bf16 v[60:63], v[212:215], v[76:79], v[60:63]
    ds_read_b128 v[72:75], v10 offset:36864
    ds_read_b128 v[76:79], v10 offset:38912
    s_waitcnt lgkmcnt(2)
    v_mfma_f32_16x16x32_bf16 v[24:27], v[216:219], v[64:67], v[24:27]
    v_mfma_f32_16x16x32_bf16 v[44:47], v[216:219], v[68:71], v[44:47]
    v_mfma_f32_16x16x32_bf16 v[28:31], v[220:223], v[64:67], v[28:31]
    v_mfma_f32_16x16x32_bf16 v[48:51], v[220:223], v[68:71], v[48:51]
    v_mfma_f32_16x16x32_bf16 v[32:35], v[224:227], v[64:67], v[32:35]
    v_mfma_f32_16x16x32_bf16 v[52:55], v[224:227], v[68:71], v[52:55]
    v_mfma_f32_16x16x32_bf16 v[36:39], v[228:231], v[64:67], v[36:39]
    v_mfma_f32_16x16x32_bf16 v[56:59], v[228:231], v[68:71], v[56:59]
    v_mfma_f32_16x16x32_bf16 v[40:43], v[232:235], v[64:67], v[40:43]
    v_mfma_f32_16x16x32_bf16 v[60:63], v[232:235], v[68:71], v[60:63]
    s_waitcnt lgkmcnt(0)
    v_mfma_f32_16x16x32_bf16 v[24:27], v[236:239], v[72:75], v[24:27]
    v_mfma_f32_16x16x32_bf16 v[44:47], v[236:239], v[76:79], v[44:47]
    v_mfma_f32_16x16x32_bf16 v[28:31], v[240:243], v[72:75], v[28:31]
    v_mfma_f32_16x16x32_bf16 v[48:51], v[240:243], v[76:79], v[48:51]
    v_mfma_f32_16x16x32_bf16 v[32:35], v[244:247], v[72:75], v[32:35]
    v_mfma_f32_16x16x32_bf16 v[52:55], v[244:247], v[76:79], v[52:55]
    v_mfma_f32_16x16x32_bf16 v[36:39], v[248:251], v[72:75], v[36:39]
    v_mfma_f32_16x16x32_bf16 v[56:59], v[248:251], v[76:79], v[56:59]
    v_mfma_f32_16x16x32_bf16 v[40:43], v[252:255], v[72:75], v[40:43]
    v_mfma_f32_16x16x32_bf16 v[60:63], v[252:255], v[76:79], v[60:63]
    s_cmp_eq_u32 s34, 2
    s_cbranch_scc1 L_B1_v
    s_mul_i32 s44, s54, 10240
    v_add_u32 v23, s44, v16
    s_lshl_b32 s55, s36, 4
    s_add_u32 s55, s55, s35
    s_mul_i32 s55, s55, 81920
    s_mul_i32 s44, s32, 5120
    s_add_u32 s55, s55, s44
    s_add_u32 s55, s55, 117440512
    v_cvt_pk_bf16_f32 v80, v24, v25
    v_cvt_pk_bf16_f32 v81, v26, v27
    v_cvt_pk_bf16_f32 v82, v28, v29
    v_cvt_pk_bf16_f32 v83, v30, v31
    v_cvt_pk_bf16_f32 v84, v32, v33
    v_cvt_pk_bf16_f32 v85, v34, v35
    v_cvt_pk_bf16_f32 v86, v36, v37
    v_cvt_pk_bf16_f32 v87, v38, v39
    v_cvt_pk_bf16_f32 v88, v40, v41
    v_cvt_pk_bf16_f32 v89, v42, v43
    v_mov_b32 v90, 0
    v_mov_b32 v91, 0
    ds_read_b128 v[64:67], v22 offset:0
    ds_read_b128 v[68:71], v22 offset:1024
    ds_read_b128 v[72:75], v22 offset:2048
    ds_read_b128 v[76:79], v22 offset:3072
    s_waitcnt lgkmcnt(3)
    v_mfma_f32_16x16x32_bf16 v[24:27], v[64:67], v[80:83], 0
    ds_read_b128 v[64:67], v22 offset:4096
    s_waitcnt lgkmcnt(3)
    v_mfma_f32_16x16x32_bf16 v[24:27], v[68:71], v[84:87], v[24:27]
    ds_read_b128 v[68:71], v22 offset:5120
    s_waitcnt lgkmcnt(3)
    v_mfma_f32_16x16x32_bf16 v[24:27], v[72:75], v[88:91], v[24:27]
    ds_read_b128 v[72:75], v22 offset:6144
    s_waitcnt lgkmcnt(3)
    v_mfma_f32_16x16x32_bf16 v[28:31], v[76:79], v[80:83], 0
    ds_read_b128 v[76:79], v22 offset:7168
    s_waitcnt lgkmcnt(3)
    v_mfma_f32_16x16x32_bf16 v[28:31], v[64:67], v[84:87], v[28:31]
    ds_read_b128 v[64:67], v22 offset:8192
    s_waitcnt lgkmcnt(3)
    v_mfma_f32_16x16x32_bf16 v[28:31], v[68:71], v[88:91], v[28:31]
    ds_read_b128 v[68:71], v22 offset:9216
    s_waitcnt lgkmcnt(3)
    v_mfma_f32_16x16x32_bf16 v[32:35], v[72:75], v[80:83], 0
    ds_read_b128 v[72:75], v22 offset:10240
    s_waitcnt lgkmcnt(3)
    v_mfma_f32_16x16x32_bf16 v[32:35], v[76:79], v[84:87], v[32:35]
    ds_read_b128 v[76:79], v22 offset:11264
    s_waitcnt lgkmcnt(3)
    v_mfma_f32_16x16x32_bf16 v[32:35], v[64:67], v[88:91], v[32:35]
    ds_read_b128 v[64:67], v22 offset:12288
    s_waitcnt lgkmcnt(3)
    v_mfma_f32_16x16x32_bf16 v[36:39], v[68:71], v[80:83], 0
    ds_read_b128 v[68:71], v22 offset:13312
    s_waitcnt lgkmcnt(3)
    v_mfma_f32_16x16x32_bf16 v[36:39], v[72:75], v[84:87], v[36:39]
    ds_read_b128 v[72:75], v22 offset:14336
    s_waitcnt lgkmcnt(3)
    v_mfma_f32_16x16x32_bf16 v[36:39], v[76:79], v[88:91], v[36:39]
    s_waitcnt lgkmcnt(2)
    v_mfma_f32_16x16x32_bf16 v[40:43], v[64:67], v[80:83], 0
    s_waitcnt lgkmcnt(1)
    v_mfma_f32_16x16x32_bf16 v[40:43], v[68:71], v[84:87], v[40:43]
    s_waitcnt lgkmcnt(0)
    v_mfma_f32_16x16x32_bf16 v[40:43], v[72:75], v[88:91], v[40:43]
    v_cvt_pk_bf16_f32 v2, v24, v25
    v_lshlrev_b32 v24, 16, v2
    v_and_b32 v25, 0xffff0000, v2
    v_cvt_pk_bf16_f32 v2, v26, v27
    v_lshlrev_b32 v26, 16, v2
    v_and_b32 v27, 0xffff0000, v2
    v_cvt_pk_bf16_f32 v2, v28, v29
    v_lshlrev_b32 v28, 16, v2
    v_and_b32 v29, 0xffff0000, v2
    v_cvt_pk_bf16_f32 v2, v30, v31
    v_lshlrev_b32 v30, 16, v2
    v_and_b32 v31, 0xffff0000, v2
    v_cvt_pk_bf16_f32 v2, v32, v33
    v_lshlrev_b32 v32, 16, v2
    v_and_b32 v33, 0xffff0000, v2
    v_cvt_pk_bf16_f32 v2, v34, v35
    v_lshlrev_b32 v34, 16, v2
    v_and_b32 v35, 0xffff0000, v2
    v_cvt_pk_bf16_f32 v2, v36, v37
    v_lshlrev_b32 v36, 16, v2
    v_and_b32 v37, 0xffff0000, v2
    v_cvt_pk_bf16_f32 v2, v38, v39
    v_lshlrev_b32 v38, 16, v2
    v_and_b32 v39, 0xffff0000, v2
    v_cvt_pk_bf16_f32 v2, v40, v41
    v_lshlrev_b32 v40, 16, v2
    v_and_b32 v41, 0xffff0000, v2
    v_cvt_pk_bf16_f32 v2, v42, v43
    v_lshlrev_b32 v42, 16, v2
    v_and_b32 v43, 0xffff0000, v2
    v_max3_f32 v4, v24, v25, v26
    v_min3_f32 v5, v24, v25, v26
    v_max3_f32 v4, v4, v27, v28
    v_min3_f32 v5, v5, v27, v28
    v_max3_f32 v4, v4, v29, v30
    v_min3_f32 v5, v5, v29, v30
    v_max3_f32 v4, v4, v31, v32
    v_min3_f32 v5, v5, v31, v32
    v_max3_f32 v4, v4, v33, v34
    v_min3_f32 v5, v5, v33, v34
    v_max3_f32 v4, v4, v35, v36
    v_min3_f32 v5, v5, v35, v36
    v_max3_f32 v4, v4, v37, v38
    v_min3_f32 v5, v5, v37, v38
    v_max3_f32 v4, v4, v39, v40
    v_min3_f32 v5, v5, v39, v40
    v_max3_f32 v4, v4, v41, v42
    v_min3_f32 v5, v5, v41, v42
    v_max_f32 v4, v4, v43
    v_min_f32 v5, v5, v43
    v_sub_f32 v92, v24, v4
    v_sub_f32 v24, v5, v24
    v_sub_f32 v93, v25, v4
    v_sub_f32 v25, v5, v25
    v_sub_f32 v94, v26, v4
    v_sub_f32 v26, v5, v26
    v_sub_f32 v95, v27, v4
    v_sub_f32 v27, v5, v27
    v_sub_f32 v96, v28, v4
    v_sub_f32 v28, v5, v28
    v_sub_f32 v97, v29, v4
    v_sub_f32 v29, v5, v29
    v_sub_f32 v98, v30, v4
    v_sub_f32 v30, v5, v30
    v_sub_f32 v99, v31, v4
    v_sub_f32 v31, v5, v31
    v_sub_f32 v100, v32, v4
    v_sub_f32 v32, v5, v32
    v_sub_f32 v101, v33, v4
    v_sub_f32 v33, v5, v33
    v_sub_f32 v102, v34, v4
    v_sub_f32 v34, v5, v34
    v_sub_f32 v103, v35, v4
    v_sub_f32 v35, v5, v35
    v_sub_f32 v104, v36, v4
    v_sub_f32 v36, v5, v36
    v_sub_f32 v105, v37, v4
    v_sub_f32 v37, v5, v37
    v_sub_f32 v106, v38, v4
    v_sub_f32 v38, v5, v38
    v_sub_f32 v107, v39, v4
    v_sub_f32 v39, v5, v39
    v_sub_f32 v108, v40, v4
    v_sub_f32 v40, v5, v40
    v_sub_f32 v109, v41, v4
    v_sub_f32 v41, v5, v41
    v_sub_f32 v110, v42, v4
    v_sub_f32 v42, v5, v42
    v_sub_f32 v111, v43, v4
    v_sub_f32 v43, v5, v43
    v_mul_f32 v92, s62, v92
    v_mul_f32 v24, s62, v24
    v_mul_f32 v93, s62, v93
    v_mul_f32 v25, s62, v25
    v_mul_f32 v94, s62, v94
    v_mul_f32 v26, s62, v26
    v_mul_f32 v95, s62, v95
    v_mul_f32 v27, s62, v27
    v_mul_f32 v96, s62, v96
    v_mul_f32 v28, s62, v28
    v_mul_f32 v97, s62, v97
    v_mul_f32 v29, s62, v29
    v_mul_f32 v98, s62, v98
    v_mul_f32 v30, s62, v30
    v_mul_f32 v99, s62, v99
    v_mul_f32 v31, s62, v31
    v_mul_f32 v100, s62, v100
    v_mul_f32 v32, s62, v32
    v_mul_f32 v101, s62, v101
    v_mul_f32 v33, s62, v33
    v_mul_f32 v102, s62, v102
    v_mul_f32 v34, s62, v34
    v_mul_f32 v103, s62, v103
    v_mul_f32 v35, s62, v35
    v_mul_f32 v104, s62, v104
    v_mul_f32 v36, s62, v36
    v_mul_f32 v105, s62, v105
    v_mul_f32 v37, s62, v37
    v_mul_f32 v106, s62, v106
    v_mul_f32 v38, s62, v38
    v_mul_f32 v107, s62, v107
    v_mul_f32 v39, s62, v39
    v_mul_f32 v108, s62, v108
    v_mul_f32 v40, s62, v40
    v_mul_f32 v109, s62, v109
    v_mul_f32 v41, s62, v41
    v_mul_f32 v110, s62, v110
    v_mul_f32 v42, s62, v42
    v_mul_f32 v111, s62, v111
    v_mul_f32 v43, s62, v43
    v_exp_f32 v92, v92
    v_exp_f32 v24, v24
    v_exp_f32 v93, v93
    v_exp_f32 v25, v25
    v_exp_f32 v94, v94
    v_exp_f32 v26, v26
    v_exp_f32 v95, v95
    v_exp_f32 v27, v27
    v_exp_f32 v96, v96
    v_exp_f32 v28, v28
    v_exp_f32 v97, v97
    v_exp_f32 v29, v29
    v_exp_f32 v98, v98
    v_exp_f32 v30, v30
    v_exp_f32 v99, v99
    v_exp_f32 v31, v31
    v_exp_f32 v100, v100
    v_exp_f32 v32, v32
    v_exp_f32 v101, v101
    v_exp_f32 v33, v33
    v_exp_f32 v102, v102
    v_exp_f32 v34, v34
    v_exp_f32 v103, v103
    v_exp_f32 v35, v35
    v_exp_f32 v104, v104
    v_exp_f32 v36, v36
    v_exp_f32 v105, v105
    v_exp_f32 v37, v37
    v_exp_f32 v106, v106
    v_exp_f32 v38, v38
    v_exp_f32 v107, v107
    v_exp_f32 v39, v39
    v_exp_f32 v108, v108
    v_exp_f32 v40, v40
    v_exp_f32 v109, v109
    v_exp_f32 v41, v41
    v_exp_f32 v110, v110
    v_exp_f32 v42, v42
    v_exp_f32 v111, v111
    v_exp_f32 v43, v43
    v_add_f32 v4, v92, v93
    v_add_f32 v5, v24, v25
    v_add_f32 v4, v4, v94
    v_add_f32 v5, v5, v26
    v_add_f32 v4, v4, v95
    v_add_f32 v5, v5, v27
    v_add_f32 v4, v4, v96
    v_add_f32 v5, v5, v28
    v_add_f32 v4, v4, v97
    v_add_f32 v5, v5, v29
    v_add_f32 v4, v4, v98
    v_add_f32 v5, v5, v30
    v_add_f32 v4, v4, v99
    v_add_f32 v5, v5, v31
    v_add_f32 v4, v4, v100
    v_add_f32 v5, v5, v32
    v_add_f32 v4, v4, v101
    v_add_f32 v5, v5, v33
    v_add_f32 v4, v4, v102
    v_add_f32 v5, v5, v34
    v_add_f32 v4, v4, v103
    v_add_f32 v5, v5, v35
    v_add_f32 v4, v4, v104
    v_add_f32 v5, v5, v36
    v_add_f32 v4, v4, v105
    v_add_f32 v5, v5, v37
    v_add_f32 v4, v4, v106
    v_add_f32 v5, v5, v38
    v_add_f32 v4, v4, v107
    v_add_f32 v5, v5, v39
    v_add_f32 v4, v4, v108
    v_add_f32 v5, v5, v40
    v_add_f32 v4, v4, v109
    v_add_f32 v5, v5, v41
    v_add_f32 v4, v4, v110
    v_add_f32 v5, v5, v42
    v_add_f32 v4, v4, v111
    v_add_f32 v5, v5, v43
    v_rcp_f32 v4, v4
    v_rcp_f32 v5, v5
    v_mul_f32 v92, v92, v4
    v_mul_f32 v24, v24, v5
    v_mul_f32 v93, v93, v4
    v_mul_f32 v25, v25, v5
    v_mul_f32 v94, v94, v4
    v_mul_f32 v26, v26, v5
    v_mul_f32 v95, v95, v4
    v_mul_f32 v27, v27, v5
    v_mul_f32 v96, v96, v4
    v_mul_f32 v28, v28, v5
    v_mul_f32 v97, v97, v4
    v_mul_f32 v29, v29, v5
    v_mul_f32 v98, v98, v4
    v_mul_f32 v30, v30, v5
    v_mul_f32 v99, v99, v4
    v_mul_f32 v31, v31, v5
    v_mul_f32 v100, v100, v4
    v_mul_f32 v32, v32, v5
    v_mul_f32 v101, v101, v4
    v_mul_f32 v33, v33, v5
    v_mul_f32 v102, v102, v4
    v_mul_f32 v34, v34, v5
    v_mul_f32 v103, v103, v4
    v_mul_f32 v35, v35, v5
    v_mul_f32 v104, v104, v4
    v_mul_f32 v36, v36, v5
    v_mul_f32 v105, v105, v4
    v_mul_f32 v37, v37, v5
    v_mul_f32 v106, v106, v4
    v_mul_f32 v38, v38, v5
    v_mul_f32 v107, v107, v4
    v_mul_f32 v39, v39, v5
    v_mul_f32 v108, v108, v4
    v_mul_f32 v40, v40, v5
    v_mul_f32 v109, v109, v4
    v_mul_f32 v41, v41, v5
    v_mul_f32 v110, v110, v4
    v_mul_f32 v42, v42, v5
    v_mul_f32 v111, v111, v4
    v_mul_f32 v43, v43, v5
    v_cvt_pk_bf16_f32 v92, v92, v93
    v_cvt_pk_bf16_f32 v93, v94, v95
    v_cvt_pk_bf16_f32 v94, v96, v97
    v_cvt_pk_bf16_f32 v95, v98, v99
    v_cvt_pk_bf16_f32 v96, v100, v101
    v_cvt_pk_bf16_f32 v97, v102, v103
    v_cvt_pk_bf16_f32 v98, v104, v105
    v_cvt_pk_bf16_f32 v99, v106, v107
    v_cvt_pk_bf16_f32 v100, v108, v109
    v_cvt_pk_bf16_f32 v101, v110, v111
    v_cvt_pk_bf16_f32 v102, v24, v25
    v_cvt_pk_bf16_f32 v103, v26, v27
    v_cvt_pk_bf16_f32 v104, v28, v29
    v_cvt_pk_bf16_f32 v105, v30, v31
    v_cvt_pk_bf16_f32 v106, v32, v33
    v_cvt_pk_bf16_f32 v107, v34, v35
    v_cvt_pk_bf16_f32 v108, v36, v37
    v_cvt_pk_bf16_f32 v109, v38, v39
    v_cvt_pk_bf16_f32 v110, v40, v41
    v_cvt_pk_bf16_f32 v111, v42, v43
    s_cmp_eq_u32 s34, 1
    s_cbranch_scc1 BK_116
    buffer_store_dwordx4 v[92:95], v18, s[8:11], s55 offen offset:0
    buffer_store_dwordx4 v[96:99], v18, s[8:11], s55 offen offset:256
    buffer_store_dwordx4 v[100:103], v18, s[8:11], s55 offen offset:512
    buffer_store_dwordx4 v[104:107], v18, s[8:11], s55 offen offset:768
    buffer_store_dwordx4 v[108:111], v18, s[8:11], s55 offen offset:1024
    s_add_u32 s55, s55, 40960
    s_branch BE_117
BK_116:
    ds_write_b128 v23, v[92:95] offset:0
    ds_write_b128 v23, v[96:99] offset:16
    ds_write_b128 v23, v[100:103] offset:32
    ds_write_b128 v23, v[104:107] offset:48
    ds_write_b128 v23, v[108:111] offset:64
    s_waitcnt lgkmcnt(0)
BE_117:
    s_nop 7
    s_nop 3
    v_cvt_pk_bf16_f32 v80, v44, v45
    v_cvt_pk_bf16_f32 v81, v46, v47
    v_cvt_pk_bf16_f32 v82, v48, v49
    v_cvt_pk_bf16_f32 v83, v50, v51
    v_cvt_pk_bf16_f32 v84, v52, v53
    v_cvt_pk_bf16_f32 v85, v54, v55
    v_cvt_pk_bf16_f32 v86, v56, v57
    v_cvt_pk_bf16_f32 v87, v58, v59
    v_cvt_pk_bf16_f32 v88, v60, v61
    v_cvt_pk_bf16_f32 v89, v62, v63
    v_mov_b32 v90, 0
    v_mov_b32 v91, 0
    ds_read_b128 v[64:67], v22 offset:0
    ds_read_b128 v[68:71], v22 offset:1024
    ds_read_b128 v[72:75], v22 offset:2048
    ds_read_b128 v[76:79], v22 offset:3072
    s_waitcnt lgkmcnt(3)
    v_mfma_f32_16x16x32_bf16 v[44:47], v[64:67], v[80:83], 0
    ds_read_b128 v[64:67], v22 offset:4096
    s_waitcnt lgkmcnt(3)
    v_mfma_f32_16x16x32_bf16 v[44:47], v[68:71], v[84:87], v[44:47]
    ds_read_b128 v[68:71], v22 offset:5120
    s_waitcnt lgkmcnt(3)
    v_mfma_f32_16x16x32_bf16 v[44:47], v[72:75], v[88:91], v[44:47]
    ds_read_b128 v[72:75], v22 offset:6144
    s_waitcnt lgkmcnt(3)
    v_mfma_f32_16x16x32_bf16 v[48:51], v[76:79], v[80:83], 0
    ds_read_b128 v[76:79], v22 offset:7168
    s_waitcnt lgkmcnt(3)
    v_mfma_f32_16x16x32_bf16 v[48:51], v[64:67], v[84:87], v[48:51]
    ds_read_b128 v[64:67], v22 offset:8192
    s_waitcnt lgkmcnt(3)
    v_mfma_f32_16x16x32_bf16 v[48:51], v[68:71], v[88:91], v[48:51]
    ds_read_b128 v[68:71], v22 offset:9216
    s_waitcnt lgkmcnt(3)
    v_mfma_f32_16x16x32_bf16 v[52:55], v[72:75], v[80:83], 0
    ds_read_b128 v[72:75], v22 offset:10240
    s_waitcnt lgkmcnt(3)
    v_mfma_f32_16x16x32_bf16 v[52:55], v[76:79], v[84:87], v[52:55]
    ds_read_b128 v[76:79], v22 offset:11264
    s_waitcnt lgkmcnt(3)
    v_mfma_f32_16x16x32_bf16 v[52:55], v[64:67], v[88:91], v[52:55]
    ds_read_b128 v[64:67], v22 offset:12288
    s_waitcnt lgkmcnt(3)
    v_mfma_f32_16x16x32_bf16 v[56:59], v[68:71], v[80:83], 0
    ds_read_b128 v[68:71], v22 offset:13312
    s_waitcnt lgkmcnt(3)
    v_mfma_f32_16x16x32_bf16 v[56:59], v[72:75], v[84:87], v[56:59]
    ds_read_b128 v[72:75], v22 offset:14336
    s_waitcnt lgkmcnt(3)
    v_mfma_f32_16x16x32_bf16 v[56:59], v[76:79], v[88:91], v[56:59]
    s_waitcnt lgkmcnt(2)
    v_mfma_f32_16x16x32_bf16 v[60:63], v[64:67], v[80:83], 0
    s_waitcnt lgkmcnt(1)
    v_mfma_f32_16x16x32_bf16 v[60:63], v[68:71], v[84:87], v[60:63]
    s_waitcnt lgkmcnt(0)
    v_mfma_f32_16x16x32_bf16 v[60:63], v[72:75], v[88:91], v[60:63]
    v_cvt_pk_bf16_f32 v2, v44, v45
    v_lshlrev_b32 v44, 16, v2
    v_and_b32 v45, 0xffff0000, v2
    v_cvt_pk_bf16_f32 v2, v46, v47
    v_lshlrev_b32 v46, 16, v2
    v_and_b32 v47, 0xffff0000, v2
    v_cvt_pk_bf16_f32 v2, v48, v49
    v_lshlrev_b32 v48, 16, v2
    v_and_b32 v49, 0xffff0000, v2
    v_cvt_pk_bf16_f32 v2, v50, v51
    v_lshlrev_b32 v50, 16, v2
    v_and_b32 v51, 0xffff0000, v2
    v_cvt_pk_bf16_f32 v2, v52, v53
    v_lshlrev_b32 v52, 16, v2
    v_and_b32 v53, 0xffff0000, v2
    v_cvt_pk_bf16_f32 v2, v54, v55
    v_lshlrev_b32 v54, 16, v2
    v_and_b32 v55, 0xffff0000, v2
    v_cvt_pk_bf16_f32 v2, v56, v57
    v_lshlrev_b32 v56, 16, v2
    v_and_b32 v57, 0xffff0000, v2
    v_cvt_pk_bf16_f32 v2, v58, v59
    v_lshlrev_b32 v58, 16, v2
    v_and_b32 v59, 0xffff0000, v2
    v_cvt_pk_bf16_f32 v2, v60, v61
    v_lshlrev_b32 v60, 16, v2
    v_and_b32 v61, 0xffff0000, v2
    v_cvt_pk_bf16_f32 v2, v62, v63
    v_lshlrev_b32 v62, 16, v2
    v_and_b32 v63, 0xffff0000, v2
    v_max3_f32 v4, v44, v45, v46
    v_min3_f32 v5, v44, v45, v46
    v_max3_f32 v4, v4, v47, v48
    v_min3_f32 v5, v5, v47, v48
    v_max3_f32 v4, v4, v49, v50
    v_min3_f32 v5, v5, v49, v50
    v_max3_f32 v4, v4, v51, v52
    v_min3_f32 v5, v5, v51, v52
    v_max3_f32 v4, v4, v53, v54
    v_min3_f32 v5, v5, v53, v54
    v_max3_f32 v4, v4, v55, v56
    v_min3_f32 v5, v5, v55, v56
    v_max3_f32 v4, v4, v57, v58
    v_min3_f32 v5, v5, v57, v58
    v_max3_f32 v4, v4, v59, v60
    v_min3_f32 v5, v5, v59, v60
    v_max3_f32 v4, v4, v61, v62
    v_min3_f32 v5, v5, v61, v62
    v_max_f32 v4, v4, v63
    v_min_f32 v5, v5, v63
    v_sub_f32 v92, v44, v4
    v_sub_f32 v44, v5, v44
    v_sub_f32 v93, v45, v4
    v_sub_f32 v45, v5, v45
    v_sub_f32 v94, v46, v4
    v_sub_f32 v46, v5, v46
    v_sub_f32 v95, v47, v4
    v_sub_f32 v47, v5, v47
    v_sub_f32 v96, v48, v4
    v_sub_f32 v48, v5, v48
    v_sub_f32 v97, v49, v4
    v_sub_f32 v49, v5, v49
    v_sub_f32 v98, v50, v4
    v_sub_f32 v50, v5, v50
    v_sub_f32 v99, v51, v4
    v_sub_f32 v51, v5, v51
    v_sub_f32 v100, v52, v4
    v_sub_f32 v52, v5, v52
    v_sub_f32 v101, v53, v4
    v_sub_f32 v53, v5, v53
    v_sub_f32 v102, v54, v4
    v_sub_f32 v54, v5, v54
    v_sub_f32 v103, v55, v4
    v_sub_f32 v55, v5, v55
    v_sub_f32 v104, v56, v4
    v_sub_f32 v56, v5, v56
    v_sub_f32 v105, v57, v4
    v_sub_f32 v57, v5, v57
    v_sub_f32 v106, v58, v4
    v_sub_f32 v58, v5, v58
    v_sub_f32 v107, v59, v4
    v_sub_f32 v59, v5, v59
    v_sub_f32 v108, v60, v4
    v_sub_f32 v60, v5, v60
    v_sub_f32 v109, v61, v4
    v_sub_f32 v61, v5, v61
    v_sub_f32 v110, v62, v4
    v_sub_f32 v62, v5, v62
    v_sub_f32 v111, v63, v4
    v_sub_f32 v63, v5, v63
    v_mul_f32 v92, s62, v92
    v_mul_f32 v44, s62, v44
    v_mul_f32 v93, s62, v93
    v_mul_f32 v45, s62, v45
    v_mul_f32 v94, s62, v94
    v_mul_f32 v46, s62, v46
    v_mul_f32 v95, s62, v95
    v_mul_f32 v47, s62, v47
    v_mul_f32 v96, s62, v96
    v_mul_f32 v48, s62, v48
    v_mul_f32 v97, s62, v97
    v_mul_f32 v49, s62, v49
    v_mul_f32 v98, s62, v98
    v_mul_f32 v50, s62, v50
    v_mul_f32 v99, s62, v99
    v_mul_f32 v51, s62, v51
    v_mul_f32 v100, s62, v100
    v_mul_f32 v52, s62, v52
    v_mul_f32 v101, s62, v101
    v_mul_f32 v53, s62, v53
    v_mul_f32 v102, s62, v102
    v_mul_f32 v54, s62, v54
    v_mul_f32 v103, s62, v103
    v_mul_f32 v55, s62, v55
    v_mul_f32 v104, s62, v104
    v_mul_f32 v56, s62, v56
    v_mul_f32 v105, s62, v105
    v_mul_f32 v57, s62, v57
    v_mul_f32 v106, s62, v106
    v_mul_f32 v58, s62, v58
    v_mul_f32 v107, s62, v107
    v_mul_f32 v59, s62, v59
    v_mul_f32 v108, s62, v108
    v_mul_f32 v60, s62, v60
    v_mul_f32 v109, s62, v109
    v_mul_f32 v61, s62, v61
    v_mul_f32 v110, s62, v110
    v_mul_f32 v62, s62, v62
    v_mul_f32 v111, s62, v111
    v_mul_f32 v63, s62, v63
    v_exp_f32 v92, v92
    v_exp_f32 v44, v44
    v_exp_f32 v93, v93
    v_exp_f32 v45, v45
    v_exp_f32 v94, v94
    v_exp_f32 v46, v46
    v_exp_f32 v95, v95
    v_exp_f32 v47, v47
    v_exp_f32 v96, v96
    v_exp_f32 v48, v48
    v_exp_f32 v97, v97
    v_exp_f32 v49, v49
    v_exp_f32 v98, v98
    v_exp_f32 v50, v50
    v_exp_f32 v99, v99
    v_exp_f32 v51, v51
    v_exp_f32 v100, v100
    v_exp_f32 v52, v52
    v_exp_f32 v101, v101
    v_exp_f32 v53, v53
    v_exp_f32 v102, v102
    v_exp_f32 v54, v54
    v_exp_f32 v103, v103
    v_exp_f32 v55, v55
    v_exp_f32 v104, v104
    v_exp_f32 v56, v56
    v_exp_f32 v105, v105
    v_exp_f32 v57, v57
    v_exp_f32 v106, v106
    v_exp_f32 v58, v58
    v_exp_f32 v107, v107
    v_exp_f32 v59, v59
    v_exp_f32 v108, v108
    v_exp_f32 v60, v60
    v_exp_f32 v109, v109
    v_exp_f32 v61, v61
    v_exp_f32 v110, v110
    v_exp_f32 v62, v62
    v_exp_f32 v111, v111
    v_exp_f32 v63, v63
    v_add_f32 v4, v92, v93
    v_add_f32 v5, v44, v45
    v_add_f32 v4, v4, v94
    v_add_f32 v5, v5, v46
    v_add_f32 v4, v4, v95
    v_add_f32 v5, v5, v47
    v_add_f32 v4, v4, v96
    v_add_f32 v5, v5, v48
    v_add_f32 v4, v4, v97
    v_add_f32 v5, v5, v49
    v_add_f32 v4, v4, v98
    v_add_f32 v5, v5, v50
    v_add_f32 v4, v4, v99
    v_add_f32 v5, v5, v51
    v_add_f32 v4, v4, v100
    v_add_f32 v5, v5, v52
    v_add_f32 v4, v4, v101
    v_add_f32 v5, v5, v53
    v_add_f32 v4, v4, v102
    v_add_f32 v5, v5, v54
    v_add_f32 v4, v4, v103
    v_add_f32 v5, v5, v55
    v_add_f32 v4, v4, v104
    v_add_f32 v5, v5, v56
    v_add_f32 v4, v4, v105
    v_add_f32 v5, v5, v57
    v_add_f32 v4, v4, v106
    v_add_f32 v5, v5, v58
    v_add_f32 v4, v4, v107
    v_add_f32 v5, v5, v59
    v_add_f32 v4, v4, v108
    v_add_f32 v5, v5, v60
    v_add_f32 v4, v4, v109
    v_add_f32 v5, v5, v61
    v_add_f32 v4, v4, v110
    v_add_f32 v5, v5, v62
    v_add_f32 v4, v4, v111
    v_add_f32 v5, v5, v63
    v_rcp_f32 v4, v4
    v_rcp_f32 v5, v5
    v_mul_f32 v92, v92, v4
    v_mul_f32 v44, v44, v5
    v_mul_f32 v93, v93, v4
    v_mul_f32 v45, v45, v5
    v_mul_f32 v94, v94, v4
    v_mul_f32 v46, v46, v5
    v_mul_f32 v95, v95, v4
    v_mul_f32 v47, v47, v5
    v_mul_f32 v96, v96, v4
    v_mul_f32 v48, v48, v5
    v_mul_f32 v97, v97, v4
    v_mul_f32 v49, v49, v5
    v_mul_f32 v98, v98, v4
    v_mul_f32 v50, v50, v5
    v_mul_f32 v99, v99, v4
    v_mul_f32 v51, v51, v5
    v_mul_f32 v100, v100, v4
    v_mul_f32 v52, v52, v5
    v_mul_f32 v101, v101, v4
    v_mul_f32 v53, v53, v5
    v_mul_f32 v102, v102, v4
    v_mul_f32 v54, v54, v5
    v_mul_f32 v103, v103, v4
    v_mul_f32 v55, v55, v5
    v_mul_f32 v104, v104, v4
    v_mul_f32 v56, v56, v5
    v_mul_f32 v105, v105, v4
    v_mul_f32 v57, v57, v5
    v_mul_f32 v106, v106, v4
    v_mul_f32 v58, v58, v5
    v_mul_f32 v107, v107, v4
    v_mul_f32 v59, v59, v5
    v_mul_f32 v108, v108, v4
    v_mul_f32 v60, v60, v5
    v_mul_f32 v109, v109, v4
    v_mul_f32 v61, v61, v5
    v_mul_f32 v110, v110, v4
    v_mul_f32 v62, v62, v5
    v_mul_f32 v111, v111, v4
    v_mul_f32 v63, v63, v5
    v_cvt_pk_bf16_f32 v92, v92, v93
    v_cvt_pk_bf16_f32 v93, v94, v95
    v_cvt_pk_bf16_f32 v94, v96, v97
    v_cvt_pk_bf16_f32 v95, v98, v99
    v_cvt_pk_bf16_f32 v96, v100, v101
    v_cvt_pk_bf16_f32 v97, v102, v103
    v_cvt_pk_bf16_f32 v98, v104, v105
    v_cvt_pk_bf16_f32 v99, v106, v107
    v_cvt_pk_bf16_f32 v100, v108, v109
    v_cvt_pk_bf16_f32 v101, v110, v111
    v_cvt_pk_bf16_f32 v102, v44, v45
    v_cvt_pk_bf16_f32 v103, v46, v47
    v_cvt_pk_bf16_f32 v104, v48, v49
    v_cvt_pk_bf16_f32 v105, v50, v51
    v_cvt_pk_bf16_f32 v106, v52, v53
    v_cvt_pk_bf16_f32 v107, v54, v55
    v_cvt_pk_bf16_f32 v108, v56, v57
    v_cvt_pk_bf16_f32 v109, v58, v59
    v_cvt_pk_bf16_f32 v110, v60, v61
    v_cvt_pk_bf16_f32 v111, v62, v63
    s_cmp_eq_u32 s34, 1
    s_cbranch_scc1 BK_118
    buffer_store_dwordx4 v[92:95], v18, s[8:11], s55 offen offset:0
    buffer_store_dwordx4 v[96:99], v18, s[8:11], s55 offen offset:256
    buffer_store_dwordx4 v[100:103], v18, s[8:11], s55 offen offset:512
    buffer_store_dwordx4 v[104:107], v18, s[8:11], s55 offen offset:768
    buffer_store_dwordx4 v[108:111], v18, s[8:11], s55 offen offset:1024
    s_add_u32 s55, s55, 40960
    s_branch BE_119
BK_118:
    ds_write_b128 v23, v[92:95] offset:5120
    ds_write_b128 v23, v[96:99] offset:5136
    ds_write_b128 v23, v[100:103] offset:5152
    ds_write_b128 v23, v[104:107] offset:5168
    ds_write_b128 v23, v[108:111] offset:5184
    s_waitcnt lgkmcnt(0)
BE_119:
    s_nop 7
    s_nop 3
    s_branch L_B1_next
L_B1_v:
    s_nop 7
    s_nop 3
    s_mul_i32 s44, s54, 6144
    v_add_u32 v23, s44, v17
    v_cvt_pk_bf16_f32 v92, v24, v25
    v_cvt_pk_bf16_f32 v93, v26, v27
    v_cvt_pk_bf16_f32 v94, v28, v29
    v_cvt_pk_bf16_f32 v95, v30, v31
    v_cvt_pk_bf16_f32 v96, v32, v33
    v_cvt_pk_bf16_f32 v97, v34, v35
    v_cvt_pk_bf16_f32 v98, v36, v37
    v_cvt_pk_bf16_f32 v99, v38, v39
    v_cvt_pk_bf16_f32 v100, v40, v41
    v_cvt_pk_bf16_f32 v101, v42, v43
    ds_write_b64 v23, v[92:93] offset:0
    ds_write_b64 v23, v[94:95] offset:8
    ds_write_b64 v23, v[96:97] offset:16
    ds_write_b64 v23, v[98:99] offset:24
    ds_write_b64 v23, v[100:101] offset:32
    v_cvt_pk_bf16_f32 v102, v44, v45
    v_cvt_pk_bf16_f32 v103, v46, v47
    v_cvt_pk_bf16_f32 v104, v48, v49
    v_cvt_pk_bf16_f32 v105, v50, v51
    v_cvt_pk_bf16_f32 v106, v52, v53
    v_cvt_pk_bf16_f32 v107, v54, v55
    v_cvt_pk_bf16_f32 v108, v56, v57
    v_cvt_pk_bf16_f32 v109, v58, v59
    v_cvt_pk_bf16_f32 v110, v60, v61
    v_cvt_pk_bf16_f32 v111, v62, v63
    ds_write_b64 v23, v[102:103] offset:3072
    ds_write_b64 v23, v[104:105] offset:3080
    ds_write_b64 v23, v[106:107] offset:3088
    ds_write_b64 v23, v[108:109] offset:3096
    ds_write_b64 v23, v[110:111] offset:3104
    s_branch L_B1_next
L_B1_kv:
    s_cmp_eq_u32 s35, 0
    s_cbranch_scc1 L_B1_next
    s_xor_b32 s54, s54, 1
    s_mul_i32 s44, s54, 10240
    v_add_u32 v2, s44, v19
    s_mul_i32 s44, s54, 6144
    v_add_u32 v3, s44, v20
    v_add_u32 v4, s44, v21
    ds_read_b64_tr_b16 v[24:25], v2 offset:0
    ds_read_b64_tr_b16 v[26:27], v2 offset:1280
    ds_read_b64_tr_b16 v[28:29], v2 offset:32
    ds_read_b64_tr_b16 v[30:31], v2 offset:1312
    ds_read_b64_tr_b16 v[32:33], v2 offset:64
    ds_read_b64_tr_b16 v[34:35], v2 offset:1344
    ds_read_b64_tr_b16 v[36:37], v3 offset:0
    ds_read_b64_tr_b16 v[38:39], v3 offset:768
    ds_read_b64_tr_b16 v[40:41], v4 offset:0
    ds_read_b64_tr_b16 v[42:43], v4 offset:768
    ds_read_b64_tr_b16 v[44:45], v2 offset:80
    ds_read_b64_tr_b16 v[46:47], v2 offset:1360
    ds_read_b64_tr_b16 v[48:49], v2 offset:112
    ds_read_b64_tr_b16 v[50:51], v2 offset:1392
    ds_read_b64_tr_b16 v[52:53], v2 offset:144
    ds_read_b64_tr_b16 v[54:55], v2 offset:1424
    ds_read_b64_tr_b16 v[56:57], v3 offset:48
    ds_read_b64_tr_b16 v[58:59], v3 offset:816
    ds_read_b64_tr_b16 v[60:61], v4 offset:48
    ds_read_b64_tr_b16 v[62:63], v4 offset:816
    ds_read_b64_tr_b16 v[64:65], v2 offset:160
    ds_read_b64_tr_b16 v[66:67], v2 offset:1440
    ds_read_b64_tr_b16 v[68:69], v2 offset:192
    ds_read_b64_tr_b16 v[70:71], v2 offset:1472
    ds_read_b64_tr_b16 v[72:73], v2 offset:224
    ds_read_b64_tr_b16 v[74:75], v2 offset:1504
    ds_read_b64_tr_b16 v[76:77], v3 offset:96
    ds_read_b64_tr_b16 v[78:79], v3 offset:864
    ds_read_b64_tr_b16 v[80:81], v4 offset:96
    ds_read_b64_tr_b16 v[82:83], v4 offset:864
    ds_read_b64_tr_b16 v[84:85], v2 offset:240
    ds_read_b64_tr_b16 v[86:87], v2 offset:1520
    ds_read_b64_tr_b16 v[88:89], v2 offset:272
    ds_read_b64_tr_b16 v[90:91], v2 offset:1552
    ds_read_b64_tr_b16 v[92:93], v2 offset:304
    ds_read_b64_tr_b16 v[94:95], v2 offset:1584
    ds_read_b64_tr_b16 v[96:97], v3 offset:144
    ds_read_b64_tr_b16 v[98:99], v3 offset:912
    ds_read_b64_tr_b16 v[100:101], v4 offset:144
    ds_read_b64_tr_b16 v[102:103], v4 offset:912
    s_waitcnt lgkmcnt(15)
    v_mfma_f32_16x16x32_bf16 v[112:115], v[24:27], v[36:39], v[112:115]
    v_mfma_f32_16x16x32_bf16 v[116:119], v[24:27], v[40:43], v[116:119]
    v_mfma_f32_16x16x32_bf16 v[120:123], v[28:31], v[36:39], v[120:123]
    v_mfma_f32_16x16x32_bf16 v[124:127], v[28:31], v[40:43], v[124:127]
    v_mfma_f32_16x16x32_bf16 v[128:131], v[32:35], v[36:39], v[128:131]
    v_mfma_f32_16x16x32_bf16 v[132:135], v[32:35], v[40:43], v[132:135]
    v_mfma_f32_16x16x32_bf16 v[136:139], v[44:47], v[56:59], v[136:139]
    v_mfma_f32_16x16x32_bf16 v[140:143], v[44:47], v[60:63], v[140:143]
    v_mfma_f32_16x16x32_bf16 v[144:147], v[48:51], v[56:59], v[144:147]
    v_mfma_f32_16x16x32_bf16 v[148:151], v[48:51], v[60:63], v[148:151]
    v_mfma_f32_16x16x32_bf16 v[152:155], v[52:55], v[56:59], v[152:155]
    v_mfma_f32_16x16x32_bf16 v[156:159], v[52:55], v[60:63], v[156:159]
    s_waitcnt lgkmcnt(10)
    v_mfma_f32_16x16x32_bf16 v[160:163], v[64:67], v[76:79], v[160:163]
    v_mfma_f32_16x16x32_bf16 v[164:167], v[64:67], v[80:83], v[164:167]
    v_mfma_f32_16x16x32_bf16 v[168:171], v[68:71], v[76:79], v[168:171]
    v_mfma_f32_16x16x32_bf16 v[172:175], v[68:71], v[80:83], v[172:175]
    v_mfma_f32_16x16x32_bf16 v[176:179], v[72:75], v[76:79], v[176:179]
    v_mfma_f32_16x16x32_bf16 v[180:183], v[72:75], v[80:83], v[180:183]
    s_waitcnt lgkmcnt(0)
    v_mfma_f32_16x16x32_bf16 v[184:187], v[84:87], v[96:99], v[184:187]
    v_mfma_f32_16x16x32_bf16 v[188:191], v[84:87], v[100:103], v[188:191]
    v_mfma_f32_16x16x32_bf16 v[192:195], v[88:91], v[96:99], v[192:195]
    v_mfma_f32_16x16x32_bf16 v[196:199], v[88:91], v[100:103], v[196:199]
    v_mfma_f32_16x16x32_bf16 v[200:203], v[92:95], v[96:99], v[200:203]
    v_mfma_f32_16x16x32_bf16 v[204:207], v[92:95], v[100:103], v[204:207]
L_B1_next:
    s_add_u32 s35, s35, 1
    s_cmp_le_u32 s35, 16
    s_cbranch_scc1 L_B1
    s_nop 7
    s_nop 3
    s_cmp_lg_u32 s34, 3
    s_cbranch_scc1 L_B2
    v_mul_u32_u24 v2, 192, v14
    v_lshl_add_u32 v2, v15, 4, v2
    s_lshl_b32 s44, s36, 5
    s_lshl_b32 s45, s32, 2
    s_add_u32 s44, s44, s45
    s_mul_i32 s44, s44, 6144
    s_add_u32 s44, s44, 130023424
    buffer_store_dwordx4 v[112:115], v2, s[8:11], s44 offen offset:0 sc1
    buffer_store_dwordx4 v[120:123], v2, s[8:11], s44 offen offset:64 sc1
    buffer_store_dwordx4 v[128:131], v2, s[8:11], s44 offen offset:128 sc1
    s_add_u32 s44, s44, 3072
    buffer_store_dwordx4 v[116:119], v2, s[8:11], s44 offen offset:0 sc1
    buffer_store_dwordx4 v[124:127], v2, s[8:11], s44 offen offset:64 sc1
    buffer_store_dwordx4 v[132:135], v2, s[8:11], s44 offen offset:128 sc1
    s_add_u32 s44, s44, 3072
    buffer_store_dwordx4 v[136:139], v2, s[8:11], s44 offen offset:0 sc1
    buffer_store_dwordx4 v[144:147], v2, s[8:11], s44 offen offset:64 sc1
    buffer_store_dwordx4 v[152:155], v2, s[8:11], s44 offen offset:128 sc1
    s_add_u32 s44, s44, 3072
    buffer_store_dwordx4 v[140:143], v2, s[8:11], s44 offen offset:0 sc1
    buffer_store_dwordx4 v[148:151], v2, s[8:11], s44 offen offset:64 sc1
    buffer_store_dwordx4 v[156:159], v2, s[8:11], s44 offen offset:128 sc1
    s_add_u32 s44, s44, 3072
    buffer_store_dwordx4 v[160:163], v2, s[8:11], s44 offen offset:0 sc1
    buffer_store_dwordx4 v[168:171], v2, s[8:11], s44 offen offset:64 sc1
    buffer_store_dwordx4 v[176:179], v2, s[8:11], s44 offen offset:128 sc1
    s_add_u32 s44, s44, 3072
    buffer_store_dwordx4 v[164:167], v2, s[8:11], s44 offen offset:0 sc1
    buffer_store_dwordx4 v[172:175], v2, s[8:11], s44 offen offset:64 sc1
    buffer_store_dwordx4 v[180:183], v2, s[8:11], s44 offen offset:128 sc1
    s_add_u32 s44, s44, 3072
    buffer_store_dwordx4 v[184:187], v2, s[8:11], s44 offen offset:0 sc1
    buffer_store_dwordx4 v[192:195], v2, s[8:11], s44 offen offset:64 sc1
    buffer_store_dwordx4 v[200:203], v2, s[8:11], s44 offen offset:128 sc1
    s_add_u32 s44, s44, 3072
    buffer_store_dwordx4 v[188:191], v2, s[8:11], s44 offen offset:0 sc1
    buffer_store_dwordx4 v[196:199], v2, s[8:11], s44 offen offset:64 sc1
    buffer_store_dwordx4 v[204:207], v2, s[8:11], s44 offen offset:128 sc1
    s_add_u32 s44, s44, 3072
L_B2:
    s_waitcnt vmcnt(0)
    s_barrier
    s_mov_b32 s35, 0
    s_cmp_lg_u32 s34, 0
    s_cbranch_scc1 SF_120
    s_add_u32 s44, s35, 1
    v_mov_b32 v2, s44
    v_mov_b32 v3, 0
    s_mov_b64 exec, 1
    buffer_store_dword v2, v3, s[8:11], s60 offen sc1
    s_mov_b64 exec, -1
SF_120:
    v_and_b32 v3, 3, v1
    v_lshlrev_b32 v23, 10, v3
    s_lshl_b32 s59, s32, 7
    s_add_u32 s59, s59, 15032320
    s_mov_b32 s58, 1
    s_mov_b32 s42, 0
    s_mov_b64 exec, 0xff
WF_121:
    buffer_load_dword v2, v23, s[8:11], s59 offen sc1
    s_waitcnt vmcnt(0)
    v_cmp_gt_u32 vcc, s58, v2
    s_cbranch_vccz WFO_122
    s_sleep 1
    s_add_u32 s42, s42, 1
    s_cmp_lt_u32 s42, s37
    s_cbranch_scc1 WF_121
    s_mov_b32 s37, 1
WFO_122:
    s_mov_b64 exec, -1
    v_mul_u32_u24 v16, 192, v14
    v_lshl_add_u32 v16, v15, 5, v16
    v_lshrrev_b32 v2, 2, v14
    v_add_u32 v2, 16, v2
    v_and_b32 v3, 3, v1
    v_cmp_eq_u32 vcc, 0, v3
    v_mov_b32 v4, 20
    s_nop 0
    v_cndmask_b32 v2, v4, v2, vcc
    v_mul_u32_u24 v17, 192, v2
    v_lshl_add_u32 v17, v15, 5, v17
    s_lshl_b32 s44, s32, 2
    s_add_u32 s44, s44, s34
    s_mul_i32 s44, s44, 6144
    s_add_u32 s44, s44, 130023424
    v_mov_b32 v112, 0
    v_mov_b32 v113, 0
    v_mov_b32 v114, 0
    v_mov_b32 v115, 0
    v_mov_b32 v116, 0
    v_mov_b32 v117, 0
    v_mov_b32 v118, 0
    v_mov_b32 v119, 0
    v_mov_b32 v120, 0
    v_mov_b32 v121, 0
    v_mov_b32 v122, 0
    v_mov_b32 v123, 0
    v_mov_b32 v124, 0
    v_mov_b32 v125, 0
    v_mov_b32 v126, 0
    v_mov_b32 v127, 0
    v_mov_b32 v128, 0
    v_mov_b32 v129, 0
    v_mov_b32 v130, 0
    v_mov_b32 v131, 0
    v_mov_b32 v132, 0
    v_mov_b32 v133, 0
    v_mov_b32 v134, 0
    v_mov_b32 v135, 0
    v_mov_b32 v136, 0
    v_mov_b32 v137, 0
    v_mov_b32 v138, 0
    v_mov_b32 v139, 0
    v_mov_b32 v140, 0
    v_mov_b32 v141, 0
    v_mov_b32 v142, 0
    v_mov_b32 v143, 0
    v_mov_b32 v144, 0
    v_mov_b32 v145, 0
    v_mov_b32 v146, 0
    v_mov_b32 v147, 0
    v_mov_b32 v148, 0
    v_mov_b32 v149, 0
    v_mov_b32 v150, 0
    v_mov_b32 v151, 0
    v_mov_b32 v152, 0
    v_mov_b32 v153, 0
    v_mov_b32 v154, 0
    v_mov_b32 v155, 0
    v_mov_b32 v156, 0
    v_mov_b32 v157, 0
    v_mov_b32 v158, 0
    v_mov_b32 v159, 0
    v_mov_b32 v160, 0
    v_mov_b32 v161, 0
    v_mov_b32 v162, 0
    v_mov_b32 v163, 0
    v_mov_b32 v164, 0
    v_mov_b32 v165, 0
    v_mov_b32 v166, 0
    v_mov_b32 v167, 0
    v_mov_b32 v168, 0
    v_mov_b32 v169, 0
    v_mov_b32 v170, 0
    v_mov_b32 v171, 0
    v_mov_b32 v172, 0
    v_mov_b32 v173, 0
    v_mov_b32 v174, 0
    v_mov_b32 v175, 0
    v_mov_b32 v176, 0
    v_mov_b32 v177, 0
    v_mov_b32 v178, 0
    v_mov_b32 v179, 0
    v_mov_b32 v180, 0
    v_mov_b32 v181, 0
    v_mov_b32 v182, 0
    v_mov_b32 v183, 0
    v_mov_b32 v184, 0
    v_mov_b32 v185, 0
    v_mov_b32 v186, 0
    v_mov_b32 v187, 0
    v_mov_b32 v188, 0
    v_mov_b32 v189, 0
    v_mov_b32 v190, 0
    v_mov_b32 v191, 0
    v_mov_b32 v192, 0
    v_mov_b32 v193, 0
    v_mov_b32 v194, 0
    v_mov_b32 v195, 0
    v_mov_b32 v196, 0
    v_mov_b32 v197, 0
    v_mov_b32 v198, 0
    v_mov_b32 v199, 0
    v_mov_b32 v200, 0
    v_mov_b32 v201, 0
    v_mov_b32 v202, 0
    v_mov_b32 v203, 0
    v_mov_b32 v204, 0
    v_mov_b32 v205, 0
    v_mov_b32 v206, 0
    v_mov_b32 v207, 0
    v_mov_b32 v208, 0
    v_mov_b32 v209, 0
    v_mov_b32 v210, 0
    v_mov_b32 v211, 0
    v_mov_b32 v212, 0
    v_mov_b32 v213, 0
    v_mov_b32 v214, 0
    v_mov_b32 v215, 0
    v_mov_b32 v216, 0
    v_mov_b32 v217, 0
    v_mov_b32 v218, 0
    v_mov_b32 v219, 0
    v_mov_b32 v220, 0
    v_mov_b32 v221, 0
    v_mov_b32 v222, 0
    v_mov_b32 v223, 0
    v_mov_b32 v224, 0
    v_mov_b32 v225, 0
    v_mov_b32 v226, 0
    v_mov_b32 v227, 0
    v_mov_b32 v228, 0
    v_mov_b32 v229, 0
    v_mov_b32 v230, 0
    v_mov_b32 v231, 0
    v_mov_b32 v232, 0
    v_mov_b32 v233, 0
    v_mov_b32 v234, 0
    v_mov_b32 v235, 0
    v_mov_b32 v236, 0
    v_mov_b32 v237, 0
    v_mov_b32 v238, 0
    v_mov_b32 v239, 0
    buffer_load_dwordx4 v[112:115], v16, s[8:11], s44 offen offset:0 sc1
    buffer_load_dwordx4 v[116:119], v16, s[8:11], s44 offen offset:16 sc1
    s_mov_b64 exec, 0xffff
    buffer_load_dwordx4 v[120:123], v16, s[8:11], s44 offen offset:128 sc1
    buffer_load_dwordx4 v[124:127], v16, s[8:11], s44 offen offset:144 sc1
    s_mov_b64 exec, -1
    buffer_load_dwordx4 v[128:131], v17, s[8:11], s44 offen offset:0 sc1
    buffer_load_dwordx4 v[132:135], v17, s[8:11], s44 offen offset:16 sc1
    s_mov_b64 exec, 0xffff
    buffer_load_dwordx4 v[136:139], v17, s[8:11], s44 offen offset:128 sc1
    buffer_load_dwordx4 v[140:143], v17, s[8:11], s44 offen offset:144 sc1
    s_mov_b64 exec, -1
    s_add_u32 s44, s44, 196608
    buffer_load_dwordx4 v[144:147], v16, s[8:11], s44 offen offset:0 sc1
    buffer_load_dwordx4 v[148:151], v16, s[8:11], s44 offen offset:16 sc1
    s_mov_b64 exec, 0xffff
    buffer_load_dwordx4 v[152:155], v16, s[8:11], s44 offen offset:128 sc1
    buffer_load_dwordx4 v[156:159], v16, s[8:11], s44 offen offset:144 sc1
    s_mov_b64 exec, -1
    buffer_load_dwordx4 v[160:163], v17, s[8:11], s44 offen offset:0 sc1
    buffer_load_dwordx4 v[164:167], v17, s[8:11], s44 offen offset:16 sc1
    s_mov_b64 exec, 0xffff
    buffer_load_dwordx4 v[168:171], v17, s[8:11], s44 offen offset:128 sc1
    buffer_load_dwordx4 v[172:175], v17, s[8:11], s44 offen offset:144 sc1
    s_mov_b64 exec, -1
    s_add_u32 s44, s44, 196608
    buffer_load_dwordx4 v[176:179], v16, s[8:11], s44 offen offset:0 sc1
    buffer_load_dwordx4 v[180:183], v16, s[8:11], s44 offen offset:16 sc1
    s_mov_b64 exec, 0xffff
    buffer_load_dwordx4 v[184:187], v16, s[8:11], s44 offen offset:128 sc1
    buffer_load_dwordx4 v[188:191], v16, s[8:11], s44 offen offset:144 sc1
    s_mov_b64 exec, -1
    buffer_load_dwordx4 v[192:195], v17, s[8:11], s44 offen offset:0 sc1
    buffer_load_dwordx4 v[196:199], v17, s[8:11], s44 offen offset:16 sc1
    s_mov_b64 exec, 0xffff
    buffer_load_dwordx4 v[200:203], v17, s[8:11], s44 offen offset:128 sc1
    buffer_load_dwordx4 v[204:207], v17, s[8:11], s44 offen offset:144 sc1
    s_mov_b64 exec, -1
    s_add_u32 s44, s44, 196608
    buffer_load_dwordx4 v[208:211], v16, s[8:11], s44 offen offset:0 sc1
    buffer_load_dwordx4 v[212:215], v16, s[8:11], s44 offen offset:16 sc1
    s_mov_b64 exec, 0xffff
    buffer_load_dwordx4 v[216:219], v16, s[8:11], s44 offen offset:128 sc1
    buffer_load_dwordx4 v[220:223], v16, s[8:11], s44 offen offset:144 sc1
    s_mov_b64 exec, -1
    buffer_load_dwordx4 v[224:227], v17, s[8:11], s44 offen offset:0 sc1
    buffer_load_dwordx4 v[228:231], v17, s[8:11], s44 offen offset:16 sc1
    s_mov_b64 exec, 0xffff
    buffer_load_dwordx4 v[232:235], v17, s[8:11], s44 offen offset:128 sc1
    buffer_load_dwordx4 v[236:239], v17, s[8:11], s44 offen offset:144 sc1
    s_mov_b64 exec, -1
    s_add_u32 s44, s44, 196608
    s_waitcnt vmcnt(0)
    v_add_f32 v112, v112, v144
    v_add_f32 v176, v176, v208
    v_add_f32 v113, v113, v145
    v_add_f32 v177, v177, v209
    v_add_f32 v114, v114, v146
    v_add_f32 v178, v178, v210
    v_add_f32 v115, v115, v147
    v_add_f32 v179, v179, v211
    v_add_f32 v116, v116, v148
    v_add_f32 v180, v180, v212
    v_add_f32 v117, v117, v149
    v_add_f32 v181, v181, v213
    v_add_f32 v118, v118, v150
    v_add_f32 v182, v182, v214
    v_add_f32 v119, v119, v151
    v_add_f32 v183, v183, v215
    v_add_f32 v120, v120, v152
    v_add_f32 v184, v184, v216
    v_add_f32 v121, v121, v153
    v_add_f32 v185, v185, v217
    v_add_f32 v122, v122, v154
    v_add_f32 v186, v186, v218
    v_add_f32 v123, v123, v155
    v_add_f32 v187, v187, v219
    v_add_f32 v124, v124, v156
    v_add_f32 v188, v188, v220
    v_add_f32 v125, v125, v157
    v_add_f32 v189, v189, v221
    v_add_f32 v126, v126, v158
    v_add_f32 v190, v190, v222
    v_add_f32 v127, v127, v159
    v_add_f32 v191, v191, v223
    v_add_f32 v128, v128, v160
    v_add_f32 v192, v192, v224
    v_add_f32 v129, v129, v161
    v_add_f32 v193, v193, v225
    v_add_f32 v130, v130, v162
    v_add_f32 v194, v194, v226
    v_add_f32 v131, v131, v163
    v_add_f32 v195, v195, v227
    v_add_f32 v132, v132, v164
    v_add_f32 v196, v196, v228
    v_add_f32 v133, v133, v165
    v_add_f32 v197, v197, v229
    v_add_f32 v134, v134, v166
    v_add_f32 v198, v198, v230
    v_add_f32 v135, v135, v167
    v_add_f32 v199, v199, v231
    v_add_f32 v136, v136, v168
    v_add_f32 v200, v200, v232
    v_add_f32 v137, v137, v169
    v_add_f32 v201, v201, v233
    v_add_f32 v138, v138, v170
    v_add_f32 v202, v202, v234
    v_add_f32 v139, v139, v171
    v_add_f32 v203, v203, v235
    v_add_f32 v140, v140, v172
    v_add_f32 v204, v204, v236
    v_add_f32 v141, v141, v173
    v_add_f32 v205, v205, v237
    v_add_f32 v142, v142, v174
    v_add_f32 v206, v206, v238
    v_add_f32 v143, v143, v175
    v_add_f32 v207, v207, v239
    v_add_f32 v112, v112, v176
    v_add_f32 v113, v113, v177
    v_add_f32 v114, v114, v178
    v_add_f32 v115, v115, v179
    v_add_f32 v116, v116, v180
    v_add_f32 v117, v117, v181
    v_add_f32 v118, v118, v182
    v_add_f32 v119, v119, v183
    v_add_f32 v120, v120, v184
    v_add_f32 v121, v121, v185
    v_add_f32 v122, v122, v186
    v_add_f32 v123, v123, v187
    v_add_f32 v124, v124, v188
    v_add_f32 v125, v125, v189
    v_add_f32 v126, v126, v190
    v_add_f32 v127, v127, v191
    v_add_f32 v128, v128, v192
    v_add_f32 v129, v129, v193
    v_add_f32 v130, v130, v194
    v_add_f32 v131, v131, v195
    v_add_f32 v132, v132, v196
    v_add_f32 v133, v133, v197
    v_add_f32 v134, v134, v198
    v_add_f32 v135, v135, v199
    v_add_f32 v136, v136, v200
    v_add_f32 v137, v137, v201
    v_add_f32 v138, v138, v202
    v_add_f32 v139, v139, v203
    v_add_f32 v140, v140, v204
    v_add_f32 v141, v141, v205
    v_add_f32 v142, v142, v206
    v_add_f32 v143, v143, v207
    v_cvt_pk_bf16_f32 v24, v112, v113
    v_cvt_pk_bf16_f32 v25, v114, v115
    v_cvt_pk_bf16_f32 v26, v116, v117
    v_cvt_pk_bf16_f32 v27, v118, v119
    v_cvt_pk_bf16_f32 v28, v120, v121
    v_cvt_pk_bf16_f32 v29, v122, v123
    v_cvt_pk_bf16_f32 v30, v124, v125
    v_cvt_pk_bf16_f32 v31, v126, v127
    v_cvt_pk_bf16_f32 v32, v128, v129
    v_cvt_pk_bf16_f32 v33, v130, v131
    v_cvt_pk_bf16_f32 v34, v132, v133
    v_cvt_pk_bf16_f32 v35, v134, v135
    v_cvt_pk_bf16_f32 v36, v136, v137
    v_cvt_pk_bf16_f32 v37, v138, v139
    v_cvt_pk_bf16_f32 v38, v140, v141
    v_cvt_pk_bf16_f32 v39, v142, v143
    v_mul_u32_u24 v2, 160, v14
    s_mul_i32 s44, s34, 40
    v_add_u32 v2, s44, v2
    v_lshl_add_u32 v19, v15, 3, v2
    v_lshl_add_u32 v20, v15, 1, v2
    s_mul_i32 s44, s34, 5120
    v_add_u32 v21, s44, v12
    s_lshl_b32 s44, s32, 2
    s_add_u32 s44, s44, s34
    s_mul_i32 s52, s44, 1280
    s_mul_i32 s44, s36, 1310720
    s_add_u32 s52, s52, s44
    s_add_u32 s52, s52, 117440512
    s_mul_i32 s53, s36, 655360
    s_mul_i32 s44, s32, 160
    s_add_u32 s53, s53, s44
    s_mul_i32 s44, s34, 40960
    s_add_u32 s53, s53, s44
    s_add_u32 s53, s53, 125829120
    s_mov_b32 s57, 0x358637bd
    s_mov_b32 s35, 0
    v_add_u32 v2, 0, v1
    v_mul_u32_u24 v3, 6554, v2
    v_lshrrev_b32 v3, 16, v3
    v_mul_u32_u24 v4, 10, v3
    v_sub_u32 v4, v2, v4
    v_mul_u32_u24 v3, 1280, v3
    v_lshl_add_u32 v104, v4, 4, v3
    v_add_u32 v2, 64, v1
    v_mul_u32_u24 v3, 6554, v2
    v_lshrrev_b32 v3, 16, v3
    v_mul_u32_u24 v4, 10, v3
    v_sub_u32 v4, v2, v4
    v_mul_u32_u24 v3, 1280, v3
    v_lshl_add_u32 v105, v4, 4, v3
    v_add_u32 v2, 128, v1
    v_mul_u32_u24 v3, 6554, v2
    v_lshrrev_b32 v3, 16, v3
    v_mul_u32_u24 v4, 10, v3
    v_sub_u32 v4, v2, v4
    v_mul_u32_u24 v3, 1280, v3
    v_lshl_add_u32 v106, v4, 4, v3
    v_add_u32 v2, 192, v1
    v_mul_u32_u24 v3, 6554, v2
    v_lshrrev_b32 v3, 16, v3
    v_mul_u32_u24 v4, 10, v3
    v_sub_u32 v4, v2, v4
    v_mul_u32_u24 v3, 1280, v3
    v_lshl_add_u32 v107, v4, 4, v3
    v_add_u32 v2, 256, v1
    v_mul_u32_u24 v3, 6554, v2
    v_lshrrev_b32 v3, 16, v3
    v_mul_u32_u24 v4, 10, v3
    v_sub_u32 v4, v2, v4
    v_mul_u32_u24 v3, 1280, v3
    v_lshl_add_u32 v108, v4, 4, v3
    v_mov_b32 v112, 0
    v_mov_b32 v113, 0
    v_mov_b32 v114, 0
    v_mov_b32 v115, 0
    v_mov_b32 v116, 0
    v_mov_b32 v117, 0
    v_mov_b32 v118, 0
    v_mov_b32 v119, 0
    v_mov_b32 v120, 0
    v_mov_b32 v121, 0
    v_mov_b32 v122, 0
    v_mov_b32 v123, 0
    v_mov_b32 v124, 0
    v_mov_b32 v125, 0
    v_mov_b32 v126, 0
    v_mov_b32 v127, 0
    v_mov_b32 v128, 0
    v_mov_b32 v129, 0
    v_mov_b32 v130, 0
    v_mov_b32 v131, 0
    v_mov_b32 v132, 0
    v_mov_b32 v133, 0
    v_mov_b32 v134, 0
    v_mov_b32 v135, 0
    v_mov_b32 v136, 0
    v_mov_b32 v137, 0
    v_mov_b32 v138, 0
    v_mov_b32 v139, 0
    v_mov_b32 v140, 0
    v_mov_b32 v141, 0
    v_mov_b32 v142, 0
    v_mov_b32 v143, 0
    v_mov_b32 v144, 0
    v_mov_b32 v145, 0
    v_mov_b32 v146, 0
    v_mov_b32 v147, 0
    v_mov_b32 v148, 0
    v_mov_b32 v149, 0
    v_mov_b32 v150, 0
    v_mov_b32 v151, 0
    v_mov_b32 v152, 0
    v_mov_b32 v153, 0
    v_mov_b32 v154, 0
    v_mov_b32 v155, 0
    v_mov_b32 v156, 0
    v_mov_b32 v157, 0
    v_mov_b32 v158, 0
    v_mov_b32 v159, 0
    v_mov_b32 v160, 0
    v_mov_b32 v161, 0
    v_mov_b32 v162, 0
    v_mov_b32 v163, 0
    v_mov_b32 v164, 0
    v_mov_b32 v165, 0
    v_mov_b32 v166, 0
    v_mov_b32 v167, 0
    v_mov_b32 v168, 0
    v_mov_b32 v169, 0
    v_mov_b32 v170, 0
    v_mov_b32 v171, 0
    v_mov_b32 v172, 0
    v_mov_b32 v173, 0
    v_mov_b32 v174, 0
    v_mov_b32 v175, 0
L_B3:
    buffer_load_dwordx4 v[112:115], v12, s[8:11], s52 offen sc1
    s_mov_b64 exec, 0xffff
    buffer_load_dwordx4 v[116:119], v12, s[8:11], s52 offen offset:1024 sc1
    s_mov_b64 exec, -1
    s_add_u32 s52, s52, 40960
    buffer_load_dwordx4 v[120:123], v12, s[8:11], s52 offen sc1
    s_mov_b64 exec, 0xffff
    buffer_load_dwordx4 v[124:127], v12, s[8:11], s52 offen offset:1024 sc1
    s_mov_b64 exec, -1
    s_add_u32 s52, s52, 40960
    buffer_load_dwordx4 v[128:131], v12, s[8:11], s52 offen sc1
    s_mov_b64 exec, 0xffff
    buffer_load_dwordx4 v[132:135], v12, s[8:11], s52 offen offset:1024 sc1
    s_mov_b64 exec, -1
    s_add_u32 s52, s52, 40960
    buffer_load_dwordx4 v[136:139], v12, s[8:11], s52 offen sc1
    s_mov_b64 exec, 0xffff
    buffer_load_dwordx4 v[140:143], v12, s[8:11], s52 offen offset:1024 sc1
    s_mov_b64 exec, -1
    s_add_u32 s52, s52, 40960
    buffer_load_dwordx4 v[144:147], v12, s[8:11], s52 offen sc1
    s_mov_b64 exec, 0xffff
    buffer_load_dwordx4 v[148:151], v12, s[8:11], s52 offen offset:1024 sc1
    s_mov_b64 exec, -1
    s_add_u32 s52, s52, 40960
    buffer_load_dwordx4 v[152:155], v12, s[8:11], s52 offen sc1
    s_mov_b64 exec, 0xffff
    buffer_load_dwordx4 v[156:159], v12, s[8:11], s52 offen offset:1024 sc1
    s_mov_b64 exec, -1
    s_add_u32 s52, s52, 40960
    buffer_load_dwordx4 v[160:163], v12, s[8:11], s52 offen sc1
    s_mov_b64 exec, 0xffff
    buffer_load_dwordx4 v[164:167], v12, s[8:11], s52 offen offset:1024 sc1
    s_mov_b64 exec, -1
    s_add_u32 s52, s52, 40960
    buffer_load_dwordx4 v[168:171], v12, s[8:11], s52 offen sc1
    s_mov_b64 exec, 0xffff
    buffer_load_dwordx4 v[172:175], v12, s[8:11], s52 offen offset:1024 sc1
    s_mov_b64 exec, -1
    s_add_u32 s52, s52, 40960
    s_waitcnt vmcnt(0)
    v_mfma_f32_16x16x32_bf16 v[40:43], v[24:27], v[112:115], 0
    v_mfma_f32_16x16x32_bf16 v[40:43], v[28:31], v[116:119], v[40:43]
    v_mfma_f32_16x16x32_bf16 v[44:47], v[32:35], v[112:115], 0
    v_mfma_f32_16x16x32_bf16 v[44:47], v[36:39], v[116:119], v[44:47]
    v_mfma_f32_16x16x32_bf16 v[48:51], v[24:27], v[120:123], 0
    v_mfma_f32_16x16x32_bf16 v[48:51], v[28:31], v[124:127], v[48:51]
    v_mfma_f32_16x16x32_bf16 v[52:55], v[32:35], v[120:123], 0
    v_mfma_f32_16x16x32_bf16 v[52:55], v[36:39], v[124:127], v[52:55]
    v_mfma_f32_16x16x32_bf16 v[56:59], v[24:27], v[128:131], 0
    v_mfma_f32_16x16x32_bf16 v[56:59], v[28:31], v[132:135], v[56:59]
    v_mfma_f32_16x16x32_bf16 v[60:63], v[32:35], v[128:131], 0
    v_mfma_f32_16x16x32_bf16 v[60:63], v[36:39], v[132:135], v[60:63]
    v_mfma_f32_16x16x32_bf16 v[64:67], v[24:27], v[136:139], 0
    v_mfma_f32_16x16x32_bf16 v[64:67], v[28:31], v[140:143], v[64:67]
    v_mfma_f32_16x16x32_bf16 v[68:71], v[32:35], v[136:139], 0
    v_mfma_f32_16x16x32_bf16 v[68:71], v[36:39], v[140:143], v[68:71]
    v_mfma_f32_16x16x32_bf16 v[72:75], v[24:27], v[144:147], 0
    v_mfma_f32_16x16x32_bf16 v[72:75], v[28:31], v[148:151], v[72:75]
    v_mfma_f32_16x16x32_bf16 v[76:79], v[32:35], v[144:147], 0
    v_mfma_f32_16x16x32_bf16 v[76:79], v[36:39], v[148:151], v[76:79]
    v_mfma_f32_16x16x32_bf16 v[80:83], v[24:27], v[152:155], 0
    v_mfma_f32_16x16x32_bf16 v[80:83], v[28:31], v[156:159], v[80:83]
    v_mfma_f32_16x16x32_bf16 v[84:87], v[32:35], v[152:155], 0
    v_mfma_f32_16x16x32_bf16 v[84:87], v[36:39], v[156:159], v[84:87]
    v_mfma_f32_16x16x32_bf16 v[88:91], v[24:27], v[160:163], 0
    v_mfma_f32_16x16x32_bf16 v[88:91], v[28:31], v[164:167], v[88:91]
    v_mfma_f32_16x16x32_bf16 v[92:95], v[32:35], v[160:163], 0
    v_mfma_f32_16x16x32_bf16 v[92:95], v[36:39], v[164:167], v[92:95]
    v_mfma_f32_16x16x32_bf16 v[96:99], v[24:27], v[168:171], 0
    v_mfma_f32_16x16x32_bf16 v[96:99], v[28:31], v[172:175], v[96:99]
    v_mfma_f32_16x16x32_bf16 v[100:103], v[32:35], v[168:171], 0
    v_mfma_f32_16x16x32_bf16 v[100:103], v[36:39], v[172:175], v[100:103]
    s_barrier
    v_cvt_pk_bf16_f32 v2, v40, v41
    v_cvt_pk_bf16_f32 v3, v42, v43
    v_cvt_pk_bf16_f32 v4, v44, v45
    v_and_b32 v5, 0xffff0000, v4
    v_add_f32 v5, s57, v5
    v_cvt_pk_bf16_f32 v5, v5, v5
    v_and_b32 v5, 0xffff0000, v5
    v_rcp_f32 v5, v5
    v_lshlrev_b32 v40, 16, v2
    v_and_b32 v41, 0xffff0000, v2
    v_lshlrev_b32 v42, 16, v3
    v_and_b32 v43, 0xffff0000, v3
    v_lshlrev_b32 v44, 16, v4
    v_mul_f32 v40, v40, v5
    v_mul_f32 v41, v41, v5
    v_mul_f32 v42, v42, v5
    v_mul_f32 v43, v43, v5
    v_mul_f32 v44, v44, v5
    v_cvt_pk_bf16_f32 v40, v40, v41
    v_cvt_pk_bf16_f32 v41, v42, v43
    v_cvt_pk_bf16_f32 v42, v44, v44
    ds_write_b64 v19, v[40:41] offset:0
    ds_write_b16 v20, v42 offset:32
    v_cvt_pk_bf16_f32 v2, v48, v49
    v_cvt_pk_bf16_f32 v3, v50, v51
    v_cvt_pk_bf16_f32 v4, v52, v53
    v_and_b32 v5, 0xffff0000, v4
    v_add_f32 v5, s57, v5
    v_cvt_pk_bf16_f32 v5, v5, v5
    v_and_b32 v5, 0xffff0000, v5
    v_rcp_f32 v5, v5
    v_lshlrev_b32 v48, 16, v2
    v_and_b32 v49, 0xffff0000, v2
    v_lshlrev_b32 v50, 16, v3
    v_and_b32 v51, 0xffff0000, v3
    v_lshlrev_b32 v52, 16, v4
    v_mul_f32 v48, v48, v5
    v_mul_f32 v49, v49, v5
    v_mul_f32 v50, v50, v5
    v_mul_f32 v51, v51, v5
    v_mul_f32 v52, v52, v5
    v_cvt_pk_bf16_f32 v48, v48, v49
    v_cvt_pk_bf16_f32 v49, v50, v51
    v_cvt_pk_bf16_f32 v50, v52, v52
    ds_write_b64 v19, v[48:49] offset:2560
    ds_write_b16 v20, v50 offset:2592
    v_cvt_pk_bf16_f32 v2, v56, v57
    v_cvt_pk_bf16_f32 v3, v58, v59
    v_cvt_pk_bf16_f32 v4, v60, v61
    v_and_b32 v5, 0xffff0000, v4
    v_add_f32 v5, s57, v5
    v_cvt_pk_bf16_f32 v5, v5, v5
    v_and_b32 v5, 0xffff0000, v5
    v_rcp_f32 v5, v5
    v_lshlrev_b32 v56, 16, v2
    v_and_b32 v57, 0xffff0000, v2
    v_lshlrev_b32 v58, 16, v3
    v_and_b32 v59, 0xffff0000, v3
    v_lshlrev_b32 v60, 16, v4
    v_mul_f32 v56, v56, v5
    v_mul_f32 v57, v57, v5
    v_mul_f32 v58, v58, v5
    v_mul_f32 v59, v59, v5
    v_mul_f32 v60, v60, v5
    v_cvt_pk_bf16_f32 v56, v56, v57
    v_cvt_pk_bf16_f32 v57, v58, v59
    v_cvt_pk_bf16_f32 v58, v60, v60
    ds_write_b64 v19, v[56:57] offset:5120
    ds_write_b16 v20, v58 offset:5152
    v_cvt_pk_bf16_f32 v2, v64, v65
    v_cvt_pk_bf16_f32 v3, v66, v67
    v_cvt_pk_bf16_f32 v4, v68, v69
    v_and_b32 v5, 0xffff0000, v4
    v_add_f32 v5, s57, v5
    v_cvt_pk_bf16_f32 v5, v5, v5
    v_and_b32 v5, 0xffff0000, v5
    v_rcp_f32 v5, v5
    v_lshlrev_b32 v64, 16, v2
    v_and_b32 v65, 0xffff0000, v2
    v_lshlrev_b32 v66, 16, v3
    v_and_b32 v67, 0xffff0000, v3
    v_lshlrev_b32 v68, 16, v4
    v_mul_f32 v64, v64, v5
    v_mul_f32 v65, v65, v5
    v_mul_f32 v66, v66, v5
    v_mul_f32 v67, v67, v5
    v_mul_f32 v68, v68, v5
    v_cvt_pk_bf16_f32 v64, v64, v65
    v_cvt_pk_bf16_f32 v65, v66, v67
    v_cvt_pk_bf16_f32 v66, v68, v68
    ds_write_b64 v19, v[64:65] offset:7680
    ds_write_b16 v20, v66 offset:7712
    v_cvt_pk_bf16_f32 v2, v72, v73
    v_cvt_pk_bf16_f32 v3, v74, v75
    v_cvt_pk_bf16_f32 v4, v76, v77
    v_and_b32 v5, 0xffff0000, v4
    v_add_f32 v5, s57, v5
    v_cvt_pk_bf16_f32 v5, v5, v5
    v_and_b32 v5, 0xffff0000, v5
    v_rcp_f32 v5, v5
    v_lshlrev_b32 v72, 16, v2
    v_and_b32 v73, 0xffff0000, v2
    v_lshlrev_b32 v74, 16, v3
    v_and_b32 v75, 0xffff0000, v3
    v_lshlrev_b32 v76, 16, v4
    v_mul_f32 v72, v72, v5
    v_mul_f32 v73, v73, v5
    v_mul_f32 v74, v74, v5
    v_mul_f32 v75, v75, v5
    v_mul_f32 v76, v76, v5
    v_cvt_pk_bf16_f32 v72, v72, v73
    v_cvt_pk_bf16_f32 v73, v74, v75
    v_cvt_pk_bf16_f32 v74, v76, v76
    ds_write_b64 v19, v[72:73] offset:10240
    ds_write_b16 v20, v74 offset:10272
    v_cvt_pk_bf16_f32 v2, v80, v81
    v_cvt_pk_bf16_f32 v3, v82, v83
    v_cvt_pk_bf16_f32 v4, v84, v85
    v_and_b32 v5, 0xffff0000, v4
    v_add_f32 v5, s57, v5
    v_cvt_pk_bf16_f32 v5, v5, v5
    v_and_b32 v5, 0xffff0000, v5
    v_rcp_f32 v5, v5
    v_lshlrev_b32 v80, 16, v2
    v_and_b32 v81, 0xffff0000, v2
    v_lshlrev_b32 v82, 16, v3
    v_and_b32 v83, 0xffff0000, v3
    v_lshlrev_b32 v84, 16, v4
    v_mul_f32 v80, v80, v5
    v_mul_f32 v81, v81, v5
    v_mul_f32 v82, v82, v5
    v_mul_f32 v83, v83, v5
    v_mul_f32 v84, v84, v5
    v_cvt_pk_bf16_f32 v80, v80, v81
    v_cvt_pk_bf16_f32 v81, v82, v83
    v_cvt_pk_bf16_f32 v82, v84, v84
    ds_write_b64 v19, v[80:81] offset:12800
    ds_write_b16 v20, v82 offset:12832
    v_cvt_pk_bf16_f32 v2, v88, v89
    v_cvt_pk_bf16_f32 v3, v90, v91
    v_cvt_pk_bf16_f32 v4, v92, v93
    v_and_b32 v5, 0xffff0000, v4
    v_add_f32 v5, s57, v5
    v_cvt_pk_bf16_f32 v5, v5, v5
    v_and_b32 v5, 0xffff0000, v5
    v_rcp_f32 v5, v5
    v_lshlrev_b32 v88, 16, v2
    v_and_b32 v89, 0xffff0000, v2
    v_lshlrev_b32 v90, 16, v3
    v_and_b32 v91, 0xffff0000, v3
    v_lshlrev_b32 v92, 16, v4
    v_mul_f32 v88, v88, v5
    v_mul_f32 v89, v89, v5
    v_mul_f32 v90, v90, v5
    v_mul_f32 v91, v91, v5
    v_mul_f32 v92, v92, v5
    v_cvt_pk_bf16_f32 v88, v88, v89
    v_cvt_pk_bf16_f32 v89, v90, v91
    v_cvt_pk_bf16_f32 v90, v92, v92
    ds_write_b64 v19, v[88:89] offset:15360
    ds_write_b16 v20, v90 offset:15392
    v_cvt_pk_bf16_f32 v2, v96, v97
    v_cvt_pk_bf16_f32 v3, v98, v99
    v_cvt_pk_bf16_f32 v4, v100, v101
    v_and_b32 v5, 0xffff0000, v4
    v_add_f32 v5, s57, v5
    v_cvt_pk_bf16_f32 v5, v5, v5
    v_and_b32 v5, 0xffff0000, v5
    v_rcp_f32 v5, v5
    v_lshlrev_b32 v96, 16, v2
    v_and_b32 v97, 0xffff0000, v2
    v_lshlrev_b32 v98, 16, v3
    v_and_b32 v99, 0xffff0000, v3
    v_lshlrev_b32 v100, 16, v4
    v_mul_f32 v96, v96, v5
    v_mul_f32 v97, v97, v5
    v_mul_f32 v98, v98, v5
    v_mul_f32 v99, v99, v5
    v_mul_f32 v100, v100, v5
    v_cvt_pk_bf16_f32 v96, v96, v97
    v_cvt_pk_bf16_f32 v97, v98, v99
    v_cvt_pk_bf16_f32 v98, v100, v100
    ds_write_b64 v19, v[96:97] offset:17920
    ds_write_b16 v20, v98 offset:17952
    s_waitcnt lgkmcnt(0)
    s_barrier
    ds_read_b128 v[180:183], v21 offset:0
    ds_read_b128 v[184:187], v21 offset:1024
    ds_read_b128 v[188:191], v21 offset:2048
    ds_read_b128 v[192:195], v21 offset:3072
    ds_read_b128 v[196:199], v21 offset:4096
    s_waitcnt lgkmcnt(0)
    buffer_store_dwordx4 v[180:183], v104, s[8:11], s53 offen sc1
    buffer_store_dwordx4 v[184:187], v105, s[8:11], s53 offen sc1
    buffer_store_dwordx4 v[188:191], v106, s[8:11], s53 offen sc1
    buffer_store_dwordx4 v[192:195], v107, s[8:11], s53 offen sc1
    buffer_store_dwordx4 v[196:199], v108, s[8:11], s53 offen sc1
    s_add_u32 s53, s53, 163840
    s_add_u32 s35, s35, 1
    s_cmp_lt_u32 s35, 4
    s_cbranch_scc1 L_B3
    s_waitcnt vmcnt(0)
    s_barrier
    s_mov_b32 s35, 1
    s_cmp_lg_u32 s34, 0
    s_cbranch_scc1 SF_123
    s_add_u32 s44, s35, 1
    v_mov_b32 v2, s44
    v_mov_b32 v3, 0
    s_mov_b64 exec, 1
    buffer_store_dword v2, v3, s[8:11], s60 offen sc1
    s_mov_b64 exec, -1
SF_123:
    s_mov_b32 s16, s88
    s_mov_b32 s17, s89
    s_mov_b32 s18, 819200
    s_mov_b32 s19, 0x20000
    s_and_b32 s44, s32, 1
    s_mul_i32 s50, s44, 640
    s_mul_i32 s44, s34, 160
    s_add_u32 s50, s50, s44
    s_mov_b32 s56, s50
    s_mul_i32 s51, s34, 36864
    v_add_u32 v2, 0, v1
    v_mul_u32_u24 v3, 6554, v2
    v_lshrrev_b32 v3, 16, v3
    v_mul_u32_u24 v4, 10, v3
    v_sub_u32 v4, v2, v4
    v_mul_u32_u24 v3, 1280, v3
    v_lshl_add_u32 v16, v4, 4, v3
    v_add_u32 v2, 64, v1
    v_mul_u32_u24 v3, 6554, v2
    v_lshrrev_b32 v3, 16, v3
    v_mul_u32_u24 v4, 10, v3
    v_sub_u32 v4, v2, v4
    v_mul_u32_u24 v3, 1280, v3
    v_lshl_add_u32 v17, v4, 4, v3
    v_add_u32 v2, 128, v1
    v_mul_u32_u24 v3, 6554, v2
    v_lshrrev_b32 v3, 16, v3
    v_mul_u32_u24 v4, 10, v3
    v_sub_u32 v4, v2, v4
    v_mul_u32_u24 v3, 1280, v3
    v_lshl_add_u32 v18, v4, 4, v3
    v_add_u32 v2, 192, v1
    v_mul_u32_u24 v3, 6554, v2
    v_lshrrev_b32 v3, 16, v3
    v_mul_u32_u24 v4, 10, v3
    v_sub_u32 v4, v2, v4
    v_mul_u32_u24 v3, 1280, v3
    v_lshl_add_u32 v19, v4, 4, v3
    v_add_u32 v2, 256, v1
    v_mul_u32_u24 v3, 6554, v2
    v_lshrrev_b32 v3, 16, v3
    v_mul_u32_u24 v4, 10, v3
    v_sub_u32 v4, v2, v4
    v_mul_u32_u24 v3, 1280, v3
    v_lshl_add_u32 v20, v4, 4, v3
    v_lshrrev_b32 v2, 4, v1
    v_bfe_u32 v3, v1, 2, 2
    v_lshl_add_u32 v2, v2, 3, v3
    v_mul_u32_u24 v2, 160, v2
    v_and_b32 v3, 3, v1
    v_mul_u32_u24 v3, 40, v3
    v_add3_u32 v21, v2, v3, s51
    s_add_u32 m0, s51, 0
    s_add_u32 s44, s50, 0
    buffer_load_dwordx4 v16, s[16:19], s44 offen lds
    s_add_u32 m0, s51, 1024
    s_nop 0
    buffer_load_dwordx4 v17, s[16:19], s44 offen lds
    s_add_u32 m0, s51, 2048
    s_nop 0
    buffer_load_dwordx4 v18, s[16:19], s44 offen lds
    s_add_u32 m0, s51, 3072
    s_nop 0
    buffer_load_dwordx4 v19, s[16:19], s44 offen lds
    s_add_u32 m0, s51, 4096
    s_nop 0
    buffer_load_dwordx4 v20, s[16:19], s44 offen lds
    s_add_u32 m0, s51, 5120
    s_add_u32 s44, s50, 40960
    buffer_load_dwordx4 v16, s[16:19], s44 offen lds
    s_add_u32 m0, s51, 6144
    s_nop 0
    buffer_load_dwordx4 v17, s[16:19], s44 offen lds
    s_add_u32 m0, s51, 7168
    s_nop 0
    buffer_load_dwordx4 v18, s[16:19], s44 offen lds
    s_add_u32 m0, s51, 8192
    s_nop 0
    buffer_load_dwordx4 v19, s[16:19], s44 offen lds
    s_add_u32 m0, s51, 9216
    s_nop 0
    buffer_load_dwordx4 v20, s[16:19], s44 offen lds
    s_add_u32 m0, s51, 12288
    s_add_u32 s44, s50, 81920
    buffer_load_dwordx4 v16, s[16:19], s44 offen lds
    s_add_u32 m0, s51, 13312
    s_nop 0
    buffer_load_dwordx4 v17, s[16:19], s44 offen lds
    s_add_u32 m0, s51, 14336
    s_nop 0
    buffer_load_dwordx4 v18, s[16:19], s44 offen lds
    s_add_u32 m0, s51, 15360
    s_nop 0
    buffer_load_dwordx4 v19, s[16:19], s44 offen lds
    s_add_u32 m0, s51, 16384
    s_nop 0
    buffer_load_dwordx4 v20, s[16:19], s44 offen lds
    s_add_u32 m0, s51, 17408
    s_add_u32 s44, s50, 122880
    buffer_load_dwordx4 v16, s[16:19], s44 offen lds
    s_add_u32 m0, s51, 18432
    s_nop 0
    buffer_load_dwordx4 v17, s[16:19], s44 offen lds
    s_add_u32 m0, s51, 19456
    s_nop 0
    buffer_load_dwordx4 v18, s[16:19], s44 offen lds
    s_add_u32 m0, s51, 20480
    s_nop 0
    buffer_load_dwordx4 v19, s[16:19], s44 offen lds
    s_add_u32 m0, s51, 21504
    s_nop 0
    buffer_load_dwordx4 v20, s[16:19], s44 offen lds
    s_add_u32 m0, s51, 24576
    s_add_u32 s44, s50, 163840
    buffer_load_dwordx4 v16, s[16:19], s44 offen lds
    s_add_u32 m0, s51, 25600
    s_nop 0
    buffer_load_dwordx4 v17, s[16:19], s44 offen lds
    s_add_u32 m0, s51, 26624
    s_nop 0
    buffer_load_dwordx4 v18, s[16:19], s44 offen lds
    s_add_u32 m0, s51, 27648
    s_nop 0
    buffer_load_dwordx4 v19, s[16:19], s44 offen lds
    s_add_u32 m0, s51, 28672
    s_nop 0
    buffer_load_dwordx4 v20, s[16:19], s44 offen lds
    s_add_u32 m0, s51, 29696
    s_add_u32 s44, s50, 204800
    buffer_load_dwordx4 v16, s[16:19], s44 offen lds
    s_add_u32 m0, s51, 30720
    s_nop 0
    buffer_load_dwordx4 v17, s[16:19], s44 offen lds
    s_add_u32 m0, s51, 31744
    s_nop 0
    buffer_load_dwordx4 v18, s[16:19], s44 offen lds
    s_add_u32 m0, s51, 32768
    s_nop 0
    buffer_load_dwordx4 v19, s[16:19], s44 offen lds
    s_add_u32 m0, s51, 33792
    s_nop 0
    buffer_load_dwordx4 v20, s[16:19], s44 offen lds
    s_waitcnt vmcnt(20)
    ds_read_b64_tr_b16 a[0:1], v21 offset:0
    ds_read_b64_tr_b16 a[2:3], v21 offset:640
    ds_read_b64_tr_b16 a[4:5], v21 offset:8
    ds_read_b64_tr_b16 a[6:7], v21 offset:648
    ds_read_b64_tr_b16 a[8:9], v21 offset:16
    ds_read_b64_tr_b16 a[10:11], v21 offset:656
    ds_read_b64_tr_b16 a[12:13], v21 offset:24
    ds_read_b64_tr_b16 a[14:15], v21 offset:664
    ds_read_b64_tr_b16 a[16:17], v21 offset:32
    ds_read_b64_tr_b16 a[18:19], v21 offset:672
    ds_read_b64_tr_b16 a[20:21], v21 offset:5120
    ds_read_b64_tr_b16 a[22:23], v21 offset:5760
    ds_read_b64_tr_b16 a[24:25], v21 offset:5128
    ds_read_b64_tr_b16 a[26:27], v21 offset:5768
    ds_read_b64_tr_b16 a[28:29], v21 offset:5136
    ds_read_b64_tr_b16 a[30:31], v21 offset:5776
    ds_read_b64_tr_b16 a[32:33], v21 offset:5144
    ds_read_b64_tr_b16 a[34:35], v21 offset:5784
    ds_read_b64_tr_b16 a[36:37], v21 offset:5152
    ds_read_b64_tr_b16 a[38:39], v21 offset:5792
    s_waitcnt lgkmcnt(0)
    s_add_u32 m0, s51, 0
    s_add_u32 s44, s50, 245760
    buffer_load_dwordx4 v16, s[16:19], s44 offen lds
    s_add_u32 m0, s51, 1024
    s_nop 0
    buffer_load_dwordx4 v17, s[16:19], s44 offen lds
    s_add_u32 m0, s51, 2048
    s_nop 0
    buffer_load_dwordx4 v18, s[16:19], s44 offen lds
    s_add_u32 m0, s51, 3072
    s_nop 0
    buffer_load_dwordx4 v19, s[16:19], s44 offen lds
    s_add_u32 m0, s51, 4096
    s_nop 0
    buffer_load_dwordx4 v20, s[16:19], s44 offen lds
    s_add_u32 m0, s51, 5120
    s_add_u32 s44, s50, 286720
    buffer_load_dwordx4 v16, s[16:19], s44 offen lds
    s_add_u32 m0, s51, 6144
    s_nop 0
    buffer_load_dwordx4 v17, s[16:19], s44 offen lds
    s_add_u32 m0, s51, 7168
    s_nop 0
    buffer_load_dwordx4 v18, s[16:19], s44 offen lds
    s_add_u32 m0, s51, 8192
    s_nop 0
    buffer_load_dwordx4 v19, s[16:19], s44 offen lds
    s_add_u32 m0, s51, 9216
    s_nop 0
    buffer_load_dwordx4 v20, s[16:19], s44 offen lds
    s_waitcnt vmcnt(20)
    ds_read_b64_tr_b16 a[40:41], v21 offset:12288
    ds_read_b64_tr_b16 a[42:43], v21 offset:12928
    ds_read_b64_tr_b16 a[44:45], v21 offset:12296
    ds_read_b64_tr_b16 a[46:47], v21 offset:12936
    ds_read_b64_tr_b16 a[48:49], v21 offset:12304
    ds_read_b64_tr_b16 a[50:51], v21 offset:12944
    ds_read_b64_tr_b16 a[52:53], v21 offset:12312
    ds_read_b64_tr_b16 a[54:55], v21 offset:12952
    ds_read_b64_tr_b16 a[56:57], v21 offset:12320
    ds_read_b64_tr_b16 a[58:59], v21 offset:12960
    ds_read_b64_tr_b16 a[60:61], v21 offset:17408
    ds_read_b64_tr_b16 a[62:63], v21 offset:18048
    ds_read_b64_tr_b16 a[64:65], v21 offset:17416
    ds_read_b64_tr_b16 a[66:67], v21 offset:18056
    ds_read_b64_tr_b16 a[68:69], v21 offset:17424
    ds_read_b64_tr_b16 a[70:71], v21 offset:18064
    ds_read_b64_tr_b16 a[72:73], v21 offset:17432
    ds_read_b64_tr_b16 a[74:75], v21 offset:18072
    ds_read_b64_tr_b16 a[76:77], v21 offset:17440
    ds_read_b64_tr_b16 a[78:79], v21 offset:18080
    s_waitcnt lgkmcnt(0)
    s_add_u32 m0, s51, 12288
    s_add_u32 s44, s50, 327680
    buffer_load_dwordx4 v16, s[16:19], s44 offen lds
    s_add_u32 m0, s51, 13312
    s_nop 0
    buffer_load_dwordx4 v17, s[16:19], s44 offen lds
    s_add_u32 m0, s51, 14336
    s_nop 0
    buffer_load_dwordx4 v18, s[16:19], s44 offen lds
    s_add_u32 m0, s51, 15360
    s_nop 0
    buffer_load_dwordx4 v19, s[16:19], s44 offen lds
    s_add_u32 m0, s51, 16384
    s_nop 0
    buffer_load_dwordx4 v20, s[16:19], s44 offen lds
    s_add_u32 m0, s51, 17408
    s_add_u32 s44, s50, 368640
    buffer_load_dwordx4 v16, s[16:19], s44 offen lds
    s_add_u32 m0, s51, 18432
    s_nop 0
    buffer_load_dwordx4 v17, s[16:19], s44 offen lds
    s_add_u32 m0, s51, 19456
    s_nop 0
    buffer_load_dwordx4 v18, s[16:19], s44 offen lds
    s_add_u32 m0, s51, 20480
    s_nop 0
    buffer_load_dwordx4 v19, s[16:19], s44 offen lds
    s_add_u32 m0, s51, 21504
    s_nop 0
    buffer_load_dwordx4 v20, s[16:19], s44 offen lds
    s_waitcnt vmcnt(20)
    ds_read_b64_tr_b16 a[80:81], v21 offset:24576
    ds_read_b64_tr_b16 a[82:83], v21 offset:25216
    ds_read_b64_tr_b16 a[84:85], v21 offset:24584
    ds_read_b64_tr_b16 a[86:87], v21 offset:25224
    ds_read_b64_tr_b16 a[88:89], v21 offset:24592
    ds_read_b64_tr_b16 a[90:91], v21 offset:25232
    ds_read_b64_tr_b16 a[92:93], v21 offset:24600
    ds_read_b64_tr_b16 a[94:95], v21 offset:25240
    ds_read_b64_tr_b16 a[96:97], v21 offset:24608
    ds_read_b64_tr_b16 a[98:99], v21 offset:25248
    ds_read_b64_tr_b16 a[100:101], v21 offset:29696
    ds_read_b64_tr_b16 a[102:103], v21 offset:30336
    ds_read_b64_tr_b16 a[104:105], v21 offset:29704
    ds_read_b64_tr_b16 a[106:107], v21 offset:30344
    ds_read_b64_tr_b16 a[108:109], v21 offset:29712
    ds_read_b64_tr_b16 a[110:111], v21 offset:30352
    ds_read_b64_tr_b16 a[112:113], v21 offset:29720
    ds_read_b64_tr_b16 a[114:115], v21 offset:30360
    ds_read_b64_tr_b16 a[116:117], v21 offset:29728
    ds_read_b64_tr_b16 a[118:119], v21 offset:30368
    s_waitcnt lgkmcnt(0)
    s_add_u32 m0, s51, 24576
    s_add_u32 s44, s50, 409600
    buffer_load_dwordx4 v16, s[16:19], s44 offen lds
    s_add_u32 m0, s51, 25600
    s_nop 0
    buffer_load_dwordx4 v17, s[16:19], s44 offen lds
    s_add_u32 m0, s51, 26624
    s_nop 0
    buffer_load_dwordx4 v18, s[16:19], s44 offen lds
    s_add_u32 m0, s51, 27648
    s_nop 0
    buffer_load_dwordx4 v19, s[16:19], s44 offen lds
    s_add_u32 m0, s51, 28672
    s_nop 0
    buffer_load_dwordx4 v20, s[16:19], s44 offen lds
    s_add_u32 m0, s51, 29696
    s_add_u32 s44, s50, 450560
    buffer_load_dwordx4 v16, s[16:19], s44 offen lds
    s_add_u32 m0, s51, 30720
    s_nop 0
    buffer_load_dwordx4 v17, s[16:19], s44 offen lds
    s_add_u32 m0, s51, 31744
    s_nop 0
    buffer_load_dwordx4 v18, s[16:19], s44 offen lds
    s_add_u32 m0, s51, 32768
    s_nop 0
    buffer_load_dwordx4 v19, s[16:19], s44 offen lds
    s_add_u32 m0, s51, 33792
    s_nop 0
    buffer_load_dwordx4 v20, s[16:19], s44 offen lds
    s_waitcnt vmcnt(20)
    ds_read_b64_tr_b16 a[120:121], v21 offset:0
    ds_read_b64_tr_b16 a[122:123], v21 offset:640
    ds_read_b64_tr_b16 a[124:125], v21 offset:8
    ds_read_b64_tr_b16 a[126:127], v21 offset:648
    ds_read_b64_tr_b16 a[128:129], v21 offset:16
    ds_read_b64_tr_b16 a[130:131], v21 offset:656
    ds_read_b64_tr_b16 a[132:133], v21 offset:24
    ds_read_b64_tr_b16 a[134:135], v21 offset:664
    ds_read_b64_tr_b16 a[136:137], v21 offset:32
    ds_read_b64_tr_b16 a[138:139], v21 offset:672
    ds_read_b64_tr_b16 a[140:141], v21 offset:5120
    ds_read_b64_tr_b16 a[142:143], v21 offset:5760
    ds_read_b64_tr_b16 a[144:145], v21 offset:5128
    ds_read_b64_tr_b16 a[146:147], v21 offset:5768
    ds_read_b64_tr_b16 a[148:149], v21 offset:5136
    ds_read_b64_tr_b16 a[150:151], v21 offset:5776
    ds_read_b64_tr_b16 a[152:153], v21 offset:5144
    ds_read_b64_tr_b16 a[154:155], v21 offset:5784
    ds_read_b64_tr_b16 a[156:157], v21 offset:5152
    ds_read_b64_tr_b16 a[158:159], v21 offset:5792
    s_waitcnt lgkmcnt(0)
    s_add_u32 m0, s51, 0
    s_add_u32 s44, s50, 491520
    buffer_load_dwordx4 v16, s[16:19], s44 offen lds
    s_add_u32 m0, s51, 1024
    s_nop 0
    buffer_load_dwordx4 v17, s[16:19], s44 offen lds
    s_add_u32 m0, s51, 2048
    s_nop 0
    buffer_load_dwordx4 v18, s[16:19], s44 offen lds
    s_add_u32 m0, s51, 3072
    s_nop 0
    buffer_load_dwordx4 v19, s[16:19], s44 offen lds
    s_add_u32 m0, s51, 4096
    s_nop 0
    buffer_load_dwordx4 v20, s[16:19], s44 offen lds
    s_add_u32 m0, s51, 5120
    s_add_u32 s44, s50, 532480
    buffer_load_dwordx4 v16, s[16:19], s44 offen lds
    s_add_u32 m0, s51, 6144
    s_nop 0
    buffer_load_dwordx4 v17, s[16:19], s44 offen lds
    s_add_u32 m0, s51, 7168
    s_nop 0
    buffer_load_dwordx4 v18, s[16:19], s44 offen lds
    s_add_u32 m0, s51, 8192
    s_nop 0
    buffer_load_dwordx4 v19, s[16:19], s44 offen lds
    s_add_u32 m0, s51, 9216
    s_nop 0
    buffer_load_dwordx4 v20, s[16:19], s44 offen lds
    s_waitcnt vmcnt(20)
    ds_read_b64_tr_b16 a[160:161], v21 offset:12288
    ds_read_b64_tr_b16 a[162:163], v21 offset:12928
    ds_read_b64_tr_b16 a[164:165], v21 offset:12296
    ds_read_b64_tr_b16 a[166:167], v21 offset:12936
    ds_read_b64_tr_b16 a[168:169], v21 offset:12304
    ds_read_b64_tr_b16 a[170:171], v21 offset:12944
    ds_read_b64_tr_b16 a[172:173], v21 offset:12312
    ds_read_b64_tr_b16 a[174:175], v21 offset:12952
    ds_read_b64_tr_b16 a[176:177], v21 offset:12320
    ds_read_b64_tr_b16 a[178:179], v21 offset:12960
    ds_read_b64_tr_b16 a[180:181], v21 offset:17408
    ds_read_b64_tr_b16 a[182:183], v21 offset:18048
    ds_read_b64_tr_b16 a[184:185], v21 offset:17416
    ds_read_b64_tr_b16 a[186:187], v21 offset:18056
    ds_read_b64_tr_b16 a[188:189], v21 offset:17424
    ds_read_b64_tr_b16 a[190:191], v21 offset:18064
    ds_read_b64_tr_b16 a[192:193], v21 offset:17432
    ds_read_b64_tr_b16 a[194:195], v21 offset:18072
    ds_read_b64_tr_b16 a[196:197], v21 offset:17440
    ds_read_b64_tr_b16 a[198:199], v21 offset:18080
    s_waitcnt lgkmcnt(0)
    s_add_u32 m0, s51, 12288
    s_add_u32 s44, s50, 573440
    buffer_load_dwordx4 v16, s[16:19], s44 offen lds
    s_add_u32 m0, s51, 13312
    s_nop 0
    buffer_load_dwordx4 v17, s[16:19], s44 offen lds
    s_add_u32 m0, s51, 14336
    s_nop 0
    buffer_load_dwordx4 v18, s[16:19], s44 offen lds
    s_add_u32 m0, s51, 15360
    s_nop 0
    buffer_load_dwordx4 v19, s[16:19], s44 offen lds
    s_add_u32 m0, s51, 16384
    s_nop 0
    buffer_load_dwordx4 v20, s[16:19], s44 offen lds
    s_add_u32 m0, s51, 17408
    s_add_u32 s44, s50, 614400
    buffer_load_dwordx4 v16, s[16:19], s44 offen lds
    s_add_u32 m0, s51, 18432
    s_nop 0
    buffer_load_dwordx4 v17, s[16:19], s44 offen lds
    s_add_u32 m0, s51, 19456
    s_nop 0
    buffer_load_dwordx4 v18, s[16:19], s44 offen lds
    s_add_u32 m0, s51, 20480
    s_nop 0
    buffer_load_dwordx4 v19, s[16:19], s44 offen lds
    s_add_u32 m0, s51, 21504
    s_nop 0
    buffer_load_dwordx4 v20, s[16:19], s44 offen lds
    s_waitcnt vmcnt(20)
    ds_read_b64_tr_b16 a[200:201], v21 offset:24576
    ds_read_b64_tr_b16 a[202:203], v21 offset:25216
    ds_read_b64_tr_b16 a[204:205], v21 offset:24584
    ds_read_b64_tr_b16 a[206:207], v21 offset:25224
    ds_read_b64_tr_b16 a[208:209], v21 offset:24592
    ds_read_b64_tr_b16 a[210:211], v21 offset:25232
    ds_read_b64_tr_b16 a[212:213], v21 offset:24600
    ds_read_b64_tr_b16 a[214:215], v21 offset:25240
    ds_read_b64_tr_b16 a[216:217], v21 offset:24608
    ds_read_b64_tr_b16 a[218:219], v21 offset:25248
    ds_read_b64_tr_b16 a[220:221], v21 offset:29696
    ds_read_b64_tr_b16 a[222:223], v21 offset:30336
    ds_read_b64_tr_b16 a[224:225], v21 offset:29704
    ds_read_b64_tr_b16 a[226:227], v21 offset:30344
    ds_read_b64_tr_b16 a[228:229], v21 offset:29712
    ds_read_b64_tr_b16 a[230:231], v21 offset:30352
    ds_read_b64_tr_b16 a[232:233], v21 offset:29720
    ds_read_b64_tr_b16 a[234:235], v21 offset:30360
    ds_read_b64_tr_b16 a[236:237], v21 offset:29728
    ds_read_b64_tr_b16 a[238:239], v21 offset:30368
    s_waitcnt lgkmcnt(0)
    s_add_u32 m0, s51, 24576
    s_add_u32 s44, s50, 655360
    buffer_load_dwordx4 v16, s[16:19], s44 offen lds
    s_add_u32 m0, s51, 25600
    s_nop 0
    buffer_load_dwordx4 v17, s[16:19], s44 offen lds
    s_add_u32 m0, s51, 26624
    s_nop 0
    buffer_load_dwordx4 v18, s[16:19], s44 offen lds
    s_add_u32 m0, s51, 27648
    s_nop 0
    buffer_load_dwordx4 v19, s[16:19], s44 offen lds
    s_add_u32 m0, s51, 28672
    s_nop 0
    buffer_load_dwordx4 v20, s[16:19], s44 offen lds
    s_add_u32 m0, s51, 29696
    s_add_u32 s44, s50, 696320
    buffer_load_dwordx4 v16, s[16:19], s44 offen lds
    s_add_u32 m0, s51, 30720
    s_nop 0
    buffer_load_dwordx4 v17, s[16:19], s44 offen lds
    s_add_u32 m0, s51, 31744
    s_nop 0
    buffer_load_dwordx4 v18, s[16:19], s44 offen lds
    s_add_u32 m0, s51, 32768
    s_nop 0
    buffer_load_dwordx4 v19, s[16:19], s44 offen lds
    s_add_u32 m0, s51, 33792
    s_nop 0
    buffer_load_dwordx4 v20, s[16:19], s44 offen lds
    s_waitcnt vmcnt(20)
    ds_read_b64_tr_b16 a[240:241], v21 offset:0
    ds_read_b64_tr_b16 a[242:243], v21 offset:640
    ds_read_b64_tr_b16 a[244:245], v21 offset:8
    ds_read_b64_tr_b16 a[246:247], v21 offset:648
    ds_read_b64_tr_b16 a[248:249], v21 offset:16
    ds_read_b64_tr_b16 a[250:251], v21 offset:656
    ds_read_b64_tr_b16 a[252:253], v21 offset:24
    ds_read_b64_tr_b16 a[254:255], v21 offset:664
    ds_read_b64_tr_b16 v[112:113], v21 offset:32
    ds_read_b64_tr_b16 v[114:115], v21 offset:672
    ds_read_b64_tr_b16 v[116:117], v21 offset:5120
    ds_read_b64_tr_b16 v[118:119], v21 offset:5760
    ds_read_b64_tr_b16 v[120:121], v21 offset:5128
    ds_read_b64_tr_b16 v[122:123], v21 offset:5768
    ds_read_b64_tr_b16 v[124:125], v21 offset:5136
    ds_read_b64_tr_b16 v[126:127], v21 offset:5776
    ds_read_b64_tr_b16 v[128:129], v21 offset:5144
    ds_read_b64_tr_b16 v[130:131], v21 offset:5784
    ds_read_b64_tr_b16 v[132:133], v21 offset:5152
    ds_read_b64_tr_b16 v[134:135], v21 offset:5792
    s_waitcnt lgkmcnt(0)
    s_add_u32 m0, s51, 0
    s_add_u32 s44, s50, 737280
    buffer_load_dwordx4 v16, s[16:19], s44 offen lds
    s_add_u32 m0, s51, 1024
    s_nop 0
    buffer_load_dwordx4 v17, s[16:19], s44 offen lds
    s_add_u32 m0, s51, 2048
    s_nop 0
    buffer_load_dwordx4 v18, s[16:19], s44 offen lds
    s_add_u32 m0, s51, 3072
    s_nop 0
    buffer_load_dwordx4 v19, s[16:19], s44 offen lds
    s_add_u32 m0, s51, 4096
    s_nop 0
    buffer_load_dwordx4 v20, s[16:19], s44 offen lds
    s_add_u32 m0, s51, 5120
    s_add_u32 s44, s50, 778240
    buffer_load_dwordx4 v16, s[16:19], s44 offen lds
    s_add_u32 m0, s51, 6144
    s_nop 0
    buffer_load_dwordx4 v17, s[16:19], s44 offen lds
    s_add_u32 m0, s51, 7168
    s_nop 0
    buffer_load_dwordx4 v18, s[16:19], s44 offen lds
    s_add_u32 m0, s51, 8192
    s_nop 0
    buffer_load_dwordx4 v19, s[16:19], s44 offen lds
    s_add_u32 m0, s51, 9216
    s_nop 0
    buffer_load_dwordx4 v20, s[16:19], s44 offen lds
    s_waitcnt vmcnt(20)
    ds_read_b64_tr_b16 v[136:137], v21 offset:12288
    ds_read_b64_tr_b16 v[138:139], v21 offset:12928
    ds_read_b64_tr_b16 v[140:141], v21 offset:12296
    ds_read_b64_tr_b16 v[142:143], v21 offset:12936
    ds_read_b64_tr_b16 v[144:145], v21 offset:12304
    ds_read_b64_tr_b16 v[146:147], v21 offset:12944
    ds_read_b64_tr_b16 v[148:149], v21 offset:12312
    ds_read_b64_tr_b16 v[150:151], v21 offset:12952
    ds_read_b64_tr_b16 v[152:153], v21 offset:12320
    ds_read_b64_tr_b16 v[154:155], v21 offset:12960
    ds_read_b64_tr_b16 v[156:157], v21 offset:17408
    ds_read_b64_tr_b16 v[158:159], v21 offset:18048
    ds_read_b64_tr_b16 v[160:161], v21 offset:17416
    ds_read_b64_tr_b16 v[162:163], v21 offset:18056
    ds_read_b64_tr_b16 v[164:165], v21 offset:17424
    ds_read_b64_tr_b16 v[166:167], v21 offset:18064
    ds_read_b64_tr_b16 v[168:169], v21 offset:17432
    ds_read_b64_tr_b16 v[170:171], v21 offset:18072
    ds_read_b64_tr_b16 v[172:173], v21 offset:17440
    ds_read_b64_tr_b16 v[174:175], v21 offset:18080
    s_waitcnt vmcnt(10)
    ds_read_b64_tr_b16 v[176:177], v21 offset:24576
    ds_read_b64_tr_b16 v[178:179], v21 offset:25216
    ds_read_b64_tr_b16 v[180:181], v21 offset:24584
    ds_read_b64_tr_b16 v[182:183], v21 offset:25224
    ds_read_b64_tr_b16 v[184:185], v21 offset:24592
    ds_read_b64_tr_b16 v[186:187], v21 offset:25232
    ds_read_b64_tr_b16 v[188:189], v21 offset:24600
    ds_read_b64_tr_b16 v[190:191], v21 offset:25240
    ds_read_b64_tr_b16 v[192:193], v21 offset:24608
    ds_read_b64_tr_b16 v[194:195], v21 offset:25248
    ds_read_b64_tr_b16 v[196:197], v21 offset:29696
    ds_read_b64_tr_b16 v[198:199], v21 offset:30336
    ds_read_b64_tr_b16 v[200:201], v21 offset:29704
    ds_read_b64_tr_b16 v[202:203], v21 offset:30344
    ds_read_b64_tr_b16 v[204:205], v21 offset:29712
    ds_read_b64_tr_b16 v[206:207], v21 offset:30352
    ds_read_b64_tr_b16 v[208:209], v21 offset:29720
    ds_read_b64_tr_b16 v[210:211], v21 offset:30360
    ds_read_b64_tr_b16 v[212:213], v21 offset:29728
    ds_read_b64_tr_b16 v[214:215], v21 offset:30368
    s_waitcnt vmcnt(0)
    ds_read_b64_tr_b16 v[216:217], v21 offset:0
    ds_read_b64_tr_b16 v[218:219], v21 offset:640
    ds_read_b64_tr_b16 v[220:221], v21 offset:8
    ds_read_b64_tr_b16 v[222:223], v21 offset:648
    ds_read_b64_tr_b16 v[224:225], v21 offset:16
    ds_read_b64_tr_b16 v[226:227], v21 offset:656
    ds_read_b64_tr_b16 v[228:229], v21 offset:24
    ds_read_b64_tr_b16 v[230:231], v21 offset:664
    ds_read_b64_tr_b16 v[232:233], v21 offset:32
    ds_read_b64_tr_b16 v[234:235], v21 offset:672
    ds_read_b64_tr_b16 v[236:237], v21 offset:5120
    ds_read_b64_tr_b16 v[238:239], v21 offset:5760
    ds_read_b64_tr_b16 v[240:241], v21 offset:5128
    ds_read_b64_tr_b16 v[242:243], v21 offset:5768
    ds_read_b64_tr_b16 v[244:245], v21 offset:5136
    ds_read_b64_tr_b16 v[246:247], v21 offset:5776
    ds_read_b64_tr_b16 v[248:249], v21 offset:5144
    ds_read_b64_tr_b16 v[250:251], v21 offset:5784
    ds_read_b64_tr_b16 v[252:253], v21 offset:5152
    ds_read_b64_tr_b16 v[254:255], v21 offset:5792
    s_waitcnt lgkmcnt(0)
    v_lshlrev_b32 v23, 7, v1
    s_lshl_b32 s59, s36, 10
    s_add_u32 s59, s59, 15032320
    s_mov_b32 s58, 2
    s_mov_b32 s42, 0
    s_mov_b64 exec, 0xff
WF_124:
    buffer_load_dword v2, v23, s[8:11], s59 offen sc1
    s_waitcnt vmcnt(0)
    v_cmp_gt_u32 vcc, s58, v2
    s_cbranch_vccz WFO_125
    s_sleep 1
    s_add_u32 s42, s42, 1
    s_cmp_lt_u32 s42, s37
    s_cbranch_scc1 WF_124
    s_mov_b32 s37, 1
WFO_125:
    s_mov_b64 exec, -1
    s_barrier
    s_lshl_b32 s44, s36, 2
    s_lshr_b32 s45, s32, 1
    s_add_u32 s44, s44, s45
    s_mul_i32 s52, s44, 163840
    s_add_u32 s52, s52, 125829120
    s_mul_i32 s55, s44, 327680
    s_add_u32 s55, s55, s56
    s_add_u32 s55, s55, 1280
    s_mov_b32 s53, 0
    s_mov_b32 s35, 0
    v_mul_u32_u24 v2, 2560, v14
    v_mul_u32_u24 v3, 40, v15
    v_add_u32 v18, v2, v3
    s_mov_b32 s44, s52
    s_lshl_b32 s46, s34, 10
    s_add_u32 s46, s46, s53
    s_add_u32 m0, s46, 0
    s_nop 0
    buffer_load_dwordx4 v11, s[8:11], s44 offen sc1 lds
    s_add_u32 m0, s46, 4096
    s_add_u32 s44, s44, 128
    buffer_load_dwordx4 v11, s[8:11], s44 offen sc1 lds
    s_add_u32 m0, s46, 8192
    s_add_u32 s44, s44, 128
    buffer_load_dwordx4 v11, s[8:11], s44 offen sc1 lds
    s_add_u32 m0, s46, 12288
    s_add_u32 s44, s44, 128
    buffer_load_dwordx4 v11, s[8:11], s44 offen sc1 lds
    s_add_u32 m0, s46, 16384
    s_add_u32 s44, s44, 128
    buffer_load_dwordx4 v11, s[8:11], s44 offen sc1 lds
    s_add_u32 m0, s46, 20480
    s_add_u32 s44, s44, 128
    buffer_load_dwordx4 v11, s[8:11], s44 offen sc1 lds
    s_add_u32 m0, s46, 24576
    s_add_u32 s44, s44, 128
    buffer_load_dwordx4 v11, s[8:11], s44 offen sc1 lds
    s_add_u32 m0, s46, 28672
    s_add_u32 s44, s44, 128
    buffer_load_dwordx4 v11, s[8:11], s44 offen sc1 lds
    s_add_u32 m0, s46, 32768
    s_add_u32 s44, s44, 128
    buffer_load_dwordx4 v11, s[8:11], s44 offen sc1 lds
    s_add_u32 m0, s46, 36864
    s_add_u32 s44, s44, 128
    buffer_load_dwordx4 v11, s[8:11], s44 offen sc1 lds
L_B4:
    s_waitcnt vmcnt(0) lgkmcnt(0)
    s_barrier
    v_add_u32 v13, s53, v0
    s_xor_b32 s53, s53, 40960
    s_add_u32 s52, s52, 40960
    s_cmp_ge_u32 s35, 3
    s_cbranch_scc1 L_B4_nox
    s_mov_b32 s44, s52
    s_lshl_b32 s46, s34, 10
    s_add_u32 s46, s46, s53
    s_add_u32 m0, s46, 0
    s_nop 0
    buffer_load_dwordx4 v11, s[8:11], s44 offen sc1 lds
    s_add_u32 m0, s46, 4096
    s_add_u32 s44, s44, 128
    buffer_load_dwordx4 v11, s[8:11], s44 offen sc1 lds
    s_add_u32 m0, s46, 8192
    s_add_u32 s44, s44, 128
    buffer_load_dwordx4 v11, s[8:11], s44 offen sc1 lds
    s_add_u32 m0, s46, 12288
    s_add_u32 s44, s44, 128
    buffer_load_dwordx4 v11, s[8:11], s44 offen sc1 lds
    s_add_u32 m0, s46, 16384
    s_add_u32 s44, s44, 128
    buffer_load_dwordx4 v11, s[8:11], s44 offen sc1 lds
    s_add_u32 m0, s46, 20480
    s_add_u32 s44, s44, 128
    buffer_load_dwordx4 v11, s[8:11], s44 offen sc1 lds
    s_add_u32 m0, s46, 24576
    s_add_u32 s44, s44, 128
    buffer_load_dwordx4 v11, s[8:11], s44 offen sc1 lds
    s_add_u32 m0, s46, 28672
    s_add_u32 s44, s44, 128
    buffer_load_dwordx4 v11, s[8:11], s44 offen sc1 lds
    s_add_u32 m0, s46, 32768
    s_add_u32 s44, s44, 128
    buffer_load_dwordx4 v11, s[8:11], s44 offen sc1 lds
    s_add_u32 m0, s46, 36864
    s_add_u32 s44, s44, 128
    buffer_load_dwordx4 v11, s[8:11], s44 offen sc1 lds
L_B4_nox:
    v_xor_b32 v10, 64, v13
    ds_read_b128 v[64:67], v13 offset:0
    ds_read_b128 v[68:71], v13 offset:2048
    ds_read_b128 v[72:75], v10 offset:0
    ds_read_b128 v[76:79], v10 offset:2048
    s_waitcnt lgkmcnt(2)
    v_mfma_f32_16x16x32_bf16 v[24:27], a[0:3], v[64:67], 0
    v_mfma_f32_16x16x32_bf16 v[44:47], a[0:3], v[68:71], 0
    v_mfma_f32_16x16x32_bf16 v[28:31], a[4:7], v[64:67], 0
    v_mfma_f32_16x16x32_bf16 v[48:51], a[4:7], v[68:71], 0
    v_mfma_f32_16x16x32_bf16 v[32:35], a[8:11], v[64:67], 0
    v_mfma_f32_16x16x32_bf16 v[52:55], a[8:11], v[68:71], 0
    v_mfma_f32_16x16x32_bf16 v[36:39], a[12:15], v[64:67], 0
    v_mfma_f32_16x16x32_bf16 v[56:59], a[12:15], v[68:71], 0
    v_mfma_f32_16x16x32_bf16 v[40:43], a[16:19], v[64:67], 0
    v_mfma_f32_16x16x32_bf16 v[60:63], a[16:19], v[68:71], 0
    ds_read_b128 v[64:67], v13 offset:4096
    ds_read_b128 v[68:71], v13 offset:6144
    s_waitcnt lgkmcnt(2)
    v_mfma_f32_16x16x32_bf16 v[24:27], a[20:23], v[72:75], v[24:27]
    v_mfma_f32_16x16x32_bf16 v[44:47], a[20:23], v[76:79], v[44:47]
    v_mfma_f32_16x16x32_bf16 v[28:31], a[24:27], v[72:75], v[28:31]
    v_mfma_f32_16x16x32_bf16 v[48:51], a[24:27], v[76:79], v[48:51]
    v_mfma_f32_16x16x32_bf16 v[32:35], a[28:31], v[72:75], v[32:35]
    v_mfma_f32_16x16x32_bf16 v[52:55], a[28:31], v[76:79], v[52:55]
    v_mfma_f32_16x16x32_bf16 v[36:39], a[32:35], v[72:75], v[36:39]
    v_mfma_f32_16x16x32_bf16 v[56:59], a[32:35], v[76:79], v[56:59]
    v_mfma_f32_16x16x32_bf16 v[40:43], a[36:39], v[72:75], v[40:43]
    v_mfma_f32_16x16x32_bf16 v[60:63], a[36:39], v[76:79], v[60:63]
    ds_read_b128 v[72:75], v10 offset:4096
    ds_read_b128 v[76:79], v10 offset:6144
    s_waitcnt lgkmcnt(2)
    v_mfma_f32_16x16x32_bf16 v[24:27], a[40:43], v[64:67], v[24:27]
    v_mfma_f32_16x16x32_bf16 v[44:47], a[40:43], v[68:71], v[44:47]
    v_mfma_f32_16x16x32_bf16 v[28:31], a[44:47], v[64:67], v[28:31]
    v_mfma_f32_16x16x32_bf16 v[48:51], a[44:47], v[68:71], v[48:51]
    v_mfma_f32_16x16x32_bf16 v[32:35], a[48:51], v[64:67], v[32:35]
    v_mfma_f32_16x16x32_bf16 v[52:55], a[48:51], v[68:71], v[52:55]
    v_mfma_f32_16x16x32_bf16 v[36:39], a[52:55], v[64:67], v[36:39]
    v_mfma_f32_16x16x32_bf16 v[56:59], a[52:55], v[68:71], v[56:59]
    v_mfma_f32_16x16x32_bf16 v[40:43], a[56:59], v[64:67], v[40:43]
    v_mfma_f32_16x16x32_bf16 v[60:63], a[56:59], v[68:71], v[60:63]
    ds_read_b128 v[64:67], v13 offset:8192
    ds_read_b128 v[68:71], v13 offset:10240
    s_waitcnt lgkmcnt(2)
    v_mfma_f32_16x16x32_bf16 v[24:27], a[60:63], v[72:75], v[24:27]
    v_mfma_f32_16x16x32_bf16 v[44:47], a[60:63], v[76:79], v[44:47]
    v_mfma_f32_16x16x32_bf16 v[28:31], a[64:67], v[72:75], v[28:31]
    v_mfma_f32_16x16x32_bf16 v[48:51], a[64:67], v[76:79], v[48:51]
    v_mfma_f32_16x16x32_bf16 v[32:35], a[68:71], v[72:75], v[32:35]
    v_mfma_f32_16x16x32_bf16 v[52:55], a[68:71], v[76:79], v[52:55]
    v_mfma_f32_16x16x32_bf16 v[36:39], a[72:75], v[72:75], v[36:39]
    v_mfma_f32_16x16x32_bf16 v[56:59], a[72:75], v[76:79], v[56:59]
    v_mfma_f32_16x16x32_bf16 v[40:43], a[76:79], v[72:75], v[40:43]
    v_mfma_f32_16x16x32_bf16 v[60:63], a[76:79], v[76:79], v[60:63]
    ds_read_b128 v[72:75], v10 offset:8192
    ds_read_b128 v[76:79], v10 offset:10240
    s_waitcnt lgkmcnt(2)
    v_mfma_f32_16x16x32_bf16 v[24:27], a[80:83], v[64:67], v[24:27]
    v_mfma_f32_16x16x32_bf16 v[44:47], a[80:83], v[68:71], v[44:47]
    v_mfma_f32_16x16x32_bf16 v[28:31], a[84:87], v[64:67], v[28:31]
    v_mfma_f32_16x16x32_bf16 v[48:51], a[84:87], v[68:71], v[48:51]
    v_mfma_f32_16x16x32_bf16 v[32:35], a[88:91], v[64:67], v[32:35]
    v_mfma_f32_16x16x32_bf16 v[52:55], a[88:91], v[68:71], v[52:55]
    v_mfma_f32_16x16x32_bf16 v[36:39], a[92:95], v[64:67], v[36:39]
    v_mfma_f32_16x16x32_bf16 v[56:59], a[92:95], v[68:71], v[56:59]
    v_mfma_f32_16x16x32_bf16 v[40:43], a[96:99], v[64:67], v[40:43]
    v_mfma_f32_16x16x32_bf16 v[60:63], a[96:99], v[68:71], v[60:63]
    ds_read_b128 v[64:67], v13 offset:12288
    ds_read_b128 v[68:71], v13 offset:14336
    s_waitcnt lgkmcnt(2)
    v_mfma_f32_16x16x32_bf16 v[24:27], a[100:103], v[72:75], v[24:27]
    v_mfma_f32_16x16x32_bf16 v[44:47], a[100:103], v[76:79], v[44:47]
    v_mfma_f32_16x16x32_bf16 v[28:31], a[104:107], v[72:75], v[28:31]
    v_mfma_f32_16x16x32_bf16 v[48:51], a[104:107], v[76:79], v[48:51]
    v_mfma_f32_16x16x32_bf16 v[32:35], a[108:111], v[72:75], v[32:35]
    v_mfma_f32_16x16x32_bf16 v[52:55], a[108:111], v[76:79], v[52:55]
    v_mfma_f32_16x16x32_bf16 v[36:39], a[112:115], v[72:75], v[36:39]
    v_mfma_f32_16x16x32_bf16 v[56:59], a[112:115], v[76:79], v[56:59]
    v_mfma_f32_16x16x32_bf16 v[40:43], a[116:119], v[72:75], v[40:43]
    v_mfma_f32_16x16x32_bf16 v[60:63], a[116:119], v[76:79], v[60:63]
    ds_read_b128 v[72:75], v10 offset:12288
    ds_read_b128 v[76:79], v10 offset:14336
    s_waitcnt lgkmcnt(2)
    v_mfma_f32_16x16x32_bf16 v[24:27], a[120:123], v[64:67], v[24:27]
    v_mfma_f32_16x16x32_bf16 v[44:47], a[120:123], v[68:71], v[44:47]
    v_mfma_f32_16x16x32_bf16 v[28:31], a[124:127], v[64:67], v[28:31]
    v_mfma_f32_16x16x32_bf16 v[48:51], a[124:127], v[68:71], v[48:51]
    v_mfma_f32_16x16x32_bf16 v[32:35], a[128:131], v[64:67], v[32:35]
    v_mfma_f32_16x16x32_bf16 v[52:55], a[128:131], v[68:71], v[52:55]
    v_mfma_f32_16x16x32_bf16 v[36:39], a[132:135], v[64:67], v[36:39]
    v_mfma_f32_16x16x32_bf16 v[56:59], a[132:135], v[68:71], v[56:59]
    v_mfma_f32_16x16x32_bf16 v[40:43], a[136:139], v[64:67], v[40:43]
    v_mfma_f32_16x16x32_bf16 v[60:63], a[136:139], v[68:71], v[60:63]
    ds_read_b128 v[64:67], v13 offset:16384
    ds_read_b128 v[68:71], v13 offset:18432
    s_waitcnt lgkmcnt(2)
    v_mfma_f32_16x16x32_bf16 v[24:27], a[140:143], v[72:75], v[24:27]
    v_mfma_f32_16x16x32_bf16 v[44:47], a[140:143], v[76:79], v[44:47]
    v_mfma_f32_16x16x32_bf16 v[28:31], a[144:147], v[72:75], v[28:31]
    v_mfma_f32_16x16x32_bf16 v[48:51], a[144:147], v[76:79], v[48:51]
    v_mfma_f32_16x16x32_bf16 v[32:35], a[148:151], v[72:75], v[32:35]
    v_mfma_f32_16x16x32_bf16 v[52:55], a[148:151], v[76:79], v[52:55]
    v_mfma_f32_16x16x32_bf16 v[36:39], a[152:155], v[72:75], v[36:39]
    v_mfma_f32_16x16x32_bf16 v[56:59], a[152:155], v[76:79], v[56:59]
    v_mfma_f32_16x16x32_bf16 v[40:43], a[156:159], v[72:75], v[40:43]
    v_mfma_f32_16x16x32_bf16 v[60:63], a[156:159], v[76:79], v[60:63]
    ds_read_b128 v[72:75], v10 offset:16384
    ds_read_b128 v[76:79], v10 offset:18432
    s_waitcnt lgkmcnt(2)
    v_mfma_f32_16x16x32_bf16 v[24:27], a[160:163], v[64:67], v[24:27]
    v_mfma_f32_16x16x32_bf16 v[44:47], a[160:163], v[68:71], v[44:47]
    v_mfma_f32_16x16x32_bf16 v[28:31], a[164:167], v[64:67], v[28:31]
    v_mfma_f32_16x16x32_bf16 v[48:51], a[164:167], v[68:71], v[48:51]
    v_mfma_f32_16x16x32_bf16 v[32:35], a[168:171], v[64:67], v[32:35]
    v_mfma_f32_16x16x32_bf16 v[52:55], a[168:171], v[68:71], v[52:55]
    v_mfma_f32_16x16x32_bf16 v[36:39], a[172:175], v[64:67], v[36:39]
    v_mfma_f32_16x16x32_bf16 v[56:59], a[172:175], v[68:71], v[56:59]
    v_mfma_f32_16x16x32_bf16 v[40:43], a[176:179], v[64:67], v[40:43]
    v_mfma_f32_16x16x32_bf16 v[60:63], a[176:179], v[68:71], v[60:63]
    ds_read_b128 v[64:67], v13 offset:20480
    ds_read_b128 v[68:71], v13 offset:22528
    s_waitcnt lgkmcnt(2)
    v_mfma_f32_16x16x32_bf16 v[24:27], a[180:183], v[72:75], v[24:27]
    v_mfma_f32_16x16x32_bf16 v[44:47], a[180:183], v[76:79], v[44:47]
    v_mfma_f32_16x16x32_bf16 v[28:31], a[184:187], v[72:75], v[28:31]
    v_mfma_f32_16x16x32_bf16 v[48:51], a[184:187], v[76:79], v[48:51]
    v_mfma_f32_16x16x32_bf16 v[32:35], a[188:191], v[72:75], v[32:35]
    v_mfma_f32_16x16x32_bf16 v[52:55], a[188:191], v[76:79], v[52:55]
    v_mfma_f32_16x16x32_bf16 v[36:39], a[192:195], v[72:75], v[36:39]
    v_mfma_f32_16x16x32_bf16 v[56:59], a[192:195], v[76:79], v[56:59]
    v_mfma_f32_16x16x32_bf16 v[40:43], a[196:199], v[72:75], v[40:43]
    v_mfma_f32_16x16x32_bf16 v[60:63], a[196:199], v[76:79], v[60:63]
    ds_read_b128 v[72:75], v10 offset:20480
    ds_read_b128 v[76:79], v10 offset:22528
    s_waitcnt lgkmcnt(2)
    v_mfma_f32_16x16x32_bf16 v[24:27], a[200:203], v[64:67], v[24:27]
    v_mfma_f32_16x16x32_bf16 v[44:47], a[200:203], v[68:71], v[44:47]
    v_mfma_f32_16x16x32_bf16 v[28:31], a[204:207], v[64:67], v[28:31]
    v_mfma_f32_16x16x32_bf16 v[48:51], a[204:207], v[68:71], v[48:51]
    v_mfma_f32_16x16x32_bf16 v[32:35], a[208:211], v[64:67], v[32:35]
    v_mfma_f32_16x16x32_bf16 v[52:55], a[208:211], v[68:71], v[52:55]
    v_mfma_f32_16x16x32_bf16 v[36:39], a[212:215], v[64:67], v[36:39]
    v_mfma_f32_16x16x32_bf16 v[56:59], a[212:215], v[68:71], v[56:59]
    v_mfma_f32_16x16x32_bf16 v[40:43], a[216:219], v[64:67], v[40:43]
    v_mfma_f32_16x16x32_bf16 v[60:63], a[216:219], v[68:71], v[60:63]
    ds_read_b128 v[64:67], v13 offset:24576
    ds_read_b128 v[68:71], v13 offset:26624
    s_waitcnt lgkmcnt(2)
    v_mfma_f32_16x16x32_bf16 v[24:27], a[220:223], v[72:75], v[24:27]
    v_mfma_f32_16x16x32_bf16 v[44:47], a[220:223], v[76:79], v[44:47]
    v_mfma_f32_16x16x32_bf16 v[28:31], a[224:227], v[72:75], v[28:31]
    v_mfma_f32_16x16x32_bf16 v[48:51], a[224:227], v[76:79], v[48:51]
    v_mfma_f32_16x16x32_bf16 v[32:35], a[228:231], v[72:75], v[32:35]
    v_mfma_f32_16x16x32_bf16 v[52:55], a[228:231], v[76:79], v[52:55]
    v_mfma_f32_16x16x32_bf16 v[36:39], a[232:235], v[72:75], v[36:39]
    v_mfma_f32_16x16x32_bf16 v[56:59], a[232:235], v[76:79], v[56:59]
    v_mfma_f32_16x16x32_bf16 v[40:43], a[236:239], v[72:75], v[40:43]
    v_mfma_f32_16x16x32_bf16 v[60:63], a[236:239], v[76:79], v[60:63]
    ds_read_b128 v[72:75], v10 offset:24576
    ds_read_b128 v[76:79], v10 offset:26624
    s_waitcnt lgkmcnt(2)
    v_mfma_f32_16x16x32_bf16 v[24:27], a[240:243], v[64:67], v[24:27]
    v_mfma_f32_16x16x32_bf16 v[44:47], a[240:243], v[68:71], v[44:47]
    v_mfma_f32_16x16x32_bf16 v[28:31], a[244:247], v[64:67], v[28:31]
    v_mfma_f32_16x16x32_bf16 v[48:51], a[244:247], v[68:71], v[48:51]
    v_mfma_f32_16x16x32_bf16 v[32:35], a[248:251], v[64:67], v[32:35]
    v_mfma_f32_16x16x32_bf16 v[52:55], a[248:251], v[68:71], v[52:55]
    v_mfma_f32_16x16x32_bf16 v[36:39], a[252:255], v[64:67], v[36:39]
    v_mfma_f32_16x16x32_bf16 v[56:59], a[252:255], v[68:71], v[56:59]
    v_mfma_f32_16x16x32_bf16 v[40:43], v[112:115], v[64:67], v[40:43]
    v_mfma_f32_16x16x32_bf16 v[60:63], v[112:115], v[68:71], v[60:63]
    ds_read_b128 v[64:67], v13 offset:28672
    ds_read_b128 v[68:71], v13 offset:30720
    s_waitcnt lgkmcnt(2)
    v_mfma_f32_16x16x32_bf16 v[24:27], v[116:119], v[72:75], v[24:27]
    v_mfma_f32_16x16x32_bf16 v[44:47], v[116:119], v[76:79], v[44:47]
    v_mfma_f32_16x16x32_bf16 v[28:31], v[120:123], v[72:75], v[28:31]
    v_mfma_f32_16x16x32_bf16 v[48:51], v[120:123], v[76:79], v[48:51]
    v_mfma_f32_16x16x32_bf16 v[32:35], v[124:127], v[72:75], v[32:35]
    v_mfma_f32_16x16x32_bf16 v[52:55], v[124:127], v[76:79], v[52:55]
    v_mfma_f32_16x16x32_bf16 v[36:39], v[128:131], v[72:75], v[36:39]
    v_mfma_f32_16x16x32_bf16 v[56:59], v[128:131], v[76:79], v[56:59]
    v_mfma_f32_16x16x32_bf16 v[40:43], v[132:135], v[72:75], v[40:43]
    v_mfma_f32_16x16x32_bf16 v[60:63], v[132:135], v[76:79], v[60:63]
    ds_read_b128 v[72:75], v10 offset:28672
    ds_read_b128 v[76:79], v10 offset:30720
    s_waitcnt lgkmcnt(2)
    v_mfma_f32_16x16x32_bf16 v[24:27], v[136:139], v[64:67], v[24:27]
    v_mfma_f32_16x16x32_bf16 v[44:47], v[136:139], v[68:71], v[44:47]
    v_mfma_f32_16x16x32_bf16 v[28:31], v[140:143], v[64:67], v[28:31]
    v_mfma_f32_16x16x32_bf16 v[48:51], v[140:143], v[68:71], v[48:51]
    v_mfma_f32_16x16x32_bf16 v[32:35], v[144:147], v[64:67], v[32:35]
    v_mfma_f32_16x16x32_bf16 v[52:55], v[144:147], v[68:71], v[52:55]
    v_mfma_f32_16x16x32_bf16 v[36:39], v[148:151], v[64:67], v[36:39]
    v_mfma_f32_16x16x32_bf16 v[56:59], v[148:151], v[68:71], v[56:59]
    v_mfma_f32_16x16x32_bf16 v[40:43], v[152:155], v[64:67], v[40:43]
    v_mfma_f32_16x16x32_bf16 v[60:63], v[152:155], v[68:71], v[60:63]
    ds_read_b128 v[64:67], v13 offset:32768
    ds_read_b128 v[68:71], v13 offset:34816
    s_waitcnt lgkmcnt(2)
    v_mfma_f32_16x16x32_bf16 v[24:27], v[156:159], v[72:75], v[24:27]
    v_mfma_f32_16x16x32_bf16 v[44:47], v[156:159], v[76:79], v[44:47]
    v_mfma_f32_16x16x32_bf16 v[28:31], v[160:163], v[72:75], v[28:31]
    v_mfma_f32_16x16x32_bf16 v[48:51], v[160:163], v[76:79], v[48:51]
    v_mfma_f32_16x16x32_bf16 v[32:35], v[164:167], v[72:75], v[32:35]
    v_mfma_f32_16x16x32_bf16 v[52:55], v[164:167], v[76:79], v[52:55]
    v_mfma_f32_16x16x32_bf16 v[36:39], v[168:171], v[72:75], v[36:39]
    v_mfma_f32_16x16x32_bf16 v[56:59], v[168:171], v[76:79], v[56:59]
    v_mfma_f32_16x16x32_bf16 v[40:43], v[172:175], v[72:75], v[40:43]
    v_mfma_f32_16x16x32_bf16 v[60:63], v[172:175], v[76:79], v[60:63]
    ds_read_b128 v[72:75], v10 offset:32768
    ds_read_b128 v[76:79], v10 offset:34816
    s_waitcnt lgkmcnt(2)
    v_mfma_f32_16x16x32_bf16 v[24:27], v[176:179], v[64:67], v[24:27]
    v_mfma_f32_16x16x32_bf16 v[44:47], v[176:179], v[68:71], v[44:47]
    v_mfma_f32_16x16x32_bf16 v[28:31], v[180:183], v[64:67], v[28:31]
    v_mfma_f32_16x16x32_bf16 v[48:51], v[180:183], v[68:71], v[48:51]
    v_mfma_f32_16x16x32_bf16 v[32:35], v[184:187], v[64:67], v[32:35]
    v_mfma_f32_16x16x32_bf16 v[52:55], v[184:187], v[68:71], v[52:55]
    v_mfma_f32_16x16x32_bf16 v[36:39], v[188:191], v[64:67], v[36:39]
    v_mfma_f32_16x16x32_bf16 v[56:59], v[188:191], v[68:71], v[56:59]
    v_mfma_f32_16x16x32_bf16 v[40:43], v[192:195], v[64:67], v[40:43]
    v_mfma_f32_16x16x32_bf16 v[60:63], v[192:195], v[68:71], v[60:63]
    ds_read_b128 v[64:67], v13 offset:36864
    ds_read_b128 v[68:71], v13 offset:38912
    s_waitcnt lgkmcnt(2)
    v_mfma_f32_16x16x32_bf16 v[24:27], v[196:199], v[72:75], v[24:27]
    v_mfma_f32_16x16x32_bf16 v[44:47], v[196:199], v[76:79], v[44:47]
    v_mfma_f32_16x16x32_bf16 v[28:31], v[200:203], v[72:75], v[28:31]
    v_mfma_f32_16x16x32_bf16 v[48:51], v[200:203], v[76:79], v[48:51]
    v_mfma_f32_16x16x32_bf16 v[32:35], v[204:207], v[72:75], v[32:35]
    v_mfma_f32_16x16x32_bf16 v[52:55], v[204:207], v[76:79], v[52:55]
    v_mfma_f32_16x16x32_bf16 v[36:39], v[208:211], v[72:75], v[36:39]
    v_mfma_f32_16x16x32_bf16 v[56:59], v[208:211], v[76:79], v[56:59]
    v_mfma_f32_16x16x32_bf16 v[40:43], v[212:215], v[72:75], v[40:43]
    v_mfma_f32_16x16x32_bf16 v[60:63], v[212:215], v[76:79], v[60:63]
    ds_read_b128 v[72:75], v10 offset:36864
    ds_read_b128 v[76:79], v10 offset:38912
    s_waitcnt lgkmcnt(2)
    v_mfma_f32_16x16x32_bf16 v[24:27], v[216:219], v[64:67], v[24:27]
    v_mfma_f32_16x16x32_bf16 v[44:47], v[216:219], v[68:71], v[44:47]
    v_mfma_f32_16x16x32_bf16 v[28:31], v[220:223], v[64:67], v[28:31]
    v_mfma_f32_16x16x32_bf16 v[48:51], v[220:223], v[68:71], v[48:51]
    v_mfma_f32_16x16x32_bf16 v[32:35], v[224:227], v[64:67], v[32:35]
    v_mfma_f32_16x16x32_bf16 v[52:55], v[224:227], v[68:71], v[52:55]
    v_mfma_f32_16x16x32_bf16 v[36:39], v[228:231], v[64:67], v[36:39]
    v_mfma_f32_16x16x32_bf16 v[56:59], v[228:231], v[68:71], v[56:59]
    v_mfma_f32_16x16x32_bf16 v[40:43], v[232:235], v[64:67], v[40:43]
    v_mfma_f32_16x16x32_bf16 v[60:63], v[232:235], v[68:71], v[60:63]
    s_waitcnt lgkmcnt(0)
    v_mfma_f32_16x16x32_bf16 v[24:27], v[236:239], v[72:75], v[24:27]
    v_mfma_f32_16x16x32_bf16 v[44:47], v[236:239], v[76:79], v[44:47]
    v_mfma_f32_16x16x32_bf16 v[28:31], v[240:243], v[72:75], v[28:31]
    v_mfma_f32_16x16x32_bf16 v[48:51], v[240:243], v[76:79], v[48:51]
    v_mfma_f32_16x16x32_bf16 v[32:35], v[244:247], v[72:75], v[32:35]
    v_mfma_f32_16x16x32_bf16 v[52:55], v[244:247], v[76:79], v[52:55]
    v_mfma_f32_16x16x32_bf16 v[36:39], v[248:251], v[72:75], v[36:39]
    v_mfma_f32_16x16x32_bf16 v[56:59], v[248:251], v[76:79], v[56:59]
    v_mfma_f32_16x16x32_bf16 v[40:43], v[252:255], v[72:75], v[40:43]
    v_mfma_f32_16x16x32_bf16 v[60:63], v[252:255], v[76:79], v[60:63]
    v_cvt_pk_bf16_f32 v92, v24, v25
    v_cvt_pk_bf16_f32 v93, v26, v27
    v_cvt_pk_bf16_f32 v94, v28, v29
    v_cvt_pk_bf16_f32 v95, v30, v31
    v_cvt_pk_bf16_f32 v96, v32, v33
    v_cvt_pk_bf16_f32 v97, v34, v35
    v_cvt_pk_bf16_f32 v98, v36, v37
    v_cvt_pk_bf16_f32 v99, v38, v39
    v_cvt_pk_bf16_f32 v100, v40, v41
    v_cvt_pk_bf16_f32 v101, v42, v43
    buffer_store_dwordx2 v[92:93], v18, s[28:31], s55 offen offset:0
    buffer_store_dwordx2 v[94:95], v18, s[28:31], s55 offen offset:8
    buffer_store_dwordx2 v[96:97], v18, s[28:31], s55 offen offset:16
    buffer_store_dwordx2 v[98:99], v18, s[28:31], s55 offen offset:24
    buffer_store_dwordx2 v[100:101], v18, s[28:31], s55 offen offset:32
    s_add_u32 s55, s55, 40960
    v_cvt_pk_bf16_f32 v102, v44, v45
    v_cvt_pk_bf16_f32 v103, v46, v47
    v_cvt_pk_bf16_f32 v104, v48, v49
    v_cvt_pk_bf16_f32 v105, v50, v51
    v_cvt_pk_bf16_f32 v106, v52, v53
    v_cvt_pk_bf16_f32 v107, v54, v55
    v_cvt_pk_bf16_f32 v108, v56, v57
    v_cvt_pk_bf16_f32 v109, v58, v59
    v_cvt_pk_bf16_f32 v110, v60, v61
    v_cvt_pk_bf16_f32 v111, v62, v63
    buffer_store_dwordx2 v[102:103], v18, s[28:31], s55 offen offset:0
    buffer_store_dwordx2 v[104:105], v18, s[28:31], s55 offen offset:8
    buffer_store_dwordx2 v[106:107], v18, s[28:31], s55 offen offset:16
    buffer_store_dwordx2 v[108:109], v18, s[28:31], s55 offen offset:24
    buffer_store_dwordx2 v[110:111], v18, s[28:31], s55 offen offset:32
    s_add_u32 s55, s55, 40960
    s_add_u32 s35, s35, 1
    s_cmp_lt_u32 s35, 4
    s_cbranch_scc1 L_B4
    s_endpgm
.section .rodata,"a"
.p2align 6
.amdhsa_kernel concat_heads__memory_aug_recurrent_mem_tr__linear_kernel_hedgehog__prompt_kernel
  .amdhsa_next_free_vgpr 512
  .amdhsa_next_free_sgpr 102
  .amdhsa_accum_offset 256
  .amdhsa_group_segment_fixed_size 0
  .amdhsa_kernarg_size 112
  .amdhsa_user_sgpr_count 2
  .amdhsa_user_sgpr_kernarg_segment_ptr 1
  .amdhsa_system_sgpr_workgroup_id_x 1
  .amdhsa_float_denorm_mode_32 3
.end_amdhsa_kernel
.text
```
